```python
import torch

def _softmax(x, axis=-1):
    return torch.softmax(x, dim=axis)
def _gelu(x):
    return torch.nn.functional.gelu(x, approximate="tanh")
def _silu(x):
    return torch.nn.functional.silu(x)
def _sigmoid(x):
    return torch.sigmoid(x)
def _layernorm(x, axis=-1, eps=1e-5):
    m = x.mean(dim=axis, keepdim=True)
    v = x.var(dim=axis, keepdim=True, unbiased=False)
    return (x - m) / torch.sqrt(v + eps)
def _scatter_add(tgt, idx, src, axis=0):
    return tgt.clone().index_add_(axis, idx, src)
def _segment_sum(src, seg, n):
    out = torch.zeros((n,) + src.shape[1:], dtype=src.dtype)
    return out.index_add_(0, seg, src)
def _pad(x, pw):
    flat = tuple(v for pair in reversed(pw) for v in pair)
    return torch.nn.functional.pad(x, flat)

kernel_name = 'sequential_preLN__sliding_block__mixer_token_mlp__prompt'

def setup_inputs():

    _w = (lambda a: (lambda t: t.to(torch.bfloat16) if t.is_floating_point() else t)(torch.as_tensor(a)))
    def _A_setup():
        B, S, D = 1, 2048, 640
        return {
            "x": _w((lambda *s: torch.randn(*s, dtype=torch.bfloat16) * 0.05)(B, S, D)),
            "wqkv": _w((lambda *s: torch.randn(*s, dtype=torch.bfloat16) * 0.05)(D, 3 * D)),
            "wo": _w((lambda *s: torch.randn(*s, dtype=torch.bfloat16) * 0.05)(D, D)),
        }
    _A_in = _A_setup()

    def _B_setup():
        B, S, D, F = 1, 2048, 640, 1728
        return {
            "x": _w((lambda *s: torch.randn(*s, dtype=torch.bfloat16) * 0.05)(B, S, D)),
            "w1": _w((lambda *s: torch.randn(*s, dtype=torch.bfloat16) * 1.6)(S, F) * (S ** -0.5)),
            "b1": _w((lambda *s: torch.randn(*s, dtype=torch.bfloat16) * 12.8)(F) * 0.02),
            "w2": _w((lambda *s: torch.randn(*s, dtype=torch.bfloat16) * 0.8)(F, S) * (F ** -0.5)),
            "b2": _w((lambda *s: torch.randn(*s, dtype=torch.bfloat16) * 12.8)(S) * 0.02),
        }
    _B_in = _B_setup()

    return {
        "A_x": _A_in["x"],
        "A_wqkv": _A_in["wqkv"],
        "A_wo": _A_in["wo"],
        "B_x": _B_in["x"],
        "B_w1": _B_in["w1"],
        "B_b1": _B_in["b1"],
        "B_w2": _B_in["w2"],
        "B_b2": _B_in["b2"],
    }

def reference(A_x, A_wqkv, A_wo, B_x, B_w1, B_b1, B_w2, B_b2):
    def _A_ref(x, wqkv, wo):
        B, S, D = x.shape
        H = 32; Dh = D // H; W = 256
        qkv = (lambda x, *d: x.permute(*d))((x @ wqkv).reshape(B, S, 3, H, Dh), 2, 0, 3, 1, 4)
        q, k, v = qkv[0], qkv[1], qkv[2]
        scores = torch.einsum("bhqd,bhkd->bhqk", q, k) * (Dh ** -0.5)
        idx = torch.arange(S)
        mask = (idx[:, None] - idx[None, :] >= 0) & (idx[:, None] - idx[None, :] < W)
        scores = torch.where(mask[None, None], scores, -1e9)
        p = _softmax(scores, axis=-1)
        o = torch.einsum("bhqk,bhkd->bhqd", p, v)
        return (lambda x, *d: x.permute(*d))(o, 0, 2, 1, 3).reshape(B, S, D) @ wo

    def _B_ref(x, w1, b1, w2, b2):
        B, S, D = x.shape
        h = _layernorm(x, axis=-1)
        u = torch.einsum("bsd,sf->bdf", h, w1) + b1
        u = _gelu(u)
        y = torch.einsum("bdf,fs->bds", u, w2) + b2
        return (lambda x, *d: x.permute(*d))(y, 0, 2, 1)

    x = A_x
    h = x + _A_ref(_layernorm(x, axis=-1), A_wqkv, A_wo)
    h2 = h + _B_ref(_layernorm(h, axis=-1), B_w1, B_b1, B_w2, B_b2)
    return h2
```

```asm
; @launch grid=(256,1,1) block=(256,1,1) lds=163840
.amdgcn_target "amdgcn-amd-amdhsa--gfx950"
.text
.globl sequential_preLN__sliding_block__mixer_token_mlp__prompt_kernel
.p2align 8
.type sequential_preLN__sliding_block__mixer_token_mlp__prompt_kernel,@function
sequential_preLN__sliding_block__mixer_token_mlp__prompt_kernel:
  s_load_dwordx16 s[4:19], s[0:1], 0
  s_lshr_b32 s57, s2, 3
  s_getpc_b64 s[70:71]
Lpc:
  v_lshrrev_b32 v53, 4, v0
  v_lshl_add_u32 v53, s57, 4, v53
  v_lshlrev_b32 v53, 7, v53
  v_min_u32 v53, Lcodeend-Lpc-4, v53
  global_load_dword v52, v53, s[70:71]
  s_cmp_gt_u32 s57, 31
  s_cbranch_scc1 Lend
  v_lshrrev_b32 v2, 6, v0
  s_and_b32 s56, s2, 7
  s_load_dwordx4 s[20:23], s[0:1], 64
  v_readfirstlane_b32 s58, v2
  s_load_dwordx2 s[24:25], s[0:1], 80
  v_and_b32 v1, 63, v0
  s_and_b32 s70, s56, 3
  s_lshl_b32 s70, s70, 2
  s_and_b32 s71, s57, 3
  s_add_u32 s62, s70, s71
  s_lshr_b32 s70, s56, 2
  s_lshl_b32 s70, s70, 3
  s_lshr_b32 s71, s57, 2
  s_add_u32 s63, s70, s71
  s_cmp_gt_u32 s57, 29
  s_cselect_b32 s70, 8, 0
  s_xor_b32 s63, s63, s70
  s_lshl_b32 s70, s62, 7
  s_lshl_b32 s71, s58, 5
  s_add_u32 s70, s70, s71
  v_lshrrev_b32 v24, 3, v1
  v_add_u32 v24, s70, v24
  v_mul_u32_u24 v24, 1280, v24
  v_lshrrev_b32 v25, 4, v1
  v_and_b32 v26, 7, v1
  v_xor_b32 v26, v26, v25
  v_lshl_add_u32 v14, v26, 4, v24
  v_xor_b32 v26, 4, v26
  v_lshl_add_u32 v15, v26, 4, v24
  v_add_u32 v16, 18432, v14
  v_add_u32 v15, 9216, v15
  v_add_u32 v17, 18432, v15
  v_and_b32 v27, 15, v1
  s_lshl_b32 s67, s58, 12
  s_mov_b32 s34, 2621440
  s_mov_b32 s35, 0x20000
  s_mov_b32 s38, 2457600
  s_mov_b32 s39, 0x20000
  s_waitcnt lgkmcnt(0)
  s_mov_b64 s[32:33], s[4:5]
  s_mov_b64 s[36:37], s[6:7]
  s_cmp_eq_u32 s63, 15
  s_cbranch_scc1 Lp1idle
  s_add_u32 m0, s67, 65536
  s_movk_i32 s65, 0
  buffer_load_dwordx4 v14, s[32:35], s65 offen offset:0 lds
  buffer_load_dwordx4 v15, s[32:35], s65 offen offset:1024 lds
  buffer_load_dwordx4 v16, s[32:35], s65 offen offset:2048 lds
  buffer_load_dwordx4 v17, s[32:35], s65 offen offset:3072 lds
  s_lshl_b32 s70, s58, 4
  v_add_u32 v24, s70, v25
  v_mul_u32_u24 v24, 3840, v24
  s_lshl_b32 s70, s63, 8
  v_add_u32 v24, s70, v24
  v_lshlrev_b32 v26, 1, v25
  v_xor_b32 v26, v26, v27
  v_lshl_add_u32 v18, v26, 4, v24
  v_xor_b32 v26, 8, v26
  v_lshl_add_u32 v20, v26, 4, v24
  v_add_u32 v19, 14336, v18
  v_add_u32 v21, 43008, v20
  v_add_u32 v20, 28672, v20
  s_add_u32 m0, s67, 81920
  s_mov_b32 s66, 0
  buffer_load_dwordx4 v18, s[36:39], s66 offen offset:0 lds
  buffer_load_dwordx4 v19, s[36:39], s66 offen offset:1024 lds
  buffer_load_dwordx4 v20, s[36:39], s66 offen offset:2048 lds
  buffer_load_dwordx4 v21, s[36:39], s66 offen offset:3072 lds
  s_lshl_b32 s60, s56, 5
  s_add_u32 s60, s60, s57
  s_mov_b32 s61, 0x40000
  s_mov_b32 s30, 18874368
  s_mov_b32 s31, 0x20000
  s_mov_b64 s[28:29], s[24:25]
  s_mov_b32 s42, 819200
  s_mov_b32 s43, 0x20000
  s_mov_b64 s[40:41], s[8:9]
  s_mov_b32 s46, 7077888
  s_mov_b32 s47, 0x20000
  s_mov_b64 s[44:45], s[12:13]
  s_mov_b32 s50, 7077888
  s_mov_b32 s51, 0x20000
  s_mov_b64 s[48:49], s[16:17]
  s_mov_b32 s54, 2621440
  s_mov_b32 s55, 0x20000
  s_mov_b64 s[52:53], s[20:21]
  buffer_load_dword v22, off, s[28:31], 0 sc1
  s_lshr_b32 s70, s57, 3
  s_lshl3_add_u32 s76, s70, s56
  s_and_b32 s9, s57, 7
  s_lshr_b32 s10, s60, 3
  s_mov_b32 s12, s9
  s_lshl3_add_u32 s11, s10, s9
  s_mul_i32 s8, s58, 25600
  s_mul_i32 s77, s58, 14
  s_lshr_b32 s70, s58, 1
  s_lshl_b32 s71, s70, 1
  s_and_b32 s71, s71, s58
  s_and_b32 s72, s58, s70
  s_add_u32 s70, s70, s72
  s_sub_u32 s77, s77, s70
  v_bfe_u32 v40, v1, 4, 1
  v_lshlrev_b32 v40, 1, v40
  v_and_b32 v41, 7, v1
  v_xor_b32 v40, v40, v41
  v_lshlrev_b32 v40, 4, v40
  v_xor_b32 v41, 64, v40
  v_lshrrev_b32 v42, 3, v1
  s_lshl_b32 s70, s58, 9
  v_add_u32 v43, s70, v42
  v_mul_u32_u24 v43, 3456, v43
  s_lshl_b32 s70, s76, 7
  s_cmp_ge_u32 s76, 27
  s_cselect_b32 s70, 0x80000000, s70
  s_mul_i32 s6, s58, 1769472
  s_add_u32 s6, s6, s70
  v_add_u32 v43, s70, v43
  v_add_u32 v244, v43, v40
  v_add_u32 v245, v43, v41
  v_add_u32 v245, 26624, v245
  s_lshl_b32 s70, s77, 5
  v_add_lshl_u32 v43, s70, v42, 12
  s_lshl_b32 s25, s70, 12
  s_lshl_b32 s70, s10, 7
  s_add_u32 s25, s25, s70
  v_add_u32 v43, s70, v43
  v_add_u32 v246, v43, v40
  v_add_u32 v247, v43, v41
  v_add_u32 v247, 31744, v247
  v_bfe_u32 v40, v1, 3, 2
  v_xor_b32 v40, s58, v40
  v_lshlrev_b32 v40, 5, v40
  v_and_b32 v41, 3, v1
  v_lshl_add_u32 v40, v41, 3, v40
  v_bfe_u32 v41, v1, 2, 2
  v_lshl_add_u32 v40, v41, 7, v40
  v_lshrrev_b32 v41, 4, v1
  v_lshl_add_u32 v250, v41, 10, v40
  s_lshr_b32 s70, s58, 1
  s_and_b32 s71, s58, 1
  v_bfe_u32 v24, v1, 1, 3
  v_xor_b32 v24, v24, v25
  v_lshlrev_b32 v24, 4, v24
  v_lshl_add_u32 v24, v27, 7, v24
  s_lshl_b32 s72, s70, 13
  v_add_u32 v2, s72, v24
  v_xor_b32 v3, 64, v2
  v_add_u32 v4, 0x10000, v2
  v_add_u32 v5, 0x10000, v3
  v_bfe_u32 v24, v1, 2, 3
  s_lshl_b32 s72, s71, 2
  s_lshl1_add_u32 s72, s70, s72
  v_xor_b32 v24, s72, v24
  v_lshlrev_b32 v24, 5, v24
  v_and_b32 v26, 3, v1
  v_lshl_add_u32 v24, v26, 3, v24
  v_bfe_u32 v26, v1, 2, 2
  v_lshl_add_u32 v26, v25, 3, v26
  v_lshl_add_u32 v24, v26, 8, v24
  v_add_u32 v6, 0x4000, v24
  v_xor_b32 v7, 32, v6
  v_xor_b32 v8, 64, v6
  v_xor_b32 v9, 96, v6
  v_add_u32 v10, 0x10000, v6
  v_add_u32 v11, 0x10000, v7
  v_add_u32 v12, 0x10000, v8
  v_add_u32 v13, 0x10000, v9
  s_lshl_b32 s72, s62, 11
  s_add_u32 s72, s72, 135168
  s_cmp_lt_u32 s63, 5
  s_cselect_b32 s68, 0x3ea52b5c, 1.0
  v_and_b32 v26, 31, v1
  s_lshl_b32 s73, s58, 5
  v_add_u32 v24, s73, v26
  v_lshl_add_u32 v28, v24, 4, s72
  v_lshlrev_b32 v29, 2, v24
  v_add_u32 v29, 8192, v29
  s_lshl_b32 s72, s58, 11
  s_add_u32 s72, s72, 0
  v_lshl_add_u32 v30, v1, 4, s72
  v_xor_b32 v32, 0x1000, v30
  v_lshrrev_b32 v24, 5, v1
  v_lshlrev_b32 v26, 4, v26
  v_mov_b32 v56, 0x3f803f80
  v_mov_b32 v57, 0x3f803f80
  v_mov_b32 v58, 0x3f803f80
  v_mov_b32 v59, 0x3f803f80
  s_add_u32 m0, s67, 98304
  s_movk_i32 s65, 128
  buffer_load_dwordx4 v14, s[32:35], s65 offen offset:0 lds
  buffer_load_dwordx4 v15, s[32:35], s65 offen offset:1024 lds
  buffer_load_dwordx4 v16, s[32:35], s65 offen offset:2048 lds
  buffer_load_dwordx4 v17, s[32:35], s65 offen offset:3072 lds
  s_add_u32 m0, s67, 114688
  s_mov_b32 s66, 245760
  buffer_load_dwordx4 v18, s[36:39], s66 offen offset:0 lds
  buffer_load_dwordx4 v19, s[36:39], s66 offen offset:1024 lds
  buffer_load_dwordx4 v20, s[36:39], s66 offen offset:2048 lds
  buffer_load_dwordx4 v21, s[36:39], s66 offen offset:3072 lds
  v_lshrrev_b32 v51, 3, v1
  v_max_u32 v51, 0, v51
  s_lshl4_add_u32 s72, s58, s62
  v_lshl_add_u32 v51, v51, 6, s72
  v_mul_u32_u24 v51, 3840, v51
  v_and_b32 v53, 4, v1
  v_lshl_add_u32 v51, v53, 5, v51
  s_lshl_b32 s72, s63, 8
  s_add_u32 s72, s72, 491520
  buffer_load_dword v51, v51, s[36:39], s72 offen
  s_cmp_ge_u32 s63, 10
  s_cbranch_scc1 Lp1v
  s_lshl_b32 s72, s63, 4
  s_lshl3_add_u32 s72, s71, s72
  v_add_u32 v24, s72, v24
  s_mov_b32 s72, 33280
  v_mad_u32_u24 v31, v24, s72, v26
  s_lshl_b32 s72, s62, 11
  s_lshl_b32 s73, s70, 10
  s_add_u32 s72, s72, s73
  v_add_u32 v31, s72, v31
  s_lshl_b32 s72, s70, 8
  s_add_u32 s72, s72, 8192
  v_lshl_add_u32 v33, v27, 2, s72
  s_mul_i32 s74, s70, 133120
  s_add_u32 s72, s74, 1048576
  s_add_u32 s73, s74, 1115136
  s_sub_u32 s75, 1248256, s74
  s_sub_u32 s74, 1181696, s74
  s_waitcnt vmcnt(10)
  s_barrier
  ds_read_b64_tr_b16 v[160:161], v10 offset:0
  ds_read_b64_tr_b16 v[162:163], v10 offset:1024
  ds_read_b128 v[128:131], v4 offset:0
  ds_read_b128 v[132:135], v4 offset:2048
  ds_read_b128 v[136:139], v4 offset:4096
  ds_read_b128 v[140:143], v4 offset:6144
  ds_read_b64_tr_b16 v[164:165], v11 offset:0
  ds_read_b64_tr_b16 v[166:167], v11 offset:1024
  ds_read_b64_tr_b16 v[168:169], v12 offset:0
  ds_read_b64_tr_b16 v[170:171], v12 offset:1024
  ds_read_b64_tr_b16 v[172:173], v13 offset:0
  ds_read_b64_tr_b16 v[174:175], v13 offset:1024
  s_waitcnt vmcnt(9)
  v_readfirstlane_b32 s59, v22
  s_nop 0
  s_mul_i32 s59, s59, 1664525
  s_add_u32 s59, s59, 1013904223
  s_waitcnt lgkmcnt(9)
  v_mfma_f32_16x16x32_bf16 v[64:67], v[160:163], v[128:131], 0
  ds_read_b64_tr_b16 v[176:177], v10 offset:8192
  s_add_u32 m0, s67, 0
  s_waitcnt lgkmcnt(9)
  v_mfma_f32_16x16x32_bf16 v[68:71], v[160:163], v[132:135], 0
  ds_read_b64_tr_b16 v[178:179], v10 offset:9216
  s_movk_i32 s65, 256
  s_waitcnt lgkmcnt(9)
  v_mfma_f32_16x16x32_bf16 v[72:75], v[160:163], v[136:139], 0
  ds_read_b128 v[144:147], v5 offset:0
  s_waitcnt lgkmcnt(9)
  v_mfma_f32_16x16x32_bf16 v[76:79], v[160:163], v[140:143], 0
  buffer_load_dwordx4 v14, s[32:35], s65 offen offset:0 lds
  s_waitcnt lgkmcnt(7)
  v_mfma_f32_16x16x32_bf16 v[80:83], v[164:167], v[128:131], 0
  ds_read_b128 v[148:151], v5 offset:2048
  v_mfma_f32_16x16x32_bf16 v[40:43], v[160:163], v[56:59], 0
  ds_read_b128 v[152:155], v5 offset:4096
  v_mfma_f32_16x16x32_bf16 v[84:87], v[164:167], v[132:135], 0
  ds_read_b128 v[156:159], v5 offset:6144
  v_mfma_f32_16x16x32_bf16 v[88:91], v[164:167], v[136:139], 0
  buffer_load_dwordx4 v15, s[32:35], s65 offen offset:1024 lds
  v_mfma_f32_16x16x32_bf16 v[92:95], v[164:167], v[140:143], 0
  ds_read_b64_tr_b16 v[180:181], v11 offset:8192
  s_waitcnt lgkmcnt(9)
  v_mfma_f32_16x16x32_bf16 v[96:99], v[168:171], v[128:131], 0
  ds_read_b64_tr_b16 v[182:183], v11 offset:9216
  v_mfma_f32_16x16x32_bf16 v[44:47], v[164:167], v[56:59], 0
  ds_read_b64_tr_b16 v[184:185], v12 offset:8192
  v_mfma_f32_16x16x32_bf16 v[100:103], v[168:171], v[132:135], 0
  buffer_load_dwordx4 v16, s[32:35], s65 offen offset:2048 lds
  v_mfma_f32_16x16x32_bf16 v[104:107], v[168:171], v[136:139], 0
  ds_read_b64_tr_b16 v[186:187], v12 offset:9216
  v_mfma_f32_16x16x32_bf16 v[108:111], v[168:171], v[140:143], 0
  ds_read_b64_tr_b16 v[188:189], v13 offset:8192
  s_waitcnt lgkmcnt(11)
  v_mfma_f32_16x16x32_bf16 v[112:115], v[172:175], v[128:131], 0
  ds_read_b64_tr_b16 v[190:191], v13 offset:9216
  v_mfma_f32_16x16x32_bf16 v[116:119], v[172:175], v[132:135], 0
  buffer_load_dwordx4 v17, s[32:35], s65 offen offset:3072 lds
  s_add_u32 m0, s67, 16384
  v_mfma_f32_16x16x32_bf16 v[120:123], v[172:175], v[136:139], 0
  s_mov_b32 s66, 491520
  v_mfma_f32_16x16x32_bf16 v[124:127], v[172:175], v[140:143], 0
  buffer_load_dwordx4 v18, s[36:39], s66 offen offset:0 lds
  s_waitcnt lgkmcnt(0)
  s_waitcnt vmcnt(6)
  s_barrier
  v_mfma_f32_16x16x32_bf16 v[64:67], v[176:179], v[144:147], v[64:67]
  ds_read_b64_tr_b16 v[160:161], v10 offset:32768
  v_mfma_f32_16x16x32_bf16 v[68:71], v[176:179], v[148:151], v[68:71]
  ds_read_b64_tr_b16 v[162:163], v10 offset:33792
  v_mfma_f32_16x16x32_bf16 v[72:75], v[176:179], v[152:155], v[72:75]
  ds_read_b128 v[128:131], v4 offset:32768
  v_mfma_f32_16x16x32_bf16 v[76:79], v[176:179], v[156:159], v[76:79]
  buffer_load_dwordx4 v19, s[36:39], s66 offen offset:1024 lds
  v_mfma_f32_16x16x32_bf16 v[80:83], v[180:183], v[144:147], v[80:83]
  ds_read_b128 v[132:135], v4 offset:34816
  v_mfma_f32_16x16x32_bf16 v[40:43], v[176:179], v[56:59], v[40:43]
  ds_read_b128 v[136:139], v4 offset:36864
  v_mfma_f32_16x16x32_bf16 v[84:87], v[180:183], v[148:151], v[84:87]
  ds_read_b128 v[140:143], v4 offset:38912
  v_mfma_f32_16x16x32_bf16 v[88:91], v[180:183], v[152:155], v[88:91]
  buffer_load_dwordx4 v20, s[36:39], s66 offen offset:2048 lds
  v_mfma_f32_16x16x32_bf16 v[92:95], v[180:183], v[156:159], v[92:95]
  ds_read_b64_tr_b16 v[164:165], v11 offset:32768
  v_mfma_f32_16x16x32_bf16 v[96:99], v[184:187], v[144:147], v[96:99]
  ds_read_b64_tr_b16 v[166:167], v11 offset:33792
  v_mfma_f32_16x16x32_bf16 v[44:47], v[180:183], v[56:59], v[44:47]
  ds_read_b64_tr_b16 v[168:169], v12 offset:32768
  v_mfma_f32_16x16x32_bf16 v[100:103], v[184:187], v[148:151], v[100:103]
  buffer_load_dwordx4 v21, s[36:39], s66 offen offset:3072 lds
  v_mfma_f32_16x16x32_bf16 v[104:107], v[184:187], v[152:155], v[104:107]
  ds_read_b64_tr_b16 v[170:171], v12 offset:33792
  s_add_u32 m0, s67, 32768
  v_mfma_f32_16x16x32_bf16 v[108:111], v[184:187], v[156:159], v[108:111]
  ds_read_b64_tr_b16 v[172:173], v13 offset:32768
  s_movk_i32 s65, 384
  v_mfma_f32_16x16x32_bf16 v[112:115], v[188:191], v[144:147], v[112:115]
  ds_read_b64_tr_b16 v[174:175], v13 offset:33792
  v_mfma_f32_16x16x32_bf16 v[116:119], v[188:191], v[148:151], v[116:119]
  buffer_load_dwordx4 v14, s[32:35], s65 offen offset:0 lds
  v_mfma_f32_16x16x32_bf16 v[120:123], v[188:191], v[152:155], v[120:123]
  buffer_load_dwordx4 v15, s[32:35], s65 offen offset:1024 lds
  v_mfma_f32_16x16x32_bf16 v[124:127], v[188:191], v[156:159], v[124:127]
  buffer_load_dwordx4 v16, s[32:35], s65 offen offset:2048 lds
  s_waitcnt lgkmcnt(9)
  v_mfma_f32_16x16x32_bf16 v[64:67], v[160:163], v[128:131], v[64:67]
  ds_read_b64_tr_b16 v[176:177], v10 offset:40960
  s_waitcnt lgkmcnt(9)
  v_mfma_f32_16x16x32_bf16 v[68:71], v[160:163], v[132:135], v[68:71]
  ds_read_b64_tr_b16 v[178:179], v10 offset:41984
  s_waitcnt lgkmcnt(9)
  v_mfma_f32_16x16x32_bf16 v[72:75], v[160:163], v[136:139], v[72:75]
  ds_read_b128 v[144:147], v5 offset:32768
  s_waitcnt lgkmcnt(9)
  v_mfma_f32_16x16x32_bf16 v[76:79], v[160:163], v[140:143], v[76:79]
  buffer_load_dwordx4 v17, s[32:35], s65 offen offset:3072 lds
  s_add_u32 m0, s67, 49152
  s_waitcnt lgkmcnt(7)
  v_mfma_f32_16x16x32_bf16 v[80:83], v[164:167], v[128:131], v[80:83]
  ds_read_b128 v[148:151], v5 offset:34816
  s_mov_b32 s66, 737280
  v_mfma_f32_16x16x32_bf16 v[40:43], v[160:163], v[56:59], v[40:43]
  ds_read_b128 v[152:155], v5 offset:36864
  v_mfma_f32_16x16x32_bf16 v[84:87], v[164:167], v[132:135], v[84:87]
  ds_read_b128 v[156:159], v5 offset:38912
  v_mfma_f32_16x16x32_bf16 v[88:91], v[164:167], v[136:139], v[88:91]
  buffer_load_dwordx4 v18, s[36:39], s66 offen offset:0 lds
  v_mfma_f32_16x16x32_bf16 v[92:95], v[164:167], v[140:143], v[92:95]
  ds_read_b64_tr_b16 v[180:181], v11 offset:40960
  s_waitcnt lgkmcnt(9)
  v_mfma_f32_16x16x32_bf16 v[96:99], v[168:171], v[128:131], v[96:99]
  ds_read_b64_tr_b16 v[182:183], v11 offset:41984
  v_mfma_f32_16x16x32_bf16 v[44:47], v[164:167], v[56:59], v[44:47]
  ds_read_b64_tr_b16 v[184:185], v12 offset:40960
  v_mfma_f32_16x16x32_bf16 v[100:103], v[168:171], v[132:135], v[100:103]
  buffer_load_dwordx4 v19, s[36:39], s66 offen offset:1024 lds
  v_mfma_f32_16x16x32_bf16 v[104:107], v[168:171], v[136:139], v[104:107]
  ds_read_b64_tr_b16 v[186:187], v12 offset:41984
  v_mfma_f32_16x16x32_bf16 v[108:111], v[168:171], v[140:143], v[108:111]
  ds_read_b64_tr_b16 v[188:189], v13 offset:40960
  s_waitcnt lgkmcnt(11)
  v_mfma_f32_16x16x32_bf16 v[112:115], v[172:175], v[128:131], v[112:115]
  ds_read_b64_tr_b16 v[190:191], v13 offset:41984
  v_mfma_f32_16x16x32_bf16 v[116:119], v[172:175], v[132:135], v[116:119]
  buffer_load_dwordx4 v20, s[36:39], s66 offen offset:2048 lds
  v_mfma_f32_16x16x32_bf16 v[120:123], v[172:175], v[136:139], v[120:123]
  buffer_load_dwordx4 v21, s[36:39], s66 offen offset:3072 lds
  v_mfma_f32_16x16x32_bf16 v[124:127], v[172:175], v[140:143], v[124:127]
  s_add_u32 m0, s67, 65536
  s_movk_i32 s65, 512
  s_waitcnt lgkmcnt(0)
  s_waitcnt vmcnt(8)
  s_barrier
  v_mfma_f32_16x16x32_bf16 v[64:67], v[176:179], v[144:147], v[64:67]
  ds_read_b64_tr_b16 v[160:161], v6 offset:0
  v_mfma_f32_16x16x32_bf16 v[68:71], v[176:179], v[148:151], v[68:71]
  ds_read_b64_tr_b16 v[162:163], v6 offset:1024
  v_mfma_f32_16x16x32_bf16 v[72:75], v[176:179], v[152:155], v[72:75]
  ds_read_b128 v[128:131], v2 offset:0
  v_mfma_f32_16x16x32_bf16 v[76:79], v[176:179], v[156:159], v[76:79]
  buffer_load_dwordx4 v14, s[32:35], s65 offen offset:0 lds
  v_mfma_f32_16x16x32_bf16 v[80:83], v[180:183], v[144:147], v[80:83]
  ds_read_b128 v[132:135], v2 offset:2048
  v_mfma_f32_16x16x32_bf16 v[40:43], v[176:179], v[56:59], v[40:43]
  ds_read_b128 v[136:139], v2 offset:4096
  v_mfma_f32_16x16x32_bf16 v[84:87], v[180:183], v[148:151], v[84:87]
  ds_read_b128 v[140:143], v2 offset:6144
  v_mfma_f32_16x16x32_bf16 v[88:91], v[180:183], v[152:155], v[88:91]
  buffer_load_dwordx4 v15, s[32:35], s65 offen offset:1024 lds
  v_mfma_f32_16x16x32_bf16 v[92:95], v[180:183], v[156:159], v[92:95]
  ds_read_b64_tr_b16 v[164:165], v7 offset:0
  v_mfma_f32_16x16x32_bf16 v[96:99], v[184:187], v[144:147], v[96:99]
  ds_read_b64_tr_b16 v[166:167], v7 offset:1024
  v_mfma_f32_16x16x32_bf16 v[44:47], v[180:183], v[56:59], v[44:47]
  ds_read_b64_tr_b16 v[168:169], v8 offset:0
  v_mfma_f32_16x16x32_bf16 v[100:103], v[184:187], v[148:151], v[100:103]
  buffer_load_dwordx4 v16, s[32:35], s65 offen offset:2048 lds
  v_mfma_f32_16x16x32_bf16 v[104:107], v[184:187], v[152:155], v[104:107]
  ds_read_b64_tr_b16 v[170:171], v8 offset:1024
  v_mfma_f32_16x16x32_bf16 v[108:111], v[184:187], v[156:159], v[108:111]
  ds_read_b64_tr_b16 v[172:173], v9 offset:0
  v_mfma_f32_16x16x32_bf16 v[112:115], v[188:191], v[144:147], v[112:115]
  ds_read_b64_tr_b16 v[174:175], v9 offset:1024
  v_mfma_f32_16x16x32_bf16 v[116:119], v[188:191], v[148:151], v[116:119]
  buffer_load_dwordx4 v17, s[32:35], s65 offen offset:3072 lds
  s_add_u32 m0, s67, 81920
  v_mfma_f32_16x16x32_bf16 v[120:123], v[188:191], v[152:155], v[120:123]
  s_mov_b32 s66, 983040
  v_mfma_f32_16x16x32_bf16 v[124:127], v[188:191], v[156:159], v[124:127]
  buffer_load_dwordx4 v18, s[36:39], s66 offen offset:0 lds
  s_waitcnt lgkmcnt(9)
  v_mfma_f32_16x16x32_bf16 v[64:67], v[160:163], v[128:131], v[64:67]
  ds_read_b64_tr_b16 v[176:177], v6 offset:8192
  s_waitcnt lgkmcnt(9)
  v_mfma_f32_16x16x32_bf16 v[68:71], v[160:163], v[132:135], v[68:71]
  ds_read_b64_tr_b16 v[178:179], v6 offset:9216
  s_waitcnt lgkmcnt(9)
  v_mfma_f32_16x16x32_bf16 v[72:75], v[160:163], v[136:139], v[72:75]
  ds_read_b128 v[144:147], v3 offset:0
  s_waitcnt lgkmcnt(9)
  v_mfma_f32_16x16x32_bf16 v[76:79], v[160:163], v[140:143], v[76:79]
  buffer_load_dwordx4 v19, s[36:39], s66 offen offset:1024 lds
  s_waitcnt lgkmcnt(7)
  v_mfma_f32_16x16x32_bf16 v[80:83], v[164:167], v[128:131], v[80:83]
  ds_read_b128 v[148:151], v3 offset:2048
  v_mfma_f32_16x16x32_bf16 v[40:43], v[160:163], v[56:59], v[40:43]
  ds_read_b128 v[152:155], v3 offset:4096
  v_mfma_f32_16x16x32_bf16 v[84:87], v[164:167], v[132:135], v[84:87]
  ds_read_b128 v[156:159], v3 offset:6144
  v_mfma_f32_16x16x32_bf16 v[88:91], v[164:167], v[136:139], v[88:91]
  buffer_load_dwordx4 v20, s[36:39], s66 offen offset:2048 lds
  v_mfma_f32_16x16x32_bf16 v[92:95], v[164:167], v[140:143], v[92:95]
  ds_read_b64_tr_b16 v[180:181], v7 offset:8192
  s_waitcnt lgkmcnt(9)
  v_mfma_f32_16x16x32_bf16 v[96:99], v[168:171], v[128:131], v[96:99]
  ds_read_b64_tr_b16 v[182:183], v7 offset:9216
  v_mfma_f32_16x16x32_bf16 v[44:47], v[164:167], v[56:59], v[44:47]
  ds_read_b64_tr_b16 v[184:185], v8 offset:8192
  v_mfma_f32_16x16x32_bf16 v[100:103], v[168:171], v[132:135], v[100:103]
  buffer_load_dwordx4 v21, s[36:39], s66 offen offset:3072 lds
  v_mfma_f32_16x16x32_bf16 v[104:107], v[168:171], v[136:139], v[104:107]
  ds_read_b64_tr_b16 v[186:187], v8 offset:9216
  s_add_u32 m0, s67, 98304
  v_mfma_f32_16x16x32_bf16 v[108:111], v[168:171], v[140:143], v[108:111]
  ds_read_b64_tr_b16 v[188:189], v9 offset:8192
  s_movk_i32 s65, 640
  s_waitcnt lgkmcnt(11)
  v_mfma_f32_16x16x32_bf16 v[112:115], v[172:175], v[128:131], v[112:115]
  ds_read_b64_tr_b16 v[190:191], v9 offset:9216
  v_mfma_f32_16x16x32_bf16 v[116:119], v[172:175], v[132:135], v[116:119]
  buffer_load_dwordx4 v14, s[32:35], s65 offen offset:0 lds
  v_mfma_f32_16x16x32_bf16 v[120:123], v[172:175], v[136:139], v[120:123]
  buffer_load_dwordx4 v15, s[32:35], s65 offen offset:1024 lds
  v_mfma_f32_16x16x32_bf16 v[124:127], v[172:175], v[140:143], v[124:127]
  buffer_load_dwordx4 v16, s[32:35], s65 offen offset:2048 lds
  s_waitcnt lgkmcnt(0)
  s_waitcnt vmcnt(11)
  s_barrier
  v_mfma_f32_16x16x32_bf16 v[64:67], v[176:179], v[144:147], v[64:67]
  ds_read_b64_tr_b16 v[160:161], v6 offset:32768
  v_mfma_f32_16x16x32_bf16 v[68:71], v[176:179], v[148:151], v[68:71]
  ds_read_b64_tr_b16 v[162:163], v6 offset:33792
  v_mfma_f32_16x16x32_bf16 v[72:75], v[176:179], v[152:155], v[72:75]
  ds_read_b128 v[128:131], v2 offset:32768
  v_mfma_f32_16x16x32_bf16 v[76:79], v[176:179], v[156:159], v[76:79]
  buffer_load_dwordx4 v17, s[32:35], s65 offen offset:3072 lds
  s_add_u32 m0, s67, 114688
  v_mfma_f32_16x16x32_bf16 v[80:83], v[180:183], v[144:147], v[80:83]
  ds_read_b128 v[132:135], v2 offset:34816
  s_mov_b32 s66, 1228800
  v_mfma_f32_16x16x32_bf16 v[40:43], v[176:179], v[56:59], v[40:43]
  ds_read_b128 v[136:139], v2 offset:36864
  v_mfma_f32_16x16x32_bf16 v[84:87], v[180:183], v[148:151], v[84:87]
  ds_read_b128 v[140:143], v2 offset:38912
  v_mfma_f32_16x16x32_bf16 v[88:91], v[180:183], v[152:155], v[88:91]
  buffer_load_dwordx4 v18, s[36:39], s66 offen offset:0 lds
  v_mfma_f32_16x16x32_bf16 v[92:95], v[180:183], v[156:159], v[92:95]
  ds_read_b64_tr_b16 v[164:165], v7 offset:32768
  v_mfma_f32_16x16x32_bf16 v[96:99], v[184:187], v[144:147], v[96:99]
  ds_read_b64_tr_b16 v[166:167], v7 offset:33792
  v_mfma_f32_16x16x32_bf16 v[44:47], v[180:183], v[56:59], v[44:47]
  ds_read_b64_tr_b16 v[168:169], v8 offset:32768
  v_mfma_f32_16x16x32_bf16 v[100:103], v[184:187], v[148:151], v[100:103]
  buffer_load_dwordx4 v19, s[36:39], s66 offen offset:1024 lds
  v_mfma_f32_16x16x32_bf16 v[104:107], v[184:187], v[152:155], v[104:107]
  ds_read_b64_tr_b16 v[170:171], v8 offset:33792
  v_mfma_f32_16x16x32_bf16 v[108:111], v[184:187], v[156:159], v[108:111]
  ds_read_b64_tr_b16 v[172:173], v9 offset:32768
  v_mfma_f32_16x16x32_bf16 v[112:115], v[188:191], v[144:147], v[112:115]
  ds_read_b64_tr_b16 v[174:175], v9 offset:33792
  v_mfma_f32_16x16x32_bf16 v[116:119], v[188:191], v[148:151], v[116:119]
  buffer_load_dwordx4 v20, s[36:39], s66 offen offset:2048 lds
  v_mfma_f32_16x16x32_bf16 v[120:123], v[188:191], v[152:155], v[120:123]
  buffer_load_dwordx4 v21, s[36:39], s66 offen offset:3072 lds
  v_mfma_f32_16x16x32_bf16 v[124:127], v[188:191], v[156:159], v[124:127]
  s_add_u32 m0, s67, 0
  s_movk_i32 s65, 768
  s_waitcnt lgkmcnt(9)
  v_mfma_f32_16x16x32_bf16 v[64:67], v[160:163], v[128:131], v[64:67]
  ds_read_b64_tr_b16 v[176:177], v6 offset:40960
  s_waitcnt lgkmcnt(9)
  v_mfma_f32_16x16x32_bf16 v[68:71], v[160:163], v[132:135], v[68:71]
  ds_read_b64_tr_b16 v[178:179], v6 offset:41984
  s_waitcnt lgkmcnt(9)
  v_mfma_f32_16x16x32_bf16 v[72:75], v[160:163], v[136:139], v[72:75]
  ds_read_b128 v[144:147], v3 offset:32768
  s_waitcnt lgkmcnt(9)
  v_mfma_f32_16x16x32_bf16 v[76:79], v[160:163], v[140:143], v[76:79]
  buffer_load_dwordx4 v14, s[32:35], s65 offen offset:0 lds
  s_waitcnt lgkmcnt(7)
  v_mfma_f32_16x16x32_bf16 v[80:83], v[164:167], v[128:131], v[80:83]
  ds_read_b128 v[148:151], v3 offset:34816
  v_mfma_f32_16x16x32_bf16 v[40:43], v[160:163], v[56:59], v[40:43]
  ds_read_b128 v[152:155], v3 offset:36864
  v_mfma_f32_16x16x32_bf16 v[84:87], v[164:167], v[132:135], v[84:87]
  ds_read_b128 v[156:159], v3 offset:38912
  v_mfma_f32_16x16x32_bf16 v[88:91], v[164:167], v[136:139], v[88:91]
  buffer_load_dwordx4 v15, s[32:35], s65 offen offset:1024 lds
  v_mfma_f32_16x16x32_bf16 v[92:95], v[164:167], v[140:143], v[92:95]
  ds_read_b64_tr_b16 v[180:181], v7 offset:40960
  s_waitcnt lgkmcnt(9)
  v_mfma_f32_16x16x32_bf16 v[96:99], v[168:171], v[128:131], v[96:99]
  ds_read_b64_tr_b16 v[182:183], v7 offset:41984
  v_mfma_f32_16x16x32_bf16 v[44:47], v[164:167], v[56:59], v[44:47]
  ds_read_b64_tr_b16 v[184:185], v8 offset:40960
  v_mfma_f32_16x16x32_bf16 v[100:103], v[168:171], v[132:135], v[100:103]
  buffer_load_dwordx4 v16, s[32:35], s65 offen offset:2048 lds
  v_mfma_f32_16x16x32_bf16 v[104:107], v[168:171], v[136:139], v[104:107]
  ds_read_b64_tr_b16 v[186:187], v8 offset:41984
  v_mfma_f32_16x16x32_bf16 v[108:111], v[168:171], v[140:143], v[108:111]
  ds_read_b64_tr_b16 v[188:189], v9 offset:40960
  s_waitcnt lgkmcnt(11)
  v_mfma_f32_16x16x32_bf16 v[112:115], v[172:175], v[128:131], v[112:115]
  ds_read_b64_tr_b16 v[190:191], v9 offset:41984
  v_mfma_f32_16x16x32_bf16 v[116:119], v[172:175], v[132:135], v[116:119]
  buffer_load_dwordx4 v17, s[32:35], s65 offen offset:3072 lds
  s_add_u32 m0, s67, 16384
  v_mfma_f32_16x16x32_bf16 v[120:123], v[172:175], v[136:139], v[120:123]
  s_mov_b32 s66, 1474560
  v_mfma_f32_16x16x32_bf16 v[124:127], v[172:175], v[140:143], v[124:127]
  buffer_load_dwordx4 v18, s[36:39], s66 offen offset:0 lds
  s_waitcnt lgkmcnt(0)
  s_waitcnt vmcnt(13)
  s_barrier
  v_mfma_f32_16x16x32_bf16 v[64:67], v[176:179], v[144:147], v[64:67]
  ds_read_b64_tr_b16 v[160:161], v10 offset:0
  v_mfma_f32_16x16x32_bf16 v[68:71], v[176:179], v[148:151], v[68:71]
  ds_read_b64_tr_b16 v[162:163], v10 offset:1024
  v_mfma_f32_16x16x32_bf16 v[72:75], v[176:179], v[152:155], v[72:75]
  ds_read_b128 v[128:131], v4 offset:0
  v_mfma_f32_16x16x32_bf16 v[76:79], v[176:179], v[156:159], v[76:79]
  buffer_load_dwordx4 v19, s[36:39], s66 offen offset:1024 lds
  v_mfma_f32_16x16x32_bf16 v[80:83], v[180:183], v[144:147], v[80:83]
  ds_read_b128 v[132:135], v4 offset:2048
  v_mfma_f32_16x16x32_bf16 v[40:43], v[176:179], v[56:59], v[40:43]
  ds_read_b128 v[136:139], v4 offset:4096
  v_mfma_f32_16x16x32_bf16 v[84:87], v[180:183], v[148:151], v[84:87]
  ds_read_b128 v[140:143], v4 offset:6144
  v_mfma_f32_16x16x32_bf16 v[88:91], v[180:183], v[152:155], v[88:91]
  buffer_load_dwordx4 v20, s[36:39], s66 offen offset:2048 lds
  v_mfma_f32_16x16x32_bf16 v[92:95], v[180:183], v[156:159], v[92:95]
  ds_read_b64_tr_b16 v[164:165], v11 offset:0
  v_mfma_f32_16x16x32_bf16 v[96:99], v[184:187], v[144:147], v[96:99]
  ds_read_b64_tr_b16 v[166:167], v11 offset:1024
  v_mfma_f32_16x16x32_bf16 v[44:47], v[180:183], v[56:59], v[44:47]
  ds_read_b64_tr_b16 v[168:169], v12 offset:0
  v_mfma_f32_16x16x32_bf16 v[100:103], v[184:187], v[148:151], v[100:103]
  buffer_load_dwordx4 v21, s[36:39], s66 offen offset:3072 lds
  v_mfma_f32_16x16x32_bf16 v[104:107], v[184:187], v[152:155], v[104:107]
  ds_read_b64_tr_b16 v[170:171], v12 offset:1024
  s_add_u32 m0, s67, 32768
  v_mfma_f32_16x16x32_bf16 v[108:111], v[184:187], v[156:159], v[108:111]
  ds_read_b64_tr_b16 v[172:173], v13 offset:0
  s_movk_i32 s65, 896
  v_mfma_f32_16x16x32_bf16 v[112:115], v[188:191], v[144:147], v[112:115]
  ds_read_b64_tr_b16 v[174:175], v13 offset:1024
  v_mfma_f32_16x16x32_bf16 v[116:119], v[188:191], v[148:151], v[116:119]
  buffer_load_dwordx4 v14, s[32:35], s65 offen offset:0 lds
  v_mfma_f32_16x16x32_bf16 v[120:123], v[188:191], v[152:155], v[120:123]
  buffer_load_dwordx4 v15, s[32:35], s65 offen offset:1024 lds
  v_mfma_f32_16x16x32_bf16 v[124:127], v[188:191], v[156:159], v[124:127]
  buffer_load_dwordx4 v16, s[32:35], s65 offen offset:2048 lds
  s_waitcnt lgkmcnt(9)
  v_mfma_f32_16x16x32_bf16 v[64:67], v[160:163], v[128:131], v[64:67]
  ds_read_b64_tr_b16 v[176:177], v10 offset:8192
  s_waitcnt lgkmcnt(9)
  v_mfma_f32_16x16x32_bf16 v[68:71], v[160:163], v[132:135], v[68:71]
  ds_read_b64_tr_b16 v[178:179], v10 offset:9216
  s_waitcnt lgkmcnt(9)
  v_mfma_f32_16x16x32_bf16 v[72:75], v[160:163], v[136:139], v[72:75]
  ds_read_b128 v[144:147], v5 offset:0
  s_waitcnt lgkmcnt(9)
  v_mfma_f32_16x16x32_bf16 v[76:79], v[160:163], v[140:143], v[76:79]
  buffer_load_dwordx4 v17, s[32:35], s65 offen offset:3072 lds
  s_add_u32 m0, s67, 49152
  s_waitcnt lgkmcnt(7)
  v_mfma_f32_16x16x32_bf16 v[80:83], v[164:167], v[128:131], v[80:83]
  ds_read_b128 v[148:151], v5 offset:2048
  s_mov_b32 s66, 1720320
  v_mfma_f32_16x16x32_bf16 v[40:43], v[160:163], v[56:59], v[40:43]
  ds_read_b128 v[152:155], v5 offset:4096
  v_mfma_f32_16x16x32_bf16 v[84:87], v[164:167], v[132:135], v[84:87]
  ds_read_b128 v[156:159], v5 offset:6144
  v_mfma_f32_16x16x32_bf16 v[88:91], v[164:167], v[136:139], v[88:91]
  buffer_load_dwordx4 v18, s[36:39], s66 offen offset:0 lds
  v_mfma_f32_16x16x32_bf16 v[92:95], v[164:167], v[140:143], v[92:95]
  ds_read_b64_tr_b16 v[180:181], v11 offset:8192
  s_waitcnt lgkmcnt(9)
  v_mfma_f32_16x16x32_bf16 v[96:99], v[168:171], v[128:131], v[96:99]
  ds_read_b64_tr_b16 v[182:183], v11 offset:9216
  v_mfma_f32_16x16x32_bf16 v[44:47], v[164:167], v[56:59], v[44:47]
  ds_read_b64_tr_b16 v[184:185], v12 offset:8192
  v_mfma_f32_16x16x32_bf16 v[100:103], v[168:171], v[132:135], v[100:103]
  buffer_load_dwordx4 v19, s[36:39], s66 offen offset:1024 lds
  v_mfma_f32_16x16x32_bf16 v[104:107], v[168:171], v[136:139], v[104:107]
  ds_read_b64_tr_b16 v[186:187], v12 offset:9216
  v_mfma_f32_16x16x32_bf16 v[108:111], v[168:171], v[140:143], v[108:111]
  ds_read_b64_tr_b16 v[188:189], v13 offset:8192
  s_waitcnt lgkmcnt(11)
  v_mfma_f32_16x16x32_bf16 v[112:115], v[172:175], v[128:131], v[112:115]
  ds_read_b64_tr_b16 v[190:191], v13 offset:9216
  v_mfma_f32_16x16x32_bf16 v[116:119], v[172:175], v[132:135], v[116:119]
  buffer_load_dwordx4 v20, s[36:39], s66 offen offset:2048 lds
  v_mfma_f32_16x16x32_bf16 v[120:123], v[172:175], v[136:139], v[120:123]
  buffer_load_dwordx4 v21, s[36:39], s66 offen offset:3072 lds
  v_mfma_f32_16x16x32_bf16 v[124:127], v[172:175], v[140:143], v[124:127]
  s_waitcnt lgkmcnt(0)
  s_waitcnt vmcnt(16)
  s_barrier
  v_mfma_f32_16x16x32_bf16 v[64:67], v[176:179], v[144:147], v[64:67]
  ds_read_b64_tr_b16 v[160:161], v10 offset:32768
  s_add_u32 m0, s67, 65536
  v_mfma_f32_16x16x32_bf16 v[68:71], v[176:179], v[148:151], v[68:71]
  ds_read_b64_tr_b16 v[162:163], v10 offset:33792
  s_movk_i32 s65, 1024
  v_mfma_f32_16x16x32_bf16 v[72:75], v[176:179], v[152:155], v[72:75]
  ds_read_b128 v[128:131], v4 offset:32768
  v_mfma_f32_16x16x32_bf16 v[76:79], v[176:179], v[156:159], v[76:79]
  buffer_load_dwordx4 v14, s[32:35], s65 offen offset:0 lds
  v_mfma_f32_16x16x32_bf16 v[80:83], v[180:183], v[144:147], v[80:83]
  ds_read_b128 v[132:135], v4 offset:34816
  v_mfma_f32_16x16x32_bf16 v[40:43], v[176:179], v[56:59], v[40:43]
  ds_read_b128 v[136:139], v4 offset:36864
  v_mfma_f32_16x16x32_bf16 v[84:87], v[180:183], v[148:151], v[84:87]
  ds_read_b128 v[140:143], v4 offset:38912
  v_mfma_f32_16x16x32_bf16 v[88:91], v[180:183], v[152:155], v[88:91]
  buffer_load_dwordx4 v15, s[32:35], s65 offen offset:1024 lds
  v_mfma_f32_16x16x32_bf16 v[92:95], v[180:183], v[156:159], v[92:95]
  ds_read_b64_tr_b16 v[164:165], v11 offset:32768
  v_mfma_f32_16x16x32_bf16 v[96:99], v[184:187], v[144:147], v[96:99]
  ds_read_b64_tr_b16 v[166:167], v11 offset:33792
  v_mfma_f32_16x16x32_bf16 v[44:47], v[180:183], v[56:59], v[44:47]
  ds_read_b64_tr_b16 v[168:169], v12 offset:32768
  v_mfma_f32_16x16x32_bf16 v[100:103], v[184:187], v[148:151], v[100:103]
  buffer_load_dwordx4 v16, s[32:35], s65 offen offset:2048 lds
  v_mfma_f32_16x16x32_bf16 v[104:107], v[184:187], v[152:155], v[104:107]
  ds_read_b64_tr_b16 v[170:171], v12 offset:33792
  v_mfma_f32_16x16x32_bf16 v[108:111], v[184:187], v[156:159], v[108:111]
  ds_read_b64_tr_b16 v[172:173], v13 offset:32768
  v_mfma_f32_16x16x32_bf16 v[112:115], v[188:191], v[144:147], v[112:115]
  ds_read_b64_tr_b16 v[174:175], v13 offset:33792
  v_mfma_f32_16x16x32_bf16 v[116:119], v[188:191], v[148:151], v[116:119]
  buffer_load_dwordx4 v17, s[32:35], s65 offen offset:3072 lds
  s_add_u32 m0, s67, 81920
  v_mfma_f32_16x16x32_bf16 v[120:123], v[188:191], v[152:155], v[120:123]
  s_mov_b32 s66, 1966080
  v_mfma_f32_16x16x32_bf16 v[124:127], v[188:191], v[156:159], v[124:127]
  buffer_load_dwordx4 v18, s[36:39], s66 offen offset:0 lds
  s_waitcnt lgkmcnt(9)
  v_mfma_f32_16x16x32_bf16 v[64:67], v[160:163], v[128:131], v[64:67]
  ds_read_b64_tr_b16 v[176:177], v10 offset:40960
  s_waitcnt lgkmcnt(9)
  v_mfma_f32_16x16x32_bf16 v[68:71], v[160:163], v[132:135], v[68:71]
  ds_read_b64_tr_b16 v[178:179], v10 offset:41984
  s_waitcnt lgkmcnt(9)
  v_mfma_f32_16x16x32_bf16 v[72:75], v[160:163], v[136:139], v[72:75]
  ds_read_b128 v[144:147], v5 offset:32768
  s_waitcnt lgkmcnt(9)
  v_mfma_f32_16x16x32_bf16 v[76:79], v[160:163], v[140:143], v[76:79]
  buffer_load_dwordx4 v19, s[36:39], s66 offen offset:1024 lds
  s_waitcnt lgkmcnt(7)
  v_mfma_f32_16x16x32_bf16 v[80:83], v[164:167], v[128:131], v[80:83]
  ds_read_b128 v[148:151], v5 offset:34816
  v_mfma_f32_16x16x32_bf16 v[40:43], v[160:163], v[56:59], v[40:43]
  ds_read_b128 v[152:155], v5 offset:36864
  v_mfma_f32_16x16x32_bf16 v[84:87], v[164:167], v[132:135], v[84:87]
  ds_read_b128 v[156:159], v5 offset:38912
  v_mfma_f32_16x16x32_bf16 v[88:91], v[164:167], v[136:139], v[88:91]
  buffer_load_dwordx4 v20, s[36:39], s66 offen offset:2048 lds
  v_mfma_f32_16x16x32_bf16 v[92:95], v[164:167], v[140:143], v[92:95]
  ds_read_b64_tr_b16 v[180:181], v11 offset:40960
  s_waitcnt lgkmcnt(9)
  v_mfma_f32_16x16x32_bf16 v[96:99], v[168:171], v[128:131], v[96:99]
  ds_read_b64_tr_b16 v[182:183], v11 offset:41984
  v_mfma_f32_16x16x32_bf16 v[44:47], v[164:167], v[56:59], v[44:47]
  ds_read_b64_tr_b16 v[184:185], v12 offset:40960
  v_mfma_f32_16x16x32_bf16 v[100:103], v[168:171], v[132:135], v[100:103]
  buffer_load_dwordx4 v21, s[36:39], s66 offen offset:3072 lds
  v_mfma_f32_16x16x32_bf16 v[104:107], v[168:171], v[136:139], v[104:107]
  ds_read_b64_tr_b16 v[186:187], v12 offset:41984
  v_mfma_f32_16x16x32_bf16 v[108:111], v[168:171], v[140:143], v[108:111]
  ds_read_b64_tr_b16 v[188:189], v13 offset:40960
  s_waitcnt lgkmcnt(11)
  v_mfma_f32_16x16x32_bf16 v[112:115], v[172:175], v[128:131], v[112:115]
  ds_read_b64_tr_b16 v[190:191], v13 offset:41984
  v_mfma_f32_16x16x32_bf16 v[116:119], v[172:175], v[132:135], v[116:119]
  v_mfma_f32_16x16x32_bf16 v[120:123], v[172:175], v[136:139], v[120:123]
  v_mfma_f32_16x16x32_bf16 v[124:127], v[172:175], v[140:143], v[124:127]
  s_waitcnt lgkmcnt(0)
  s_waitcnt vmcnt(16)
  s_barrier
  v_mfma_f32_16x16x32_bf16 v[64:67], v[176:179], v[144:147], v[64:67]
  ds_read_b64_tr_b16 v[160:161], v6 offset:0
  s_add_u32 m0, s67, 98304
  v_mfma_f32_16x16x32_bf16 v[68:71], v[176:179], v[148:151], v[68:71]
  ds_read_b64_tr_b16 v[162:163], v6 offset:1024
  s_movk_i32 s65, 1152
  v_mfma_f32_16x16x32_bf16 v[72:75], v[176:179], v[152:155], v[72:75]
  ds_read_b128 v[128:131], v2 offset:0
  v_mfma_f32_16x16x32_bf16 v[76:79], v[176:179], v[156:159], v[76:79]
  buffer_load_dwordx4 v14, s[32:35], s65 offen offset:0 lds
  v_mfma_f32_16x16x32_bf16 v[80:83], v[180:183], v[144:147], v[80:83]
  ds_read_b128 v[132:135], v2 offset:2048
  v_mfma_f32_16x16x32_bf16 v[40:43], v[176:179], v[56:59], v[40:43]
  ds_read_b128 v[136:139], v2 offset:4096
  v_mfma_f32_16x16x32_bf16 v[84:87], v[180:183], v[148:151], v[84:87]
  ds_read_b128 v[140:143], v2 offset:6144
  v_mfma_f32_16x16x32_bf16 v[88:91], v[180:183], v[152:155], v[88:91]
  buffer_load_dwordx4 v15, s[32:35], s65 offen offset:1024 lds
  v_mfma_f32_16x16x32_bf16 v[92:95], v[180:183], v[156:159], v[92:95]
  ds_read_b64_tr_b16 v[164:165], v7 offset:0
  v_mfma_f32_16x16x32_bf16 v[96:99], v[184:187], v[144:147], v[96:99]
  ds_read_b64_tr_b16 v[166:167], v7 offset:1024
  v_mfma_f32_16x16x32_bf16 v[44:47], v[180:183], v[56:59], v[44:47]
  ds_read_b64_tr_b16 v[168:169], v8 offset:0
  v_mfma_f32_16x16x32_bf16 v[100:103], v[184:187], v[148:151], v[100:103]
  buffer_load_dwordx4 v16, s[32:35], s65 offen offset:2048 lds
  v_mfma_f32_16x16x32_bf16 v[104:107], v[184:187], v[152:155], v[104:107]
  ds_read_b64_tr_b16 v[170:171], v8 offset:1024
  v_mfma_f32_16x16x32_bf16 v[108:111], v[184:187], v[156:159], v[108:111]
  ds_read_b64_tr_b16 v[172:173], v9 offset:0
  v_mfma_f32_16x16x32_bf16 v[112:115], v[188:191], v[144:147], v[112:115]
  ds_read_b64_tr_b16 v[174:175], v9 offset:1024
  v_mfma_f32_16x16x32_bf16 v[116:119], v[188:191], v[148:151], v[116:119]
  buffer_load_dwordx4 v17, s[32:35], s65 offen offset:3072 lds
  s_add_u32 m0, s67, 114688
  v_mfma_f32_16x16x32_bf16 v[120:123], v[188:191], v[152:155], v[120:123]
  s_mov_b32 s66, 2211840
  v_mfma_f32_16x16x32_bf16 v[124:127], v[188:191], v[156:159], v[124:127]
  buffer_load_dwordx4 v18, s[36:39], s66 offen offset:0 lds
  s_waitcnt lgkmcnt(9)
  v_mfma_f32_16x16x32_bf16 v[64:67], v[160:163], v[128:131], v[64:67]
  ds_read_b64_tr_b16 v[176:177], v6 offset:8192
  s_waitcnt lgkmcnt(9)
  v_mfma_f32_16x16x32_bf16 v[68:71], v[160:163], v[132:135], v[68:71]
  ds_read_b64_tr_b16 v[178:179], v6 offset:9216
  s_waitcnt lgkmcnt(9)
  v_mfma_f32_16x16x32_bf16 v[72:75], v[160:163], v[136:139], v[72:75]
  ds_read_b128 v[144:147], v3 offset:0
  s_waitcnt lgkmcnt(9)
  v_mfma_f32_16x16x32_bf16 v[76:79], v[160:163], v[140:143], v[76:79]
  buffer_load_dwordx4 v19, s[36:39], s66 offen offset:1024 lds
  s_waitcnt lgkmcnt(7)
  v_mfma_f32_16x16x32_bf16 v[80:83], v[164:167], v[128:131], v[80:83]
  ds_read_b128 v[148:151], v3 offset:2048
  v_mfma_f32_16x16x32_bf16 v[40:43], v[160:163], v[56:59], v[40:43]
  ds_read_b128 v[152:155], v3 offset:4096
  v_mfma_f32_16x16x32_bf16 v[84:87], v[164:167], v[132:135], v[84:87]
  ds_read_b128 v[156:159], v3 offset:6144
  v_mfma_f32_16x16x32_bf16 v[88:91], v[164:167], v[136:139], v[88:91]
  buffer_load_dwordx4 v20, s[36:39], s66 offen offset:2048 lds
  v_mfma_f32_16x16x32_bf16 v[92:95], v[164:167], v[140:143], v[92:95]
  ds_read_b64_tr_b16 v[180:181], v7 offset:8192
  s_waitcnt lgkmcnt(9)
  v_mfma_f32_16x16x32_bf16 v[96:99], v[168:171], v[128:131], v[96:99]
  ds_read_b64_tr_b16 v[182:183], v7 offset:9216
  v_mfma_f32_16x16x32_bf16 v[44:47], v[164:167], v[56:59], v[44:47]
  ds_read_b64_tr_b16 v[184:185], v8 offset:8192
  v_mfma_f32_16x16x32_bf16 v[100:103], v[168:171], v[132:135], v[100:103]
  buffer_load_dwordx4 v21, s[36:39], s66 offen offset:3072 lds
  v_mfma_f32_16x16x32_bf16 v[104:107], v[168:171], v[136:139], v[104:107]
  ds_read_b64_tr_b16 v[186:187], v8 offset:9216
  v_mfma_f32_16x16x32_bf16 v[108:111], v[168:171], v[140:143], v[108:111]
  ds_read_b64_tr_b16 v[188:189], v9 offset:8192
  s_waitcnt lgkmcnt(11)
  v_mfma_f32_16x16x32_bf16 v[112:115], v[172:175], v[128:131], v[112:115]
  ds_read_b64_tr_b16 v[190:191], v9 offset:9216
  v_mfma_f32_16x16x32_bf16 v[116:119], v[172:175], v[132:135], v[116:119]
  v_mfma_f32_16x16x32_bf16 v[120:123], v[172:175], v[136:139], v[120:123]
  v_mfma_f32_16x16x32_bf16 v[124:127], v[172:175], v[140:143], v[124:127]
  s_waitcnt lgkmcnt(0)
  s_waitcnt vmcnt(16)
  s_barrier
  v_mfma_f32_16x16x32_bf16 v[64:67], v[176:179], v[144:147], v[64:67]
  ds_read_b64_tr_b16 v[160:161], v6 offset:32768
  v_mfma_f32_16x16x32_bf16 v[68:71], v[176:179], v[148:151], v[68:71]
  ds_read_b64_tr_b16 v[162:163], v6 offset:33792
  v_mfma_f32_16x16x32_bf16 v[72:75], v[176:179], v[152:155], v[72:75]
  ds_read_b128 v[128:131], v2 offset:32768
  v_mfma_f32_16x16x32_bf16 v[76:79], v[176:179], v[156:159], v[76:79]
  v_mfma_f32_16x16x32_bf16 v[80:83], v[180:183], v[144:147], v[80:83]
  ds_read_b128 v[132:135], v2 offset:34816
  v_mfma_f32_16x16x32_bf16 v[40:43], v[176:179], v[56:59], v[40:43]
  ds_read_b128 v[136:139], v2 offset:36864
  v_mfma_f32_16x16x32_bf16 v[84:87], v[180:183], v[148:151], v[84:87]
  ds_read_b128 v[140:143], v2 offset:38912
  v_mfma_f32_16x16x32_bf16 v[88:91], v[180:183], v[152:155], v[88:91]
  v_mfma_f32_16x16x32_bf16 v[92:95], v[180:183], v[156:159], v[92:95]
  ds_read_b64_tr_b16 v[164:165], v7 offset:32768
  v_mfma_f32_16x16x32_bf16 v[96:99], v[184:187], v[144:147], v[96:99]
  ds_read_b64_tr_b16 v[166:167], v7 offset:33792
  v_mfma_f32_16x16x32_bf16 v[44:47], v[180:183], v[56:59], v[44:47]
  ds_read_b64_tr_b16 v[168:169], v8 offset:32768
  v_mfma_f32_16x16x32_bf16 v[100:103], v[184:187], v[148:151], v[100:103]
  v_mfma_f32_16x16x32_bf16 v[104:107], v[184:187], v[152:155], v[104:107]
  ds_read_b64_tr_b16 v[170:171], v8 offset:33792
  v_mfma_f32_16x16x32_bf16 v[108:111], v[184:187], v[156:159], v[108:111]
  ds_read_b64_tr_b16 v[172:173], v9 offset:32768
  v_mfma_f32_16x16x32_bf16 v[112:115], v[188:191], v[144:147], v[112:115]
  ds_read_b64_tr_b16 v[174:175], v9 offset:33792
  v_mfma_f32_16x16x32_bf16 v[116:119], v[188:191], v[148:151], v[116:119]
  v_mfma_f32_16x16x32_bf16 v[120:123], v[188:191], v[152:155], v[120:123]
  v_mfma_f32_16x16x32_bf16 v[124:127], v[188:191], v[156:159], v[124:127]
  buffer_load_dwordx4 v[36:39], v28, s[28:31], 0 offen sc1
  s_lshl2_add_u32 s17, s60, s58
  v_min_u32 v61, 6, v1
  s_mul_i32 s17, s17, 896
  v_lshlrev_b32 v61, 7, v61
  buffer_load_dword v61, v61, s[40:43], s17 offen
  s_mul_i32 s17, s12, 44
  v_min_u32 v60, 43, v1
  s_add_u32 s17, s17, 0
  v_add_u32 v60, s17, v60
  v_mul_u32_u24 v60, 3456, v60
  buffer_load_dword v60, v60, s[44:47], s6 offen
  s_waitcnt lgkmcnt(9)
  v_mfma_f32_16x16x32_bf16 v[64:67], v[160:163], v[128:131], v[64:67]
  ds_read_b64_tr_b16 v[176:177], v6 offset:40960
  s_waitcnt lgkmcnt(9)
  v_mfma_f32_16x16x32_bf16 v[68:71], v[160:163], v[132:135], v[68:71]
  ds_read_b64_tr_b16 v[178:179], v6 offset:41984
  s_waitcnt lgkmcnt(9)
  v_mfma_f32_16x16x32_bf16 v[72:75], v[160:163], v[136:139], v[72:75]
  ds_read_b128 v[144:147], v3 offset:32768
  s_waitcnt lgkmcnt(9)
  v_mfma_f32_16x16x32_bf16 v[76:79], v[160:163], v[140:143], v[76:79]
  s_waitcnt lgkmcnt(7)
  v_mfma_f32_16x16x32_bf16 v[80:83], v[164:167], v[128:131], v[80:83]
  ds_read_b128 v[148:151], v3 offset:34816
  v_mfma_f32_16x16x32_bf16 v[40:43], v[160:163], v[56:59], v[40:43]
  ds_read_b128 v[152:155], v3 offset:36864
  v_mfma_f32_16x16x32_bf16 v[84:87], v[164:167], v[132:135], v[84:87]
  ds_read_b128 v[156:159], v3 offset:38912
  v_mfma_f32_16x16x32_bf16 v[88:91], v[164:167], v[136:139], v[88:91]
  v_mfma_f32_16x16x32_bf16 v[92:95], v[164:167], v[140:143], v[92:95]
  ds_read_b64_tr_b16 v[180:181], v7 offset:40960
  s_waitcnt lgkmcnt(9)
  v_mfma_f32_16x16x32_bf16 v[96:99], v[168:171], v[128:131], v[96:99]
  ds_read_b64_tr_b16 v[182:183], v7 offset:41984
  v_mfma_f32_16x16x32_bf16 v[44:47], v[164:167], v[56:59], v[44:47]
  ds_read_b64_tr_b16 v[184:185], v8 offset:40960
  v_mfma_f32_16x16x32_bf16 v[100:103], v[168:171], v[132:135], v[100:103]
  v_mfma_f32_16x16x32_bf16 v[104:107], v[168:171], v[136:139], v[104:107]
  ds_read_b64_tr_b16 v[186:187], v8 offset:41984
  v_mfma_f32_16x16x32_bf16 v[108:111], v[168:171], v[140:143], v[108:111]
  ds_read_b64_tr_b16 v[188:189], v9 offset:40960
  s_waitcnt lgkmcnt(11)
  v_mfma_f32_16x16x32_bf16 v[112:115], v[172:175], v[128:131], v[112:115]
  ds_read_b64_tr_b16 v[190:191], v9 offset:41984
  v_mfma_f32_16x16x32_bf16 v[116:119], v[172:175], v[132:135], v[116:119]
  v_mfma_f32_16x16x32_bf16 v[120:123], v[172:175], v[136:139], v[120:123]
  v_mfma_f32_16x16x32_bf16 v[124:127], v[172:175], v[140:143], v[124:127]
  s_waitcnt lgkmcnt(0)
  s_waitcnt vmcnt(11)
  s_barrier
  v_mfma_f32_16x16x32_bf16 v[64:67], v[176:179], v[144:147], v[64:67]
  ds_read_b64_tr_b16 v[160:161], v10 offset:0
  v_mfma_f32_16x16x32_bf16 v[68:71], v[176:179], v[148:151], v[68:71]
  ds_read_b64_tr_b16 v[162:163], v10 offset:1024
  v_mfma_f32_16x16x32_bf16 v[72:75], v[176:179], v[152:155], v[72:75]
  ds_read_b128 v[128:131], v4 offset:0
  v_mfma_f32_16x16x32_bf16 v[76:79], v[176:179], v[156:159], v[76:79]
  v_mfma_f32_16x16x32_bf16 v[80:83], v[180:183], v[144:147], v[80:83]
  ds_read_b128 v[132:135], v4 offset:2048
  v_mfma_f32_16x16x32_bf16 v[40:43], v[176:179], v[56:59], v[40:43]
  ds_read_b128 v[136:139], v4 offset:4096
  v_mfma_f32_16x16x32_bf16 v[84:87], v[180:183], v[148:151], v[84:87]
  ds_read_b128 v[140:143], v4 offset:6144
  v_mfma_f32_16x16x32_bf16 v[88:91], v[180:183], v[152:155], v[88:91]
  v_mfma_f32_16x16x32_bf16 v[92:95], v[180:183], v[156:159], v[92:95]
  ds_read_b64_tr_b16 v[164:165], v11 offset:0
  v_mfma_f32_16x16x32_bf16 v[96:99], v[184:187], v[144:147], v[96:99]
  ds_read_b64_tr_b16 v[166:167], v11 offset:1024
  v_mfma_f32_16x16x32_bf16 v[44:47], v[180:183], v[56:59], v[44:47]
  ds_read_b64_tr_b16 v[168:169], v12 offset:0
  v_mfma_f32_16x16x32_bf16 v[100:103], v[184:187], v[148:151], v[100:103]
  v_mfma_f32_16x16x32_bf16 v[104:107], v[184:187], v[152:155], v[104:107]
  ds_read_b64_tr_b16 v[170:171], v12 offset:1024
  v_mfma_f32_16x16x32_bf16 v[108:111], v[184:187], v[156:159], v[108:111]
  ds_read_b64_tr_b16 v[172:173], v13 offset:0
  v_mfma_f32_16x16x32_bf16 v[112:115], v[188:191], v[144:147], v[112:115]
  ds_read_b64_tr_b16 v[174:175], v13 offset:1024
  v_mfma_f32_16x16x32_bf16 v[116:119], v[188:191], v[148:151], v[116:119]
  v_mfma_f32_16x16x32_bf16 v[120:123], v[188:191], v[152:155], v[120:123]
  v_mfma_f32_16x16x32_bf16 v[124:127], v[188:191], v[156:159], v[124:127]
  s_waitcnt vmcnt(2)
  v_cmp_ne_u32 vcc, s59, v38
  s_cbranch_vccz Ld2
Lp1:
  buffer_load_dwordx4 v[36:39], v28, s[28:31], 0 offen sc1
  s_waitcnt vmcnt(0) lgkmcnt(0)
  v_cmp_ne_u32 vcc, s59, v38
  s_cbranch_vccz Ld2
  s_sub_u32 s61, s61, 1
  s_cbranch_scc0 Lp1
  s_branch Lexit
Ld2:
  v_mul_f32 v36, s68, v36
  ds_write2_b32 v29, v36, v37 offset1:128
  s_waitcnt lgkmcnt(10)
  v_mfma_f32_16x16x32_bf16 v[64:67], v[160:163], v[128:131], v[64:67]
  ds_read_b64_tr_b16 v[176:177], v10 offset:8192
  s_waitcnt lgkmcnt(10)
  v_mfma_f32_16x16x32_bf16 v[68:71], v[160:163], v[132:135], v[68:71]
  ds_read_b64_tr_b16 v[178:179], v10 offset:9216
  s_waitcnt lgkmcnt(10)
  v_mfma_f32_16x16x32_bf16 v[72:75], v[160:163], v[136:139], v[72:75]
  ds_read_b128 v[144:147], v5 offset:0
  s_waitcnt lgkmcnt(10)
  v_mfma_f32_16x16x32_bf16 v[76:79], v[160:163], v[140:143], v[76:79]
  s_waitcnt lgkmcnt(8)
  v_mfma_f32_16x16x32_bf16 v[80:83], v[164:167], v[128:131], v[80:83]
  ds_read_b128 v[148:151], v5 offset:2048
  v_mfma_f32_16x16x32_bf16 v[40:43], v[160:163], v[56:59], v[40:43]
  ds_read_b128 v[152:155], v5 offset:4096
  v_mfma_f32_16x16x32_bf16 v[84:87], v[164:167], v[132:135], v[84:87]
  ds_read_b128 v[156:159], v5 offset:6144
  v_mfma_f32_16x16x32_bf16 v[88:91], v[164:167], v[136:139], v[88:91]
  v_mfma_f32_16x16x32_bf16 v[92:95], v[164:167], v[140:143], v[92:95]
  ds_read_b64_tr_b16 v[180:181], v11 offset:8192
  s_waitcnt lgkmcnt(10)
  v_mfma_f32_16x16x32_bf16 v[96:99], v[168:171], v[128:131], v[96:99]
  ds_read_b64_tr_b16 v[182:183], v11 offset:9216
  v_mfma_f32_16x16x32_bf16 v[44:47], v[164:167], v[56:59], v[44:47]
  ds_read_b64_tr_b16 v[184:185], v12 offset:8192
  v_mfma_f32_16x16x32_bf16 v[100:103], v[168:171], v[132:135], v[100:103]
  v_mfma_f32_16x16x32_bf16 v[104:107], v[168:171], v[136:139], v[104:107]
  ds_read_b64_tr_b16 v[186:187], v12 offset:9216
  ds_write_b128 v30, v[40:43] offset:0
  v_mfma_f32_16x16x32_bf16 v[108:111], v[168:171], v[140:143], v[108:111]
  ds_read_b64_tr_b16 v[188:189], v13 offset:8192
  s_waitcnt lgkmcnt(13)
  v_mfma_f32_16x16x32_bf16 v[112:115], v[172:175], v[128:131], v[112:115]
  ds_read_b64_tr_b16 v[190:191], v13 offset:9216
  ds_write_b128 v30, v[44:47] offset:1024
  v_mfma_f32_16x16x32_bf16 v[116:119], v[172:175], v[132:135], v[116:119]
  v_mfma_f32_16x16x32_bf16 v[120:123], v[172:175], v[136:139], v[120:123]
  v_mfma_f32_16x16x32_bf16 v[124:127], v[172:175], v[140:143], v[124:127]
  s_waitcnt lgkmcnt(0)
  s_barrier
  v_mfma_f32_16x16x32_bf16 v[64:67], v[176:179], v[144:147], v[64:67]
  ds_read_b128 v[48:51], v32 offset:0
  ds_read_b128 v[52:55], v32 offset:1024
  v_mfma_f32_16x16x32_bf16 v[68:71], v[176:179], v[148:151], v[68:71]
  ds_read_b64_tr_b16 v[160:161], v10 offset:32768
  ds_read_b64_tr_b16 v[162:163], v10 offset:33792
  v_mfma_f32_16x16x32_bf16 v[72:75], v[176:179], v[152:155], v[72:75]
  ds_read_b64_tr_b16 v[164:165], v11 offset:32768
  ds_read_b64_tr_b16 v[166:167], v11 offset:33792
  v_mfma_f32_16x16x32_bf16 v[76:79], v[176:179], v[156:159], v[76:79]
  ds_read_b64_tr_b16 v[168:169], v12 offset:32768
  ds_read_b64_tr_b16 v[170:171], v12 offset:33792
  v_mfma_f32_16x16x32_bf16 v[80:83], v[180:183], v[144:147], v[80:83]
  ds_read_b64_tr_b16 v[172:173], v13 offset:32768
  ds_read_b64_tr_b16 v[174:175], v13 offset:33792
  v_mfma_f32_16x16x32_bf16 v[84:87], v[180:183], v[148:151], v[84:87]
  ds_read_b64_tr_b16 v[208:209], v10 offset:40960
  ds_read_b64_tr_b16 v[210:211], v10 offset:41984
  v_mfma_f32_16x16x32_bf16 v[88:91], v[180:183], v[152:155], v[88:91]
  ds_read_b64_tr_b16 v[212:213], v11 offset:40960
  ds_read_b64_tr_b16 v[214:215], v11 offset:41984
  v_mfma_f32_16x16x32_bf16 v[92:95], v[180:183], v[156:159], v[92:95]
  ds_read_b64_tr_b16 v[216:217], v12 offset:40960
  ds_read_b64_tr_b16 v[218:219], v12 offset:41984
  v_mfma_f32_16x16x32_bf16 v[40:43], v[176:179], v[56:59], v[40:43]
  ds_read_b64_tr_b16 v[220:221], v13 offset:40960
  ds_read_b64_tr_b16 v[222:223], v13 offset:41984
  v_mfma_f32_16x16x32_bf16 v[44:47], v[180:183], v[56:59], v[44:47]
  ds_read2_b32 v[224:225], v33 offset0:0 offset1:128
  ds_read2_b32 v[226:227], v33 offset0:16 offset1:144
  s_waitcnt lgkmcnt(15)
  v_mfma_f32_16x16x32_bf16 v[48:51], v[184:187], v[56:59], v[48:51]
  ds_read2_b32 v[228:229], v33 offset0:32 offset1:160
  ds_read2_b32 v[230:231], v33 offset0:48 offset1:176
  v_mfma_f32_16x16x32_bf16 v[52:55], v[188:191], v[56:59], v[52:55]
  ds_read_b128 v[128:131], v4 offset:32768
  v_mfma_f32_16x16x32_bf16 v[40:43], v[160:163], v[56:59], v[40:43]
  ds_read_b128 v[192:195], v5 offset:32768
  s_waitcnt lgkmcnt(15)
  v_mfma_f32_16x16x32_bf16 v[44:47], v[164:167], v[56:59], v[44:47]
  ds_read_b128 v[132:135], v4 offset:34816
  v_mfma_f32_16x16x32_bf16 v[48:51], v[168:171], v[56:59], v[48:51]
  ds_read_b128 v[196:199], v5 offset:34816
  s_waitcnt lgkmcnt(15)
  v_mfma_f32_16x16x32_bf16 v[52:55], v[172:175], v[56:59], v[52:55]
  ds_read_b128 v[136:139], v4 offset:36864
  s_waitcnt lgkmcnt(15)
  v_mfma_f32_16x16x32_bf16 v[40:43], v[208:211], v[56:59], v[40:43]
  ds_read_b128 v[200:203], v5 offset:36864
  s_waitcnt lgkmcnt(14)
  v_mfma_f32_16x16x32_bf16 v[44:47], v[212:215], v[56:59], v[44:47]
  ds_read_b128 v[140:143], v4 offset:38912
  s_waitcnt lgkmcnt(13)
  v_mfma_f32_16x16x32_bf16 v[48:51], v[216:219], v[56:59], v[48:51]
  ds_read_b128 v[204:207], v5 offset:38912
  s_waitcnt lgkmcnt(12)
  v_mfma_f32_16x16x32_bf16 v[52:55], v[220:223], v[56:59], v[52:55]
  v_mfma_f32_16x16x32_bf16 v[96:99], v[184:187], v[144:147], v[96:99]
  s_waitcnt lgkmcnt(11)
  v_fmac_f32 v64, v40, v225
  v_fmac_f32 v65, v41, v225
  v_fmac_f32 v66, v42, v225
  v_fmac_f32 v67, v43, v225
  v_mfma_f32_16x16x32_bf16 v[100:103], v[184:187], v[148:151], v[100:103]
  s_waitcnt lgkmcnt(10)
  v_fmac_f32 v68, v40, v227
  v_fmac_f32 v69, v41, v227
  v_fmac_f32 v70, v42, v227
  v_fmac_f32 v71, v43, v227
  v_mfma_f32_16x16x32_bf16 v[104:107], v[184:187], v[152:155], v[104:107]
  s_waitcnt lgkmcnt(9)
  v_fmac_f32 v72, v40, v229
  v_fmac_f32 v73, v41, v229
  v_fmac_f32 v74, v42, v229
  v_fmac_f32 v75, v43, v229
  v_mfma_f32_16x16x32_bf16 v[108:111], v[184:187], v[156:159], v[108:111]
  s_waitcnt lgkmcnt(8)
  v_fmac_f32 v76, v40, v231
  v_fmac_f32 v77, v41, v231
  v_fmac_f32 v78, v42, v231
  v_fmac_f32 v79, v43, v231
  v_mfma_f32_16x16x32_bf16 v[112:115], v[188:191], v[144:147], v[112:115]
  v_fmac_f32 v80, v44, v225
  v_fmac_f32 v81, v45, v225
  v_fmac_f32 v82, v46, v225
  v_fmac_f32 v83, v47, v225
  v_mfma_f32_16x16x32_bf16 v[116:119], v[188:191], v[148:151], v[116:119]
  v_fmac_f32 v84, v44, v227
  v_fmac_f32 v85, v45, v227
  v_fmac_f32 v86, v46, v227
  v_fmac_f32 v87, v47, v227
  v_mfma_f32_16x16x32_bf16 v[120:123], v[188:191], v[152:155], v[120:123]
  v_fmac_f32 v88, v44, v229
  v_fmac_f32 v89, v45, v229
  v_fmac_f32 v90, v46, v229
  v_fmac_f32 v91, v47, v229
  v_mfma_f32_16x16x32_bf16 v[124:127], v[188:191], v[156:159], v[124:127]
  v_fmac_f32 v92, v44, v231
  v_fmac_f32 v93, v45, v231
  v_fmac_f32 v94, v46, v231
  v_fmac_f32 v95, v47, v231
  s_waitcnt lgkmcnt(7)
  v_mfma_f32_16x16x32_bf16 v[64:67], v[160:163], v[128:131], v[64:67]
  s_waitcnt lgkmcnt(5)
  v_mfma_f32_16x16x32_bf16 v[68:71], v[160:163], v[132:135], v[68:71]
  v_fmac_f32 v96, v48, v225
  v_fmac_f32 v97, v49, v225
  v_fmac_f32 v98, v50, v225
  v_fmac_f32 v99, v51, v225
  v_mfma_f32_16x16x32_bf16 v[64:67], v[208:211], v[192:195], v[64:67]
  v_fmac_f32 v100, v48, v227
  v_fmac_f32 v101, v49, v227
  v_fmac_f32 v102, v50, v227
  v_fmac_f32 v103, v51, v227
  s_waitcnt lgkmcnt(4)
  v_mfma_f32_16x16x32_bf16 v[68:71], v[208:211], v[196:199], v[68:71]
  v_fmac_f32 v104, v48, v229
  v_fmac_f32 v105, v49, v229
  v_fmac_f32 v106, v50, v229
  v_fmac_f32 v107, v51, v229
  s_waitcnt lgkmcnt(3)
  v_mfma_f32_16x16x32_bf16 v[72:75], v[160:163], v[136:139], v[72:75]
  v_fmac_f32 v108, v48, v231
  v_fmac_f32 v109, v49, v231
  v_fmac_f32 v110, v50, v231
  v_fmac_f32 v111, v51, v231
  s_waitcnt lgkmcnt(1)
  v_mfma_f32_16x16x32_bf16 v[76:79], v[160:163], v[140:143], v[76:79]
  v_fmac_f32 v112, v52, v225
  v_fmac_f32 v113, v53, v225
  v_fmac_f32 v114, v54, v225
  v_fmac_f32 v115, v55, v225
  v_mfma_f32_16x16x32_bf16 v[72:75], v[208:211], v[200:203], v[72:75]
  v_fmac_f32 v116, v52, v227
  v_fmac_f32 v117, v53, v227
  v_fmac_f32 v118, v54, v227
  v_fmac_f32 v119, v55, v227
  s_waitcnt lgkmcnt(0)
  v_mfma_f32_16x16x32_bf16 v[76:79], v[208:211], v[204:207], v[76:79]
  v_mul_f32 v64, v64, v224
  v_mul_f32 v65, v65, v224
  v_mul_f32 v68, v68, v226
  v_mul_f32 v69, v69, v226
  v_mfma_f32_16x16x32_bf16 v[80:83], v[164:167], v[128:131], v[80:83]
  v_mul_f32 v66, v66, v224
  v_mul_f32 v67, v67, v224
  v_cvt_pk_bf16_f32 v64, v64, v65
  v_mul_f32 v70, v70, v226
  v_mfma_f32_16x16x32_bf16 v[84:87], v[164:167], v[132:135], v[84:87]
  v_mul_f32 v71, v71, v226
  v_cvt_pk_bf16_f32 v65, v66, v67
  v_cvt_pk_bf16_f32 v66, v68, v69
  v_cvt_pk_bf16_f32 v67, v70, v71
  v_mfma_f32_16x16x32_bf16 v[80:83], v[212:215], v[192:195], v[80:83]
  v_permlane16_swap_b32 v64, v66
  v_permlane16_swap_b32 v65, v67
  buffer_store_dwordx4 v[64:67], v31, s[28:31], s72 offen offset:0 sc1
  v_fmac_f32 v120, v52, v229
  v_mfma_f32_16x16x32_bf16 v[84:87], v[212:215], v[196:199], v[84:87]
  v_fmac_f32 v121, v53, v229
  v_fmac_f32 v122, v54, v229
  v_fmac_f32 v123, v55, v229
  v_fmac_f32 v124, v52, v231
  v_mfma_f32_16x16x32_bf16 v[88:91], v[164:167], v[136:139], v[88:91]
  v_fmac_f32 v125, v53, v231
  v_fmac_f32 v126, v54, v231
  v_fmac_f32 v127, v55, v231
  v_mul_f32 v72, v72, v228
  v_mfma_f32_16x16x32_bf16 v[92:95], v[164:167], v[140:143], v[92:95]
  v_mul_f32 v73, v73, v228
  v_mul_f32 v76, v76, v230
  v_mul_f32 v77, v77, v230
  v_mul_f32 v74, v74, v228
  v_mfma_f32_16x16x32_bf16 v[88:91], v[212:215], v[200:203], v[88:91]
  v_mul_f32 v75, v75, v228
  v_cvt_pk_bf16_f32 v72, v72, v73
  v_mul_f32 v78, v78, v230
  v_mul_f32 v79, v79, v230
  v_mfma_f32_16x16x32_bf16 v[92:95], v[212:215], v[204:207], v[92:95]
  v_cvt_pk_bf16_f32 v73, v74, v75
  v_cvt_pk_bf16_f32 v74, v76, v77
  v_cvt_pk_bf16_f32 v75, v78, v79
  s_nop 0
  v_permlane16_swap_b32 v72, v74
  v_mfma_f32_16x16x32_bf16 v[96:99], v[168:171], v[128:131], v[96:99]
  v_permlane16_swap_b32 v73, v75
  buffer_store_dwordx4 v[72:75], v31, s[28:31], s72 offen offset:512 sc1
  v_mul_f32 v80, v80, v224
  v_mul_f32 v81, v81, v224
  v_mfma_f32_16x16x32_bf16 v[100:103], v[168:171], v[132:135], v[100:103]
  v_mul_f32 v84, v84, v226
  v_mul_f32 v85, v85, v226
  v_mul_f32 v82, v82, v224
  v_mul_f32 v83, v83, v224
  v_mfma_f32_16x16x32_bf16 v[96:99], v[216:219], v[192:195], v[96:99]
  v_cvt_pk_bf16_f32 v80, v80, v81
  v_mul_f32 v86, v86, v226
  v_mul_f32 v87, v87, v226
  v_cvt_pk_bf16_f32 v81, v82, v83
  v_mfma_f32_16x16x32_bf16 v[100:103], v[216:219], v[196:199], v[100:103]
  v_cvt_pk_bf16_f32 v82, v84, v85
  v_cvt_pk_bf16_f32 v83, v86, v87
  s_nop 0
  v_permlane16_swap_b32 v80, v82
  v_permlane16_swap_b32 v81, v83
  v_mfma_f32_16x16x32_bf16 v[104:107], v[168:171], v[136:139], v[104:107]
  buffer_store_dwordx4 v[80:83], v31, s[28:31], s73 offen offset:0 sc1
  v_mul_f32 v88, v88, v228
  v_mul_f32 v89, v89, v228
  v_mul_f32 v92, v92, v230
  v_mfma_f32_16x16x32_bf16 v[108:111], v[168:171], v[140:143], v[108:111]
  v_mul_f32 v93, v93, v230
  v_mul_f32 v90, v90, v228
  v_mul_f32 v91, v91, v228
  v_cvt_pk_bf16_f32 v88, v88, v89
  v_mfma_f32_16x16x32_bf16 v[104:107], v[216:219], v[200:203], v[104:107]
  v_mul_f32 v94, v94, v230
  v_mul_f32 v95, v95, v230
  v_cvt_pk_bf16_f32 v89, v90, v91
  v_cvt_pk_bf16_f32 v90, v92, v93
  v_mfma_f32_16x16x32_bf16 v[108:111], v[216:219], v[204:207], v[108:111]
  v_cvt_pk_bf16_f32 v91, v94, v95
  v_permlane16_swap_b32 v88, v90
  s_nop 0
  v_permlane16_swap_b32 v89, v91
  buffer_store_dwordx4 v[88:91], v31, s[28:31], s73 offen offset:512 sc1
  v_mfma_f32_16x16x32_bf16 v[112:115], v[172:175], v[128:131], v[112:115]
  v_mul_f32 v96, v96, v224
  v_mul_f32 v97, v97, v224
  v_mul_f32 v100, v100, v226
  v_mul_f32 v101, v101, v226
  v_mfma_f32_16x16x32_bf16 v[116:119], v[172:175], v[132:135], v[116:119]
  v_mul_f32 v98, v98, v224
  v_mul_f32 v99, v99, v224
  v_cvt_pk_bf16_f32 v96, v96, v97
  v_mul_f32 v102, v102, v226
  v_mfma_f32_16x16x32_bf16 v[112:115], v[220:223], v[192:195], v[112:115]
  v_mul_f32 v103, v103, v226
  v_cvt_pk_bf16_f32 v97, v98, v99
  v_cvt_pk_bf16_f32 v98, v100, v101
  v_cvt_pk_bf16_f32 v99, v102, v103
  v_mfma_f32_16x16x32_bf16 v[116:119], v[220:223], v[196:199], v[116:119]
  v_permlane16_swap_b32 v96, v98
  v_permlane16_swap_b32 v97, v99
  buffer_store_dwordx4 v[96:99], v31, s[28:31], s74 offen offset:0 sc1
  v_mul_f32 v104, v104, v228
  v_mfma_f32_16x16x32_bf16 v[120:123], v[172:175], v[136:139], v[120:123]
  v_mul_f32 v105, v105, v228
  v_mul_f32 v108, v108, v230
  v_mul_f32 v109, v109, v230
  v_mul_f32 v106, v106, v228
  v_mfma_f32_16x16x32_bf16 v[124:127], v[172:175], v[140:143], v[124:127]
  v_mul_f32 v107, v107, v228
  v_cvt_pk_bf16_f32 v104, v104, v105
  v_mul_f32 v110, v110, v230
  v_mul_f32 v111, v111, v230
  v_mfma_f32_16x16x32_bf16 v[120:123], v[220:223], v[200:203], v[120:123]
  v_cvt_pk_bf16_f32 v105, v106, v107
  v_cvt_pk_bf16_f32 v106, v108, v109
  v_cvt_pk_bf16_f32 v107, v110, v111
  s_nop 0
  v_permlane16_swap_b32 v104, v106
  v_mfma_f32_16x16x32_bf16 v[124:127], v[220:223], v[204:207], v[124:127]
  v_permlane16_swap_b32 v105, v107
  buffer_store_dwordx4 v[104:107], v31, s[28:31], s74 offen offset:512 sc1
  v_mul_f32 v112, v112, v224
  v_mul_f32 v113, v113, v224
  v_mul_f32 v116, v116, v226
  v_mul_f32 v117, v117, v226
  v_mul_f32 v114, v114, v224
  v_mul_f32 v115, v115, v224
  v_cvt_pk_bf16_f32 v112, v112, v113
  v_mul_f32 v118, v118, v226
  v_mul_f32 v119, v119, v226
  v_cvt_pk_bf16_f32 v113, v114, v115
  v_cvt_pk_bf16_f32 v114, v116, v117
  v_cvt_pk_bf16_f32 v115, v118, v119
  s_nop 0
  v_permlane16_swap_b32 v112, v114
  v_permlane16_swap_b32 v113, v115
  buffer_store_dwordx4 v[112:115], v31, s[28:31], s75 offen offset:0 sc1
  v_mul_f32 v120, v120, v228
  v_mul_f32 v121, v121, v228
  v_mul_f32 v124, v124, v230
  v_mul_f32 v125, v125, v230
  v_mul_f32 v122, v122, v228
  v_mul_f32 v123, v123, v228
  v_cvt_pk_bf16_f32 v120, v120, v121
  v_mul_f32 v126, v126, v230
  v_mul_f32 v127, v127, v230
  v_cvt_pk_bf16_f32 v121, v122, v123
  v_cvt_pk_bf16_f32 v122, v124, v125
  v_cvt_pk_bf16_f32 v123, v126, v127
  s_nop 0
  v_permlane16_swap_b32 v120, v122
  v_permlane16_swap_b32 v121, v123
  buffer_store_dwordx4 v[120:123], v31, s[28:31], s75 offen offset:512 sc1
  s_branch Lp1flag
Lp1idle:
  s_lshl_b32 s70, s62, 7
  s_lshl_b32 s71, s58, 5
  s_add_u32 s70, s70, s71
  v_add_u32 v24, s70, v25
  v_lshlrev_b32 v28, 4, v24
  v_mul_u32_u24 v24, 1280, v24
  v_lshl_add_u32 v24, v27, 4, v24
  s_mov_b32 s72, 0
  s_movk_i32 s68, 10240
  s_movk_i32 s69, 15360
  s_movk_i32 s70, 20480
  s_movk_i32 s71, 25600
  s_movk_i32 s72, 5120
  s_movk_i32 s73, 30720
  s_mov_b32 s75, 35840
  buffer_load_dwordx4 v[68:71], v24, s[32:35], 0 offen offset:256
  buffer_load_dwordx4 v[88:91], v24, s[32:35], s72 offen offset:256
  buffer_load_dwordx4 v[108:111], v24, s[32:35], s68 offen offset:256
  buffer_load_dwordx4 v[128:131], v24, s[32:35], s69 offen offset:256
  buffer_load_dwordx4 v[148:151], v24, s[32:35], s70 offen offset:256
  buffer_load_dwordx4 v[168:171], v24, s[32:35], s71 offen offset:256
  buffer_load_dwordx4 v[188:191], v24, s[32:35], s73 offen offset:256
  buffer_load_dwordx4 v[208:211], v24, s[32:35], s75 offen offset:256
  s_lshl_b32 s60, s56, 5
  s_add_u32 s60, s60, s57
  s_mov_b32 s61, 0x40000
  s_mov_b32 s30, 18874368
  s_mov_b32 s31, 0x20000
  s_mov_b64 s[28:29], s[24:25]
  s_mov_b32 s42, 819200
  s_mov_b32 s43, 0x20000
  s_mov_b64 s[40:41], s[8:9]
  s_mov_b32 s46, 7077888
  s_mov_b32 s47, 0x20000
  s_mov_b64 s[44:45], s[12:13]
  s_mov_b32 s50, 7077888
  s_mov_b32 s51, 0x20000
  s_mov_b64 s[48:49], s[16:17]
  s_mov_b32 s54, 2621440
  s_mov_b32 s55, 0x20000
  s_mov_b64 s[52:53], s[20:21]
  buffer_load_dword v22, off, s[28:31], 0 sc1
  v_mov_b32 v48, 0x3f803f80
  v_lshl_add_u32 v28, v27, 6, v28
  s_mov_b32 s74, 135168
  v_mov_b32 v224, 0
  v_mov_b32 v225, 0
  v_mov_b32 v226, 0
  v_mov_b32 v227, 0
  v_mov_b32 v228, 0
  v_mov_b32 v229, 0
  v_mov_b32 v230, 0
  v_mov_b32 v231, 0
  v_mov_b32 v232, 0
  v_mov_b32 v233, 0
  v_mov_b32 v234, 0
  v_mov_b32 v235, 0
  v_mov_b32 v236, 0
  v_mov_b32 v237, 0
  v_mov_b32 v238, 0
  v_mov_b32 v239, 0
  buffer_load_dwordx4 v[72:75], v24, s[32:35], 0 offen offset:512
  buffer_load_dwordx4 v[92:95], v24, s[32:35], s72 offen offset:512
  buffer_load_dwordx4 v[112:115], v24, s[32:35], s68 offen offset:512
  buffer_load_dwordx4 v[132:135], v24, s[32:35], s69 offen offset:512
  buffer_load_dwordx4 v[152:155], v24, s[32:35], s70 offen offset:512
  buffer_load_dwordx4 v[172:175], v24, s[32:35], s71 offen offset:512
  buffer_load_dwordx4 v[192:195], v24, s[32:35], s73 offen offset:512
  buffer_load_dwordx4 v[212:215], v24, s[32:35], s75 offen offset:512
  buffer_load_dwordx4 v[76:79], v24, s[32:35], 0 offen offset:768
  s_waitcnt vmcnt(17)
  v_dot2c_f32_bf16 v225, v68, v48
  v_dot2c_f32_bf16 v224, v68, v68
  v_dot2c_f32_bf16 v225, v69, v48
  v_dot2c_f32_bf16 v224, v69, v69
  v_dot2c_f32_bf16 v225, v70, v48
  v_dot2c_f32_bf16 v224, v70, v70
  v_dot2c_f32_bf16 v225, v71, v48
  v_dot2c_f32_bf16 v224, v71, v71
  buffer_load_dwordx4 v[96:99], v24, s[32:35], s72 offen offset:768
  s_waitcnt vmcnt(17)
  v_dot2c_f32_bf16 v227, v88, v48
  v_dot2c_f32_bf16 v226, v88, v88
  v_dot2c_f32_bf16 v227, v89, v48
  v_dot2c_f32_bf16 v226, v89, v89
  v_dot2c_f32_bf16 v227, v90, v48
  v_dot2c_f32_bf16 v226, v90, v90
  v_dot2c_f32_bf16 v227, v91, v48
  v_dot2c_f32_bf16 v226, v91, v91
  buffer_load_dwordx4 v[116:119], v24, s[32:35], s68 offen offset:768
  s_waitcnt vmcnt(17)
  v_dot2c_f32_bf16 v229, v108, v48
  v_dot2c_f32_bf16 v228, v108, v108
  v_dot2c_f32_bf16 v229, v109, v48
  v_dot2c_f32_bf16 v228, v109, v109
  v_dot2c_f32_bf16 v229, v110, v48
  v_dot2c_f32_bf16 v228, v110, v110
  v_dot2c_f32_bf16 v229, v111, v48
  v_dot2c_f32_bf16 v228, v111, v111
  buffer_load_dwordx4 v[136:139], v24, s[32:35], s69 offen offset:768
  s_waitcnt vmcnt(17)
  v_dot2c_f32_bf16 v231, v128, v48
  v_dot2c_f32_bf16 v230, v128, v128
  v_dot2c_f32_bf16 v231, v129, v48
  v_dot2c_f32_bf16 v230, v129, v129
  v_dot2c_f32_bf16 v231, v130, v48
  v_dot2c_f32_bf16 v230, v130, v130
  v_dot2c_f32_bf16 v231, v131, v48
  v_dot2c_f32_bf16 v230, v131, v131
  buffer_load_dwordx4 v[156:159], v24, s[32:35], s70 offen offset:768
  s_waitcnt vmcnt(17)
  v_dot2c_f32_bf16 v233, v148, v48
  v_dot2c_f32_bf16 v232, v148, v148
  v_dot2c_f32_bf16 v233, v149, v48
  v_dot2c_f32_bf16 v232, v149, v149
  v_dot2c_f32_bf16 v233, v150, v48
  v_dot2c_f32_bf16 v232, v150, v150
  v_dot2c_f32_bf16 v233, v151, v48
  v_dot2c_f32_bf16 v232, v151, v151
  buffer_load_dwordx4 v[176:179], v24, s[32:35], s71 offen offset:768
  s_waitcnt vmcnt(17)
  v_dot2c_f32_bf16 v235, v168, v48
  v_dot2c_f32_bf16 v234, v168, v168
  v_dot2c_f32_bf16 v235, v169, v48
  v_dot2c_f32_bf16 v234, v169, v169
  v_dot2c_f32_bf16 v235, v170, v48
  v_dot2c_f32_bf16 v234, v170, v170
  v_dot2c_f32_bf16 v235, v171, v48
  v_dot2c_f32_bf16 v234, v171, v171
  buffer_load_dwordx4 v[196:199], v24, s[32:35], s73 offen offset:768
  s_waitcnt vmcnt(17)
  v_dot2c_f32_bf16 v237, v188, v48
  v_dot2c_f32_bf16 v236, v188, v188
  v_dot2c_f32_bf16 v237, v189, v48
  v_dot2c_f32_bf16 v236, v189, v189
  v_dot2c_f32_bf16 v237, v190, v48
  v_dot2c_f32_bf16 v236, v190, v190
  v_dot2c_f32_bf16 v237, v191, v48
  v_dot2c_f32_bf16 v236, v191, v191
  buffer_load_dwordx4 v[216:219], v24, s[32:35], s75 offen offset:768
  s_waitcnt vmcnt(17)
  v_dot2c_f32_bf16 v239, v208, v48
  v_dot2c_f32_bf16 v238, v208, v208
  v_dot2c_f32_bf16 v239, v209, v48
  v_dot2c_f32_bf16 v238, v209, v209
  v_dot2c_f32_bf16 v239, v210, v48
  v_dot2c_f32_bf16 v238, v210, v210
  v_dot2c_f32_bf16 v239, v211, v48
  v_dot2c_f32_bf16 v238, v211, v211
  buffer_load_dwordx4 v[80:83], v24, s[32:35], 0 offen offset:1024
  s_waitcnt vmcnt(16)
  v_dot2c_f32_bf16 v225, v72, v48
  v_dot2c_f32_bf16 v224, v72, v72
  v_dot2c_f32_bf16 v225, v73, v48
  v_dot2c_f32_bf16 v224, v73, v73
  v_dot2c_f32_bf16 v225, v74, v48
  v_dot2c_f32_bf16 v224, v74, v74
  v_dot2c_f32_bf16 v225, v75, v48
  v_dot2c_f32_bf16 v224, v75, v75
  buffer_load_dwordx4 v[100:103], v24, s[32:35], s72 offen offset:1024
  s_waitcnt vmcnt(16)
  v_dot2c_f32_bf16 v227, v92, v48
  v_dot2c_f32_bf16 v226, v92, v92
  v_dot2c_f32_bf16 v227, v93, v48
  v_dot2c_f32_bf16 v226, v93, v93
  v_dot2c_f32_bf16 v227, v94, v48
  v_dot2c_f32_bf16 v226, v94, v94
  v_dot2c_f32_bf16 v227, v95, v48
  v_dot2c_f32_bf16 v226, v95, v95
  buffer_load_dwordx4 v[120:123], v24, s[32:35], s68 offen offset:1024
  s_waitcnt vmcnt(16)
  v_dot2c_f32_bf16 v229, v112, v48
  v_dot2c_f32_bf16 v228, v112, v112
  v_dot2c_f32_bf16 v229, v113, v48
  v_dot2c_f32_bf16 v228, v113, v113
  v_dot2c_f32_bf16 v229, v114, v48
  v_dot2c_f32_bf16 v228, v114, v114
  v_dot2c_f32_bf16 v229, v115, v48
  v_dot2c_f32_bf16 v228, v115, v115
  buffer_load_dwordx4 v[140:143], v24, s[32:35], s69 offen offset:1024
  s_waitcnt vmcnt(16)
  v_dot2c_f32_bf16 v231, v132, v48
  v_dot2c_f32_bf16 v230, v132, v132
  v_dot2c_f32_bf16 v231, v133, v48
  v_dot2c_f32_bf16 v230, v133, v133
  v_dot2c_f32_bf16 v231, v134, v48
  v_dot2c_f32_bf16 v230, v134, v134
  v_dot2c_f32_bf16 v231, v135, v48
  v_dot2c_f32_bf16 v230, v135, v135
  buffer_load_dwordx4 v[160:163], v24, s[32:35], s70 offen offset:1024
  s_waitcnt vmcnt(16)
  v_dot2c_f32_bf16 v233, v152, v48
  v_dot2c_f32_bf16 v232, v152, v152
  v_dot2c_f32_bf16 v233, v153, v48
  v_dot2c_f32_bf16 v232, v153, v153
  v_dot2c_f32_bf16 v233, v154, v48
  v_dot2c_f32_bf16 v232, v154, v154
  v_dot2c_f32_bf16 v233, v155, v48
  v_dot2c_f32_bf16 v232, v155, v155
  buffer_load_dwordx4 v[180:183], v24, s[32:35], s71 offen offset:1024
  s_waitcnt vmcnt(16)
  v_dot2c_f32_bf16 v235, v172, v48
  v_dot2c_f32_bf16 v234, v172, v172
  v_dot2c_f32_bf16 v235, v173, v48
  v_dot2c_f32_bf16 v234, v173, v173
  v_dot2c_f32_bf16 v235, v174, v48
  v_dot2c_f32_bf16 v234, v174, v174
  v_dot2c_f32_bf16 v235, v175, v48
  v_dot2c_f32_bf16 v234, v175, v175
  buffer_load_dwordx4 v[200:203], v24, s[32:35], s73 offen offset:1024
  s_waitcnt vmcnt(16)
  v_dot2c_f32_bf16 v237, v192, v48
  v_dot2c_f32_bf16 v236, v192, v192
  v_dot2c_f32_bf16 v237, v193, v48
  v_dot2c_f32_bf16 v236, v193, v193
  v_dot2c_f32_bf16 v237, v194, v48
  v_dot2c_f32_bf16 v236, v194, v194
  v_dot2c_f32_bf16 v237, v195, v48
  v_dot2c_f32_bf16 v236, v195, v195
  buffer_load_dwordx4 v[220:223], v24, s[32:35], s75 offen offset:1024
  s_waitcnt vmcnt(16)
  v_dot2c_f32_bf16 v239, v212, v48
  v_dot2c_f32_bf16 v238, v212, v212
  v_dot2c_f32_bf16 v239, v213, v48
  v_dot2c_f32_bf16 v238, v213, v213
  v_dot2c_f32_bf16 v239, v214, v48
  v_dot2c_f32_bf16 v238, v214, v214
  v_dot2c_f32_bf16 v239, v215, v48
  v_dot2c_f32_bf16 v238, v215, v215
  buffer_load_dwordx4 v[64:67], v24, s[32:35], 0 offen offset:0
  s_waitcnt vmcnt(16)
  v_dot2c_f32_bf16 v225, v76, v48
  v_dot2c_f32_bf16 v224, v76, v76
  v_dot2c_f32_bf16 v225, v77, v48
  v_dot2c_f32_bf16 v224, v77, v77
  v_dot2c_f32_bf16 v225, v78, v48
  v_dot2c_f32_bf16 v224, v78, v78
  v_dot2c_f32_bf16 v225, v79, v48
  v_dot2c_f32_bf16 v224, v79, v79
  buffer_load_dwordx4 v[84:87], v24, s[32:35], s72 offen offset:0
  s_waitcnt vmcnt(16)
  v_dot2c_f32_bf16 v227, v96, v48
  v_dot2c_f32_bf16 v226, v96, v96
  v_dot2c_f32_bf16 v227, v97, v48
  v_dot2c_f32_bf16 v226, v97, v97
  v_dot2c_f32_bf16 v227, v98, v48
  v_dot2c_f32_bf16 v226, v98, v98
  v_dot2c_f32_bf16 v227, v99, v48
  v_dot2c_f32_bf16 v226, v99, v99
  buffer_load_dwordx4 v[104:107], v24, s[32:35], s68 offen offset:0
  s_waitcnt vmcnt(16)
  v_dot2c_f32_bf16 v229, v116, v48
  v_dot2c_f32_bf16 v228, v116, v116
  v_dot2c_f32_bf16 v229, v117, v48
  v_dot2c_f32_bf16 v228, v117, v117
  v_dot2c_f32_bf16 v229, v118, v48
  v_dot2c_f32_bf16 v228, v118, v118
  v_dot2c_f32_bf16 v229, v119, v48
  v_dot2c_f32_bf16 v228, v119, v119
  buffer_load_dwordx4 v[124:127], v24, s[32:35], s69 offen offset:0
  s_waitcnt vmcnt(16)
  v_dot2c_f32_bf16 v231, v136, v48
  v_dot2c_f32_bf16 v230, v136, v136
  v_dot2c_f32_bf16 v231, v137, v48
  v_dot2c_f32_bf16 v230, v137, v137
  v_dot2c_f32_bf16 v231, v138, v48
  v_dot2c_f32_bf16 v230, v138, v138
  v_dot2c_f32_bf16 v231, v139, v48
  v_dot2c_f32_bf16 v230, v139, v139
  buffer_load_dwordx4 v[144:147], v24, s[32:35], s70 offen offset:0
  s_waitcnt vmcnt(16)
  v_dot2c_f32_bf16 v233, v156, v48
  v_dot2c_f32_bf16 v232, v156, v156
  v_dot2c_f32_bf16 v233, v157, v48
  v_dot2c_f32_bf16 v232, v157, v157
  v_dot2c_f32_bf16 v233, v158, v48
  v_dot2c_f32_bf16 v232, v158, v158
  v_dot2c_f32_bf16 v233, v159, v48
  v_dot2c_f32_bf16 v232, v159, v159
  buffer_load_dwordx4 v[164:167], v24, s[32:35], s71 offen offset:0
  s_waitcnt vmcnt(16)
  v_dot2c_f32_bf16 v235, v176, v48
  v_dot2c_f32_bf16 v234, v176, v176
  v_dot2c_f32_bf16 v235, v177, v48
  v_dot2c_f32_bf16 v234, v177, v177
  v_dot2c_f32_bf16 v235, v178, v48
  v_dot2c_f32_bf16 v234, v178, v178
  v_dot2c_f32_bf16 v235, v179, v48
  v_dot2c_f32_bf16 v234, v179, v179
  buffer_load_dwordx4 v[184:187], v24, s[32:35], s73 offen offset:0
  s_waitcnt vmcnt(16)
  v_dot2c_f32_bf16 v237, v196, v48
  v_dot2c_f32_bf16 v236, v196, v196
  v_dot2c_f32_bf16 v237, v197, v48
  v_dot2c_f32_bf16 v236, v197, v197
  v_dot2c_f32_bf16 v237, v198, v48
  v_dot2c_f32_bf16 v236, v198, v198
  v_dot2c_f32_bf16 v237, v199, v48
  v_dot2c_f32_bf16 v236, v199, v199
  buffer_load_dwordx4 v[204:207], v24, s[32:35], s75 offen offset:0
  s_waitcnt vmcnt(16)
  v_dot2c_f32_bf16 v239, v216, v48
  v_dot2c_f32_bf16 v238, v216, v216
  v_dot2c_f32_bf16 v239, v217, v48
  v_dot2c_f32_bf16 v238, v217, v217
  v_dot2c_f32_bf16 v239, v218, v48
  v_dot2c_f32_bf16 v238, v218, v218
  v_dot2c_f32_bf16 v239, v219, v48
  v_dot2c_f32_bf16 v238, v219, v219
  s_waitcnt vmcnt(15)
  v_dot2c_f32_bf16 v225, v80, v48
  v_dot2c_f32_bf16 v224, v80, v80
  v_dot2c_f32_bf16 v225, v81, v48
  v_dot2c_f32_bf16 v224, v81, v81
  v_dot2c_f32_bf16 v225, v82, v48
  v_dot2c_f32_bf16 v224, v82, v82
  v_dot2c_f32_bf16 v225, v83, v48
  v_dot2c_f32_bf16 v224, v83, v83
  s_waitcnt vmcnt(14)
  v_dot2c_f32_bf16 v227, v100, v48
  v_dot2c_f32_bf16 v226, v100, v100
  v_dot2c_f32_bf16 v227, v101, v48
  v_dot2c_f32_bf16 v226, v101, v101
  v_dot2c_f32_bf16 v227, v102, v48
  v_dot2c_f32_bf16 v226, v102, v102
  v_dot2c_f32_bf16 v227, v103, v48
  v_dot2c_f32_bf16 v226, v103, v103
  s_waitcnt vmcnt(13)
  v_dot2c_f32_bf16 v229, v120, v48
  v_dot2c_f32_bf16 v228, v120, v120
  v_dot2c_f32_bf16 v229, v121, v48
  v_dot2c_f32_bf16 v228, v121, v121
  v_dot2c_f32_bf16 v229, v122, v48
  v_dot2c_f32_bf16 v228, v122, v122
  v_dot2c_f32_bf16 v229, v123, v48
  v_dot2c_f32_bf16 v228, v123, v123
  s_waitcnt vmcnt(12)
  v_dot2c_f32_bf16 v231, v140, v48
  v_dot2c_f32_bf16 v230, v140, v140
  v_dot2c_f32_bf16 v231, v141, v48
  v_dot2c_f32_bf16 v230, v141, v141
  v_dot2c_f32_bf16 v231, v142, v48
  v_dot2c_f32_bf16 v230, v142, v142
  v_dot2c_f32_bf16 v231, v143, v48
  v_dot2c_f32_bf16 v230, v143, v143
  s_waitcnt vmcnt(11)
  v_dot2c_f32_bf16 v233, v160, v48
  v_dot2c_f32_bf16 v232, v160, v160
  v_dot2c_f32_bf16 v233, v161, v48
  v_dot2c_f32_bf16 v232, v161, v161
  v_dot2c_f32_bf16 v233, v162, v48
  v_dot2c_f32_bf16 v232, v162, v162
  v_dot2c_f32_bf16 v233, v163, v48
  v_dot2c_f32_bf16 v232, v163, v163
  s_waitcnt vmcnt(10)
  v_dot2c_f32_bf16 v235, v180, v48
  v_dot2c_f32_bf16 v234, v180, v180
  v_dot2c_f32_bf16 v235, v181, v48
  v_dot2c_f32_bf16 v234, v181, v181
  v_dot2c_f32_bf16 v235, v182, v48
  v_dot2c_f32_bf16 v234, v182, v182
  v_dot2c_f32_bf16 v235, v183, v48
  v_dot2c_f32_bf16 v234, v183, v183
  s_waitcnt vmcnt(9)
  v_dot2c_f32_bf16 v237, v200, v48
  v_dot2c_f32_bf16 v236, v200, v200
  v_dot2c_f32_bf16 v237, v201, v48
  v_dot2c_f32_bf16 v236, v201, v201
  v_dot2c_f32_bf16 v237, v202, v48
  v_dot2c_f32_bf16 v236, v202, v202
  v_dot2c_f32_bf16 v237, v203, v48
  v_dot2c_f32_bf16 v236, v203, v203
  s_waitcnt vmcnt(8)
  v_dot2c_f32_bf16 v239, v220, v48
  v_dot2c_f32_bf16 v238, v220, v220
  v_dot2c_f32_bf16 v239, v221, v48
  v_dot2c_f32_bf16 v238, v221, v221
  v_dot2c_f32_bf16 v239, v222, v48
  v_dot2c_f32_bf16 v238, v222, v222
  v_dot2c_f32_bf16 v239, v223, v48
  v_dot2c_f32_bf16 v238, v223, v223
  s_waitcnt vmcnt(7)
  v_dot2c_f32_bf16 v225, v64, v48
  v_dot2c_f32_bf16 v224, v64, v64
  v_dot2c_f32_bf16 v225, v65, v48
  v_dot2c_f32_bf16 v224, v65, v65
  v_dot2c_f32_bf16 v225, v66, v48
  v_dot2c_f32_bf16 v224, v66, v66
  v_dot2c_f32_bf16 v225, v67, v48
  v_dot2c_f32_bf16 v224, v67, v67
  s_waitcnt vmcnt(6)
  v_dot2c_f32_bf16 v227, v84, v48
  v_dot2c_f32_bf16 v226, v84, v84
  v_dot2c_f32_bf16 v227, v85, v48
  v_dot2c_f32_bf16 v226, v85, v85
  v_dot2c_f32_bf16 v227, v86, v48
  v_dot2c_f32_bf16 v226, v86, v86
  v_dot2c_f32_bf16 v227, v87, v48
  v_dot2c_f32_bf16 v226, v87, v87
  s_waitcnt vmcnt(5)
  v_dot2c_f32_bf16 v229, v104, v48
  v_dot2c_f32_bf16 v228, v104, v104
  v_dot2c_f32_bf16 v229, v105, v48
  v_dot2c_f32_bf16 v228, v105, v105
  v_dot2c_f32_bf16 v229, v106, v48
  v_dot2c_f32_bf16 v228, v106, v106
  v_dot2c_f32_bf16 v229, v107, v48
  v_dot2c_f32_bf16 v228, v107, v107
  s_waitcnt vmcnt(4)
  v_dot2c_f32_bf16 v231, v124, v48
  v_dot2c_f32_bf16 v230, v124, v124
  v_dot2c_f32_bf16 v231, v125, v48
  v_dot2c_f32_bf16 v230, v125, v125
  v_dot2c_f32_bf16 v231, v126, v48
  v_dot2c_f32_bf16 v230, v126, v126
  v_dot2c_f32_bf16 v231, v127, v48
  v_dot2c_f32_bf16 v230, v127, v127
  s_waitcnt vmcnt(3)
  v_dot2c_f32_bf16 v233, v144, v48
  v_dot2c_f32_bf16 v232, v144, v144
  v_dot2c_f32_bf16 v233, v145, v48
  v_dot2c_f32_bf16 v232, v145, v145
  v_dot2c_f32_bf16 v233, v146, v48
  v_dot2c_f32_bf16 v232, v146, v146
  v_dot2c_f32_bf16 v233, v147, v48
  v_dot2c_f32_bf16 v232, v147, v147
  s_waitcnt vmcnt(2)
  v_dot2c_f32_bf16 v235, v164, v48
  v_dot2c_f32_bf16 v234, v164, v164
  v_dot2c_f32_bf16 v235, v165, v48
  v_dot2c_f32_bf16 v234, v165, v165
  v_dot2c_f32_bf16 v235, v166, v48
  v_dot2c_f32_bf16 v234, v166, v166
  v_dot2c_f32_bf16 v235, v167, v48
  v_dot2c_f32_bf16 v234, v167, v167
  s_waitcnt vmcnt(1)
  v_dot2c_f32_bf16 v237, v184, v48
  v_dot2c_f32_bf16 v236, v184, v184
  v_dot2c_f32_bf16 v237, v185, v48
  v_dot2c_f32_bf16 v236, v185, v185
  v_dot2c_f32_bf16 v237, v186, v48
  v_dot2c_f32_bf16 v236, v186, v186
  v_dot2c_f32_bf16 v237, v187, v48
  v_dot2c_f32_bf16 v236, v187, v187
  s_waitcnt vmcnt(0)
  v_dot2c_f32_bf16 v239, v204, v48
  v_dot2c_f32_bf16 v238, v204, v204
  v_dot2c_f32_bf16 v239, v205, v48
  v_dot2c_f32_bf16 v238, v205, v205
  v_dot2c_f32_bf16 v239, v206, v48
  v_dot2c_f32_bf16 v238, v206, v206
  v_dot2c_f32_bf16 v239, v207, v48
  v_dot2c_f32_bf16 v238, v207, v207
  s_mov_b32 s72, 0x10001
  s_mov_b32 s73, 0x10001
  v_readfirstlane_b32 s59, v22
  s_nop 0
  s_mul_i32 s59, s59, 1664525
  s_add_u32 s59, s59, 1013904223
  v_add_f32_dpp v224, v224, v224 quad_perm:[1,0,3,2] row_mask:0xf bank_mask:0xf
  v_add_f32_dpp v225, v225, v225 quad_perm:[1,0,3,2] row_mask:0xf bank_mask:0xf
  v_add_f32_dpp v226, v226, v226 quad_perm:[1,0,3,2] row_mask:0xf bank_mask:0xf
  v_add_f32_dpp v227, v227, v227 quad_perm:[1,0,3,2] row_mask:0xf bank_mask:0xf
  v_add_f32_dpp v228, v228, v228 quad_perm:[1,0,3,2] row_mask:0xf bank_mask:0xf
  v_add_f32_dpp v229, v229, v229 quad_perm:[1,0,3,2] row_mask:0xf bank_mask:0xf
  v_add_f32_dpp v230, v230, v230 quad_perm:[1,0,3,2] row_mask:0xf bank_mask:0xf
  v_add_f32_dpp v231, v231, v231 quad_perm:[1,0,3,2] row_mask:0xf bank_mask:0xf
  v_add_f32_dpp v232, v232, v232 quad_perm:[1,0,3,2] row_mask:0xf bank_mask:0xf
  v_add_f32_dpp v233, v233, v233 quad_perm:[1,0,3,2] row_mask:0xf bank_mask:0xf
  v_add_f32_dpp v234, v234, v234 quad_perm:[1,0,3,2] row_mask:0xf bank_mask:0xf
  v_add_f32_dpp v235, v235, v235 quad_perm:[1,0,3,2] row_mask:0xf bank_mask:0xf
  v_add_f32_dpp v236, v236, v236 quad_perm:[1,0,3,2] row_mask:0xf bank_mask:0xf
  v_add_f32_dpp v237, v237, v237 quad_perm:[1,0,3,2] row_mask:0xf bank_mask:0xf
  v_add_f32_dpp v238, v238, v238 quad_perm:[1,0,3,2] row_mask:0xf bank_mask:0xf
  v_add_f32_dpp v239, v239, v239 quad_perm:[1,0,3,2] row_mask:0xf bank_mask:0xf
  v_add_f32_dpp v224, v224, v224 quad_perm:[2,3,0,1] row_mask:0xf bank_mask:0xf
  v_add_f32_dpp v225, v225, v225 quad_perm:[2,3,0,1] row_mask:0xf bank_mask:0xf
  v_add_f32_dpp v226, v226, v226 quad_perm:[2,3,0,1] row_mask:0xf bank_mask:0xf
  v_add_f32_dpp v227, v227, v227 quad_perm:[2,3,0,1] row_mask:0xf bank_mask:0xf
  v_add_f32_dpp v228, v228, v228 quad_perm:[2,3,0,1] row_mask:0xf bank_mask:0xf
  v_add_f32_dpp v229, v229, v229 quad_perm:[2,3,0,1] row_mask:0xf bank_mask:0xf
  v_add_f32_dpp v230, v230, v230 quad_perm:[2,3,0,1] row_mask:0xf bank_mask:0xf
  v_add_f32_dpp v231, v231, v231 quad_perm:[2,3,0,1] row_mask:0xf bank_mask:0xf
  v_add_f32_dpp v232, v232, v232 quad_perm:[2,3,0,1] row_mask:0xf bank_mask:0xf
  v_add_f32_dpp v233, v233, v233 quad_perm:[2,3,0,1] row_mask:0xf bank_mask:0xf
  v_add_f32_dpp v234, v234, v234 quad_perm:[2,3,0,1] row_mask:0xf bank_mask:0xf
  v_add_f32_dpp v235, v235, v235 quad_perm:[2,3,0,1] row_mask:0xf bank_mask:0xf
  v_add_f32_dpp v236, v236, v236 quad_perm:[2,3,0,1] row_mask:0xf bank_mask:0xf
  v_add_f32_dpp v237, v237, v237 quad_perm:[2,3,0,1] row_mask:0xf bank_mask:0xf
  v_add_f32_dpp v238, v238, v238 quad_perm:[2,3,0,1] row_mask:0xf bank_mask:0xf
  v_add_f32_dpp v239, v239, v239 quad_perm:[2,3,0,1] row_mask:0xf bank_mask:0xf
  v_add_f32_dpp v224, v224, v224 row_half_mirror row_mask:0xf bank_mask:0xf
  v_add_f32_dpp v225, v225, v225 row_half_mirror row_mask:0xf bank_mask:0xf
  v_add_f32_dpp v226, v226, v226 row_half_mirror row_mask:0xf bank_mask:0xf
  v_add_f32_dpp v227, v227, v227 row_half_mirror row_mask:0xf bank_mask:0xf
  v_add_f32_dpp v228, v228, v228 row_half_mirror row_mask:0xf bank_mask:0xf
  v_add_f32_dpp v229, v229, v229 row_half_mirror row_mask:0xf bank_mask:0xf
  v_add_f32_dpp v230, v230, v230 row_half_mirror row_mask:0xf bank_mask:0xf
  v_add_f32_dpp v231, v231, v231 row_half_mirror row_mask:0xf bank_mask:0xf
  v_add_f32_dpp v232, v232, v232 row_half_mirror row_mask:0xf bank_mask:0xf
  v_add_f32_dpp v233, v233, v233 row_half_mirror row_mask:0xf bank_mask:0xf
  v_add_f32_dpp v234, v234, v234 row_half_mirror row_mask:0xf bank_mask:0xf
  v_add_f32_dpp v235, v235, v235 row_half_mirror row_mask:0xf bank_mask:0xf
  v_add_f32_dpp v236, v236, v236 row_half_mirror row_mask:0xf bank_mask:0xf
  v_add_f32_dpp v237, v237, v237 row_half_mirror row_mask:0xf bank_mask:0xf
  v_add_f32_dpp v238, v238, v238 row_half_mirror row_mask:0xf bank_mask:0xf
  v_add_f32_dpp v239, v239, v239 row_half_mirror row_mask:0xf bank_mask:0xf
  v_add_f32_dpp v224, v224, v224 row_mirror row_mask:0xf bank_mask:0xf
  v_add_f32_dpp v225, v225, v225 row_mirror row_mask:0xf bank_mask:0xf
  v_add_f32_dpp v226, v226, v226 row_mirror row_mask:0xf bank_mask:0xf
  v_add_f32_dpp v227, v227, v227 row_mirror row_mask:0xf bank_mask:0xf
  v_add_f32_dpp v228, v228, v228 row_mirror row_mask:0xf bank_mask:0xf
  v_add_f32_dpp v229, v229, v229 row_mirror row_mask:0xf bank_mask:0xf
  v_add_f32_dpp v230, v230, v230 row_mirror row_mask:0xf bank_mask:0xf
  v_add_f32_dpp v231, v231, v231 row_mirror row_mask:0xf bank_mask:0xf
  v_add_f32_dpp v232, v232, v232 row_mirror row_mask:0xf bank_mask:0xf
  v_add_f32_dpp v233, v233, v233 row_mirror row_mask:0xf bank_mask:0xf
  v_add_f32_dpp v234, v234, v234 row_mirror row_mask:0xf bank_mask:0xf
  v_add_f32_dpp v235, v235, v235 row_mirror row_mask:0xf bank_mask:0xf
  v_add_f32_dpp v236, v236, v236 row_mirror row_mask:0xf bank_mask:0xf
  v_add_f32_dpp v237, v237, v237 row_mirror row_mask:0xf bank_mask:0xf
  v_add_f32_dpp v238, v238, v238 row_mirror row_mask:0xf bank_mask:0xf
  v_add_f32_dpp v239, v239, v239 row_mirror row_mask:0xf bank_mask:0xf
  v_mov_b32 v46, s59
  v_mov_b32 v47, s59
  s_lshl_b64 exec, s[72:73], 1
  v_mov_b32 v224, v226
  v_mov_b32 v225, v227
  s_lshl_b64 exec, s[72:73], 2
  v_mov_b32 v224, v228
  v_mov_b32 v225, v229
  s_lshl_b64 exec, s[72:73], 3
  v_mov_b32 v224, v230
  v_mov_b32 v225, v231
  s_lshl_b64 exec, s[72:73], 4
  v_mov_b32 v224, v232
  v_mov_b32 v225, v233
  s_lshl_b64 exec, s[72:73], 5
  v_mov_b32 v224, v234
  v_mov_b32 v225, v235
  s_lshl_b64 exec, s[72:73], 6
  v_mov_b32 v224, v236
  v_mov_b32 v225, v237
  s_lshl_b64 exec, s[72:73], 7
  v_mov_b32 v224, v238
  v_mov_b32 v225, v239
  s_mov_b32 exec_lo, 0xff00ff
  s_mov_b32 exec_hi, 0xff00ff
  v_mul_f32 v45, 0xbacccccd, v225
  v_mul_f32 v44, 0x3acccccd, v224
  v_fma_f32 v44, -v45, v45, v44
  v_max_f32 v44, 0, v44
  v_add_f32 v44, 0x3727c5ac, v44
  v_rsq_f32 v44, v44
  buffer_store_dwordx4 v[44:47], v28, s[28:31], s74 offen sc1
  s_mov_b64 exec, -1
  s_lshr_b32 s70, s57, 3
  s_lshl3_add_u32 s76, s70, s56
  s_and_b32 s9, s57, 7
  s_lshr_b32 s10, s60, 3
  s_mov_b32 s12, s9
  s_lshl3_add_u32 s11, s10, s9
  s_mul_i32 s8, s58, 25600
  s_mul_i32 s77, s58, 14
  s_lshr_b32 s70, s58, 1
  s_lshl_b32 s71, s70, 1
  s_and_b32 s71, s71, s58
  s_and_b32 s72, s58, s70
  s_add_u32 s70, s70, s72
  s_sub_u32 s77, s77, s70
  v_bfe_u32 v40, v1, 4, 1
  v_lshlrev_b32 v40, 1, v40
  v_and_b32 v41, 7, v1
  v_xor_b32 v40, v40, v41
  v_lshlrev_b32 v40, 4, v40
  v_xor_b32 v41, 64, v40
  v_lshrrev_b32 v42, 3, v1
  s_lshl_b32 s70, s58, 9
  v_add_u32 v43, s70, v42
  v_mul_u32_u24 v43, 3456, v43
  s_lshl_b32 s70, s76, 7
  s_cmp_ge_u32 s76, 27
  s_cselect_b32 s70, 0x80000000, s70
  s_mul_i32 s6, s58, 1769472
  s_add_u32 s6, s6, s70
  v_add_u32 v43, s70, v43
  v_add_u32 v244, v43, v40
  v_add_u32 v245, v43, v41
  v_add_u32 v245, 26624, v245
  s_lshl_b32 s70, s77, 5
  v_add_lshl_u32 v43, s70, v42, 12
  s_lshl_b32 s25, s70, 12
  s_lshl_b32 s70, s10, 7
  s_add_u32 s25, s25, s70
  v_add_u32 v43, s70, v43
  v_add_u32 v246, v43, v40
  v_add_u32 v247, v43, v41
  v_add_u32 v247, 31744, v247
  v_bfe_u32 v40, v1, 3, 2
  v_xor_b32 v40, s58, v40
  v_lshlrev_b32 v40, 5, v40
  v_and_b32 v41, 3, v1
  v_lshl_add_u32 v40, v41, 3, v40
  v_bfe_u32 v41, v1, 2, 2
  v_lshl_add_u32 v40, v41, 7, v40
  v_lshrrev_b32 v41, 4, v1
  v_lshl_add_u32 v250, v41, 10, v40
  s_lshl2_add_u32 s17, s60, s58
  v_min_u32 v61, 6, v1
  s_mul_i32 s17, s17, 896
  v_lshlrev_b32 v61, 7, v61
  buffer_load_dword v61, v61, s[40:43], s17 offen
  s_mul_i32 s17, s12, 44
  v_min_u32 v60, 43, v1
  s_add_u32 s17, s17, 0
  v_add_u32 v60, s17, v60
  v_mul_u32_u24 v60, 3456, v60
  buffer_load_dword v60, v60, s[44:47], s6 offen
  s_lshl_b32 s70, s58, 8
  s_add_u32 s70, s70, s62
  s_add_u32 s70, s70, 176
  s_mul_i32 s70, s70, 6912
  v_min_u32 v16, 53, v1
  v_lshlrev_b32 v16, 7, v16
  s_waitcnt vmcnt(0) lgkmcnt(0)
  s_branch Lp1end
Lp1v:
  s_lshl_b32 s72, s62, 4
  s_lshl3_add_u32 s72, s70, s72
  v_add_u32 v24, s72, v24
  s_mov_b32 s72, 10240
  v_mad_u32_u24 v31, v24, s72, v26
  s_sub_u32 s72, s63, 10
  s_lshl_b32 s72, s72, 11
  s_lshl_b32 s73, s71, 10
  s_add_u32 s72, s72, s73
  s_lshl_b32 s73, s70, 9
  s_add_u32 s72, s72, s73
  s_xor_b32 s73, s72, 512
  v_add_u32 v34, s73, v31
  v_add_u32 v31, s72, v31
  s_lshl_b32 s72, s70, 8
  s_add_u32 s72, s72, 8192
  v_lshl_add_u32 v33, v25, 4, s72
  s_mov_b32 s72, 6815744
  s_mov_b32 s73, 6836224
  s_mov_b32 s74, 6856704
  s_mov_b32 s75, 6877184
  s_waitcnt vmcnt(10)
  s_barrier
  ds_read_b64_tr_b16 v[160:161], v10 offset:0
  ds_read_b64_tr_b16 v[162:163], v10 offset:1024
  ds_read_b128 v[128:131], v4 offset:0
  ds_read_b64_tr_b16 v[164:165], v11 offset:0
  ds_read_b64_tr_b16 v[166:167], v11 offset:1024
  ds_read_b128 v[132:135], v4 offset:2048
  ds_read_b128 v[136:139], v4 offset:4096
  ds_read_b128 v[140:143], v4 offset:6144
  ds_read_b64_tr_b16 v[168:169], v12 offset:0
  ds_read_b64_tr_b16 v[170:171], v12 offset:1024
  ds_read_b64_tr_b16 v[172:173], v13 offset:0
  ds_read_b64_tr_b16 v[174:175], v13 offset:1024
  s_waitcnt vmcnt(9)
  v_readfirstlane_b32 s59, v22
  s_nop 0
  s_mul_i32 s59, s59, 1664525
  s_add_u32 s59, s59, 1013904223
  s_waitcnt lgkmcnt(9)
  v_mfma_f32_16x16x32_bf16 v[64:67], v[128:131], v[160:163], 0
  ds_read_b64_tr_b16 v[176:177], v10 offset:8192
  s_add_u32 m0, s67, 0
  s_waitcnt lgkmcnt(8)
  v_mfma_f32_16x16x32_bf16 v[68:71], v[128:131], v[164:167], 0
  ds_read_b64_tr_b16 v[178:179], v10 offset:9216
  s_movk_i32 s65, 256
  s_waitcnt lgkmcnt(8)
  v_mfma_f32_16x16x32_bf16 v[72:75], v[132:135], v[160:163], 0
  ds_read_b128 v[144:147], v5 offset:0
  v_mfma_f32_16x16x32_bf16 v[76:79], v[132:135], v[164:167], 0
  buffer_load_dwordx4 v14, s[32:35], s65 offen offset:0 lds
  s_waitcnt lgkmcnt(8)
  v_mfma_f32_16x16x32_bf16 v[80:83], v[136:139], v[160:163], 0
  ds_read_b64_tr_b16 v[180:181], v11 offset:8192
  v_mfma_f32_16x16x32_bf16 v[40:43], v[56:59], v[160:163], 0
  ds_read_b64_tr_b16 v[182:183], v11 offset:9216
  v_mfma_f32_16x16x32_bf16 v[84:87], v[136:139], v[164:167], 0
  ds_read_b128 v[148:151], v5 offset:2048
  s_waitcnt lgkmcnt(10)
  v_mfma_f32_16x16x32_bf16 v[88:91], v[140:143], v[160:163], 0
  buffer_load_dwordx4 v15, s[32:35], s65 offen offset:1024 lds
  v_mfma_f32_16x16x32_bf16 v[92:95], v[140:143], v[164:167], 0
  ds_read_b128 v[152:155], v5 offset:4096
  s_waitcnt lgkmcnt(9)
  v_mfma_f32_16x16x32_bf16 v[96:99], v[128:131], v[168:171], 0
  ds_read_b128 v[156:159], v5 offset:6144
  v_mfma_f32_16x16x32_bf16 v[44:47], v[56:59], v[164:167], 0
  ds_read_b64_tr_b16 v[184:185], v12 offset:8192
  s_waitcnt lgkmcnt(9)
  v_mfma_f32_16x16x32_bf16 v[100:103], v[128:131], v[172:175], 0
  buffer_load_dwordx4 v16, s[32:35], s65 offen offset:2048 lds
  v_mfma_f32_16x16x32_bf16 v[104:107], v[132:135], v[168:171], 0
  ds_read_b64_tr_b16 v[186:187], v12 offset:9216
  v_mfma_f32_16x16x32_bf16 v[108:111], v[132:135], v[172:175], 0
  ds_read_b64_tr_b16 v[188:189], v13 offset:8192
  v_mfma_f32_16x16x32_bf16 v[112:115], v[136:139], v[168:171], 0
  ds_read_b64_tr_b16 v[190:191], v13 offset:9216
  v_mfma_f32_16x16x32_bf16 v[116:119], v[136:139], v[172:175], 0
  buffer_load_dwordx4 v17, s[32:35], s65 offen offset:3072 lds
  s_add_u32 m0, s67, 16384
  v_mfma_f32_16x16x32_bf16 v[120:123], v[140:143], v[168:171], 0
  s_mov_b32 s66, 491520
  v_mfma_f32_16x16x32_bf16 v[124:127], v[140:143], v[172:175], 0
  buffer_load_dwordx4 v18, s[36:39], s66 offen offset:0 lds
  s_waitcnt lgkmcnt(0)
  s_waitcnt vmcnt(6)
  s_barrier
  v_mfma_f32_16x16x32_bf16 v[64:67], v[144:147], v[176:179], v[64:67]
  ds_read_b64_tr_b16 v[160:161], v10 offset:32768
  v_mfma_f32_16x16x32_bf16 v[68:71], v[144:147], v[180:183], v[68:71]
  ds_read_b64_tr_b16 v[162:163], v10 offset:33792
  v_mfma_f32_16x16x32_bf16 v[72:75], v[148:151], v[176:179], v[72:75]
  ds_read_b128 v[128:131], v4 offset:32768
  v_mfma_f32_16x16x32_bf16 v[76:79], v[148:151], v[180:183], v[76:79]
  buffer_load_dwordx4 v19, s[36:39], s66 offen offset:1024 lds
  v_mfma_f32_16x16x32_bf16 v[80:83], v[152:155], v[176:179], v[80:83]
  ds_read_b64_tr_b16 v[164:165], v11 offset:32768
  v_mfma_f32_16x16x32_bf16 v[40:43], v[56:59], v[176:179], v[40:43]
  ds_read_b64_tr_b16 v[166:167], v11 offset:33792
  v_mfma_f32_16x16x32_bf16 v[84:87], v[152:155], v[180:183], v[84:87]
  ds_read_b128 v[132:135], v4 offset:34816
  v_mfma_f32_16x16x32_bf16 v[88:91], v[156:159], v[176:179], v[88:91]
  buffer_load_dwordx4 v20, s[36:39], s66 offen offset:2048 lds
  v_mfma_f32_16x16x32_bf16 v[92:95], v[156:159], v[180:183], v[92:95]
  ds_read_b128 v[136:139], v4 offset:36864
  v_mfma_f32_16x16x32_bf16 v[96:99], v[144:147], v[184:187], v[96:99]
  ds_read_b128 v[140:143], v4 offset:38912
  v_mfma_f32_16x16x32_bf16 v[44:47], v[56:59], v[180:183], v[44:47]
  ds_read_b64_tr_b16 v[168:169], v12 offset:32768
  v_mfma_f32_16x16x32_bf16 v[100:103], v[144:147], v[188:191], v[100:103]
  buffer_load_dwordx4 v21, s[36:39], s66 offen offset:3072 lds
  v_mfma_f32_16x16x32_bf16 v[104:107], v[148:151], v[184:187], v[104:107]
  ds_read_b64_tr_b16 v[170:171], v12 offset:33792
  s_add_u32 m0, s67, 32768
  v_mfma_f32_16x16x32_bf16 v[108:111], v[148:151], v[188:191], v[108:111]
  ds_read_b64_tr_b16 v[172:173], v13 offset:32768
  s_movk_i32 s65, 384
  v_mfma_f32_16x16x32_bf16 v[112:115], v[152:155], v[184:187], v[112:115]
  ds_read_b64_tr_b16 v[174:175], v13 offset:33792
  v_mfma_f32_16x16x32_bf16 v[116:119], v[152:155], v[188:191], v[116:119]
  buffer_load_dwordx4 v14, s[32:35], s65 offen offset:0 lds
  v_mfma_f32_16x16x32_bf16 v[120:123], v[156:159], v[184:187], v[120:123]
  buffer_load_dwordx4 v15, s[32:35], s65 offen offset:1024 lds
  v_mfma_f32_16x16x32_bf16 v[124:127], v[156:159], v[188:191], v[124:127]
  buffer_load_dwordx4 v16, s[32:35], s65 offen offset:2048 lds
  s_waitcnt lgkmcnt(9)
  v_mfma_f32_16x16x32_bf16 v[64:67], v[128:131], v[160:163], v[64:67]
  ds_read_b64_tr_b16 v[176:177], v10 offset:40960
  s_waitcnt lgkmcnt(8)
  v_mfma_f32_16x16x32_bf16 v[68:71], v[128:131], v[164:167], v[68:71]
  ds_read_b64_tr_b16 v[178:179], v10 offset:41984
  s_waitcnt lgkmcnt(8)
  v_mfma_f32_16x16x32_bf16 v[72:75], v[132:135], v[160:163], v[72:75]
  ds_read_b128 v[144:147], v5 offset:32768
  v_mfma_f32_16x16x32_bf16 v[76:79], v[132:135], v[164:167], v[76:79]
  buffer_load_dwordx4 v17, s[32:35], s65 offen offset:3072 lds
  s_add_u32 m0, s67, 49152
  s_waitcnt lgkmcnt(8)
  v_mfma_f32_16x16x32_bf16 v[80:83], v[136:139], v[160:163], v[80:83]
  ds_read_b64_tr_b16 v[180:181], v11 offset:40960
  s_mov_b32 s66, 737280
  v_mfma_f32_16x16x32_bf16 v[40:43], v[56:59], v[160:163], v[40:43]
  ds_read_b64_tr_b16 v[182:183], v11 offset:41984
  v_mfma_f32_16x16x32_bf16 v[84:87], v[136:139], v[164:167], v[84:87]
  ds_read_b128 v[148:151], v5 offset:34816
  s_waitcnt lgkmcnt(10)
  v_mfma_f32_16x16x32_bf16 v[88:91], v[140:143], v[160:163], v[88:91]
  buffer_load_dwordx4 v18, s[36:39], s66 offen offset:0 lds
  v_mfma_f32_16x16x32_bf16 v[92:95], v[140:143], v[164:167], v[92:95]
  ds_read_b128 v[152:155], v5 offset:36864
  s_waitcnt lgkmcnt(9)
  v_mfma_f32_16x16x32_bf16 v[96:99], v[128:131], v[168:171], v[96:99]
  ds_read_b128 v[156:159], v5 offset:38912
  v_mfma_f32_16x16x32_bf16 v[44:47], v[56:59], v[164:167], v[44:47]
  ds_read_b64_tr_b16 v[184:185], v12 offset:40960
  s_waitcnt lgkmcnt(9)
  v_mfma_f32_16x16x32_bf16 v[100:103], v[128:131], v[172:175], v[100:103]
  buffer_load_dwordx4 v19, s[36:39], s66 offen offset:1024 lds
  v_mfma_f32_16x16x32_bf16 v[104:107], v[132:135], v[168:171], v[104:107]
  ds_read_b64_tr_b16 v[186:187], v12 offset:41984
  v_mfma_f32_16x16x32_bf16 v[108:111], v[132:135], v[172:175], v[108:111]
  ds_read_b64_tr_b16 v[188:189], v13 offset:40960
  v_mfma_f32_16x16x32_bf16 v[112:115], v[136:139], v[168:171], v[112:115]
  ds_read_b64_tr_b16 v[190:191], v13 offset:41984
  v_mfma_f32_16x16x32_bf16 v[116:119], v[136:139], v[172:175], v[116:119]
  buffer_load_dwordx4 v20, s[36:39], s66 offen offset:2048 lds
  v_mfma_f32_16x16x32_bf16 v[120:123], v[140:143], v[168:171], v[120:123]
  buffer_load_dwordx4 v21, s[36:39], s66 offen offset:3072 lds
  v_mfma_f32_16x16x32_bf16 v[124:127], v[140:143], v[172:175], v[124:127]
  s_add_u32 m0, s67, 65536
  s_movk_i32 s65, 512
  s_waitcnt lgkmcnt(0)
  s_waitcnt vmcnt(8)
  s_barrier
  v_mfma_f32_16x16x32_bf16 v[64:67], v[144:147], v[176:179], v[64:67]
  ds_read_b64_tr_b16 v[160:161], v6 offset:0
  v_mfma_f32_16x16x32_bf16 v[68:71], v[144:147], v[180:183], v[68:71]
  ds_read_b64_tr_b16 v[162:163], v6 offset:1024
  v_mfma_f32_16x16x32_bf16 v[72:75], v[148:151], v[176:179], v[72:75]
  ds_read_b128 v[128:131], v2 offset:0
  v_mfma_f32_16x16x32_bf16 v[76:79], v[148:151], v[180:183], v[76:79]
  buffer_load_dwordx4 v14, s[32:35], s65 offen offset:0 lds
  v_mfma_f32_16x16x32_bf16 v[80:83], v[152:155], v[176:179], v[80:83]
  ds_read_b64_tr_b16 v[164:165], v7 offset:0
  v_mfma_f32_16x16x32_bf16 v[40:43], v[56:59], v[176:179], v[40:43]
  ds_read_b64_tr_b16 v[166:167], v7 offset:1024
  v_mfma_f32_16x16x32_bf16 v[84:87], v[152:155], v[180:183], v[84:87]
  ds_read_b128 v[132:135], v2 offset:2048
  v_mfma_f32_16x16x32_bf16 v[88:91], v[156:159], v[176:179], v[88:91]
  buffer_load_dwordx4 v15, s[32:35], s65 offen offset:1024 lds
  v_mfma_f32_16x16x32_bf16 v[92:95], v[156:159], v[180:183], v[92:95]
  ds_read_b128 v[136:139], v2 offset:4096
  v_mfma_f32_16x16x32_bf16 v[96:99], v[144:147], v[184:187], v[96:99]
  ds_read_b128 v[140:143], v2 offset:6144
  v_mfma_f32_16x16x32_bf16 v[44:47], v[56:59], v[180:183], v[44:47]
  ds_read_b64_tr_b16 v[168:169], v8 offset:0
  v_mfma_f32_16x16x32_bf16 v[100:103], v[144:147], v[188:191], v[100:103]
  buffer_load_dwordx4 v16, s[32:35], s65 offen offset:2048 lds
  v_mfma_f32_16x16x32_bf16 v[104:107], v[148:151], v[184:187], v[104:107]
  ds_read_b64_tr_b16 v[170:171], v8 offset:1024
  v_mfma_f32_16x16x32_bf16 v[108:111], v[148:151], v[188:191], v[108:111]
  ds_read_b64_tr_b16 v[172:173], v9 offset:0
  v_mfma_f32_16x16x32_bf16 v[112:115], v[152:155], v[184:187], v[112:115]
  ds_read_b64_tr_b16 v[174:175], v9 offset:1024
  v_mfma_f32_16x16x32_bf16 v[116:119], v[152:155], v[188:191], v[116:119]
  buffer_load_dwordx4 v17, s[32:35], s65 offen offset:3072 lds
  s_add_u32 m0, s67, 81920
  v_mfma_f32_16x16x32_bf16 v[120:123], v[156:159], v[184:187], v[120:123]
  s_mov_b32 s66, 983040
  v_mfma_f32_16x16x32_bf16 v[124:127], v[156:159], v[188:191], v[124:127]
  buffer_load_dwordx4 v18, s[36:39], s66 offen offset:0 lds
  s_waitcnt lgkmcnt(9)
  v_mfma_f32_16x16x32_bf16 v[64:67], v[128:131], v[160:163], v[64:67]
  ds_read_b64_tr_b16 v[176:177], v6 offset:8192
  s_waitcnt lgkmcnt(8)
  v_mfma_f32_16x16x32_bf16 v[68:71], v[128:131], v[164:167], v[68:71]
  ds_read_b64_tr_b16 v[178:179], v6 offset:9216
  s_waitcnt lgkmcnt(8)
  v_mfma_f32_16x16x32_bf16 v[72:75], v[132:135], v[160:163], v[72:75]
  ds_read_b128 v[144:147], v3 offset:0
  v_mfma_f32_16x16x32_bf16 v[76:79], v[132:135], v[164:167], v[76:79]
  buffer_load_dwordx4 v19, s[36:39], s66 offen offset:1024 lds
  s_waitcnt lgkmcnt(8)
  v_mfma_f32_16x16x32_bf16 v[80:83], v[136:139], v[160:163], v[80:83]
  ds_read_b64_tr_b16 v[180:181], v7 offset:8192
  v_mfma_f32_16x16x32_bf16 v[40:43], v[56:59], v[160:163], v[40:43]
  ds_read_b64_tr_b16 v[182:183], v7 offset:9216
  v_mfma_f32_16x16x32_bf16 v[84:87], v[136:139], v[164:167], v[84:87]
  ds_read_b128 v[148:151], v3 offset:2048
  s_waitcnt lgkmcnt(10)
  v_mfma_f32_16x16x32_bf16 v[88:91], v[140:143], v[160:163], v[88:91]
  buffer_load_dwordx4 v20, s[36:39], s66 offen offset:2048 lds
  v_mfma_f32_16x16x32_bf16 v[92:95], v[140:143], v[164:167], v[92:95]
  ds_read_b128 v[152:155], v3 offset:4096
  s_waitcnt lgkmcnt(9)
  v_mfma_f32_16x16x32_bf16 v[96:99], v[128:131], v[168:171], v[96:99]
  ds_read_b128 v[156:159], v3 offset:6144
  v_mfma_f32_16x16x32_bf16 v[44:47], v[56:59], v[164:167], v[44:47]
  ds_read_b64_tr_b16 v[184:185], v8 offset:8192
  s_waitcnt lgkmcnt(9)
  v_mfma_f32_16x16x32_bf16 v[100:103], v[128:131], v[172:175], v[100:103]
  buffer_load_dwordx4 v21, s[36:39], s66 offen offset:3072 lds
  v_mfma_f32_16x16x32_bf16 v[104:107], v[132:135], v[168:171], v[104:107]
  ds_read_b64_tr_b16 v[186:187], v8 offset:9216
  s_add_u32 m0, s67, 98304
  v_mfma_f32_16x16x32_bf16 v[108:111], v[132:135], v[172:175], v[108:111]
  ds_read_b64_tr_b16 v[188:189], v9 offset:8192
  s_movk_i32 s65, 640
  v_mfma_f32_16x16x32_bf16 v[112:115], v[136:139], v[168:171], v[112:115]
  ds_read_b64_tr_b16 v[190:191], v9 offset:9216
  v_mfma_f32_16x16x32_bf16 v[116:119], v[136:139], v[172:175], v[116:119]
  buffer_load_dwordx4 v14, s[32:35], s65 offen offset:0 lds
  v_mfma_f32_16x16x32_bf16 v[120:123], v[140:143], v[168:171], v[120:123]
  buffer_load_dwordx4 v15, s[32:35], s65 offen offset:1024 lds
  v_mfma_f32_16x16x32_bf16 v[124:127], v[140:143], v[172:175], v[124:127]
  buffer_load_dwordx4 v16, s[32:35], s65 offen offset:2048 lds
  s_waitcnt lgkmcnt(0)
  s_waitcnt vmcnt(11)
  s_barrier
  v_mfma_f32_16x16x32_bf16 v[64:67], v[144:147], v[176:179], v[64:67]
  ds_read_b64_tr_b16 v[160:161], v6 offset:32768
  v_mfma_f32_16x16x32_bf16 v[68:71], v[144:147], v[180:183], v[68:71]
  ds_read_b64_tr_b16 v[162:163], v6 offset:33792
  v_mfma_f32_16x16x32_bf16 v[72:75], v[148:151], v[176:179], v[72:75]
  ds_read_b128 v[128:131], v2 offset:32768
  v_mfma_f32_16x16x32_bf16 v[76:79], v[148:151], v[180:183], v[76:79]
  buffer_load_dwordx4 v17, s[32:35], s65 offen offset:3072 lds
  s_add_u32 m0, s67, 114688
  v_mfma_f32_16x16x32_bf16 v[80:83], v[152:155], v[176:179], v[80:83]
  ds_read_b64_tr_b16 v[164:165], v7 offset:32768
  s_mov_b32 s66, 1228800
  v_mfma_f32_16x16x32_bf16 v[40:43], v[56:59], v[176:179], v[40:43]
  ds_read_b64_tr_b16 v[166:167], v7 offset:33792
  v_mfma_f32_16x16x32_bf16 v[84:87], v[152:155], v[180:183], v[84:87]
  ds_read_b128 v[132:135], v2 offset:34816
  v_mfma_f32_16x16x32_bf16 v[88:91], v[156:159], v[176:179], v[88:91]
  buffer_load_dwordx4 v18, s[36:39], s66 offen offset:0 lds
  v_mfma_f32_16x16x32_bf16 v[92:95], v[156:159], v[180:183], v[92:95]
  ds_read_b128 v[136:139], v2 offset:36864
  v_mfma_f32_16x16x32_bf16 v[96:99], v[144:147], v[184:187], v[96:99]
  ds_read_b128 v[140:143], v2 offset:38912
  v_mfma_f32_16x16x32_bf16 v[44:47], v[56:59], v[180:183], v[44:47]
  ds_read_b64_tr_b16 v[168:169], v8 offset:32768
  v_mfma_f32_16x16x32_bf16 v[100:103], v[144:147], v[188:191], v[100:103]
  buffer_load_dwordx4 v19, s[36:39], s66 offen offset:1024 lds
  v_mfma_f32_16x16x32_bf16 v[104:107], v[148:151], v[184:187], v[104:107]
  ds_read_b64_tr_b16 v[170:171], v8 offset:33792
  v_mfma_f32_16x16x32_bf16 v[108:111], v[148:151], v[188:191], v[108:111]
  ds_read_b64_tr_b16 v[172:173], v9 offset:32768
  v_mfma_f32_16x16x32_bf16 v[112:115], v[152:155], v[184:187], v[112:115]
  ds_read_b64_tr_b16 v[174:175], v9 offset:33792
  v_mfma_f32_16x16x32_bf16 v[116:119], v[152:155], v[188:191], v[116:119]
  buffer_load_dwordx4 v20, s[36:39], s66 offen offset:2048 lds
  v_mfma_f32_16x16x32_bf16 v[120:123], v[156:159], v[184:187], v[120:123]
  buffer_load_dwordx4 v21, s[36:39], s66 offen offset:3072 lds
  v_mfma_f32_16x16x32_bf16 v[124:127], v[156:159], v[188:191], v[124:127]
  s_add_u32 m0, s67, 0
  s_movk_i32 s65, 768
  s_waitcnt lgkmcnt(9)
  v_mfma_f32_16x16x32_bf16 v[64:67], v[128:131], v[160:163], v[64:67]
  ds_read_b64_tr_b16 v[176:177], v6 offset:40960
  s_waitcnt lgkmcnt(8)
  v_mfma_f32_16x16x32_bf16 v[68:71], v[128:131], v[164:167], v[68:71]
  ds_read_b64_tr_b16 v[178:179], v6 offset:41984
  s_waitcnt lgkmcnt(8)
  v_mfma_f32_16x16x32_bf16 v[72:75], v[132:135], v[160:163], v[72:75]
  ds_read_b128 v[144:147], v3 offset:32768
  v_mfma_f32_16x16x32_bf16 v[76:79], v[132:135], v[164:167], v[76:79]
  buffer_load_dwordx4 v14, s[32:35], s65 offen offset:0 lds
  s_waitcnt lgkmcnt(8)
  v_mfma_f32_16x16x32_bf16 v[80:83], v[136:139], v[160:163], v[80:83]
  ds_read_b64_tr_b16 v[180:181], v7 offset:40960
  v_mfma_f32_16x16x32_bf16 v[40:43], v[56:59], v[160:163], v[40:43]
  ds_read_b64_tr_b16 v[182:183], v7 offset:41984
  v_mfma_f32_16x16x32_bf16 v[84:87], v[136:139], v[164:167], v[84:87]
  ds_read_b128 v[148:151], v3 offset:34816
  s_waitcnt lgkmcnt(10)
  v_mfma_f32_16x16x32_bf16 v[88:91], v[140:143], v[160:163], v[88:91]
  buffer_load_dwordx4 v15, s[32:35], s65 offen offset:1024 lds
  v_mfma_f32_16x16x32_bf16 v[92:95], v[140:143], v[164:167], v[92:95]
  ds_read_b128 v[152:155], v3 offset:36864
  s_waitcnt lgkmcnt(9)
  v_mfma_f32_16x16x32_bf16 v[96:99], v[128:131], v[168:171], v[96:99]
  ds_read_b128 v[156:159], v3 offset:38912
  v_mfma_f32_16x16x32_bf16 v[44:47], v[56:59], v[164:167], v[44:47]
  ds_read_b64_tr_b16 v[184:185], v8 offset:40960
  s_waitcnt lgkmcnt(9)
  v_mfma_f32_16x16x32_bf16 v[100:103], v[128:131], v[172:175], v[100:103]
  buffer_load_dwordx4 v16, s[32:35], s65 offen offset:2048 lds
  v_mfma_f32_16x16x32_bf16 v[104:107], v[132:135], v[168:171], v[104:107]
  ds_read_b64_tr_b16 v[186:187], v8 offset:41984
  v_mfma_f32_16x16x32_bf16 v[108:111], v[132:135], v[172:175], v[108:111]
  ds_read_b64_tr_b16 v[188:189], v9 offset:40960
  v_mfma_f32_16x16x32_bf16 v[112:115], v[136:139], v[168:171], v[112:115]
  ds_read_b64_tr_b16 v[190:191], v9 offset:41984
  v_mfma_f32_16x16x32_bf16 v[116:119], v[136:139], v[172:175], v[116:119]
  buffer_load_dwordx4 v17, s[32:35], s65 offen offset:3072 lds
  s_add_u32 m0, s67, 16384
  v_mfma_f32_16x16x32_bf16 v[120:123], v[140:143], v[168:171], v[120:123]
  s_mov_b32 s66, 1474560
  v_mfma_f32_16x16x32_bf16 v[124:127], v[140:143], v[172:175], v[124:127]
  buffer_load_dwordx4 v18, s[36:39], s66 offen offset:0 lds
  s_waitcnt lgkmcnt(0)
  s_waitcnt vmcnt(13)
  s_barrier
  v_mfma_f32_16x16x32_bf16 v[64:67], v[144:147], v[176:179], v[64:67]
  ds_read_b64_tr_b16 v[160:161], v10 offset:0
  v_mfma_f32_16x16x32_bf16 v[68:71], v[144:147], v[180:183], v[68:71]
  ds_read_b64_tr_b16 v[162:163], v10 offset:1024
  v_mfma_f32_16x16x32_bf16 v[72:75], v[148:151], v[176:179], v[72:75]
  ds_read_b128 v[128:131], v4 offset:0
  v_mfma_f32_16x16x32_bf16 v[76:79], v[148:151], v[180:183], v[76:79]
  buffer_load_dwordx4 v19, s[36:39], s66 offen offset:1024 lds
  v_mfma_f32_16x16x32_bf16 v[80:83], v[152:155], v[176:179], v[80:83]
  ds_read_b64_tr_b16 v[164:165], v11 offset:0
  v_mfma_f32_16x16x32_bf16 v[40:43], v[56:59], v[176:179], v[40:43]
  ds_read_b64_tr_b16 v[166:167], v11 offset:1024
  v_mfma_f32_16x16x32_bf16 v[84:87], v[152:155], v[180:183], v[84:87]
  ds_read_b128 v[132:135], v4 offset:2048
  v_mfma_f32_16x16x32_bf16 v[88:91], v[156:159], v[176:179], v[88:91]
  buffer_load_dwordx4 v20, s[36:39], s66 offen offset:2048 lds
  v_mfma_f32_16x16x32_bf16 v[92:95], v[156:159], v[180:183], v[92:95]
  ds_read_b128 v[136:139], v4 offset:4096
  v_mfma_f32_16x16x32_bf16 v[96:99], v[144:147], v[184:187], v[96:99]
  ds_read_b128 v[140:143], v4 offset:6144
  v_mfma_f32_16x16x32_bf16 v[44:47], v[56:59], v[180:183], v[44:47]
  ds_read_b64_tr_b16 v[168:169], v12 offset:0
  v_mfma_f32_16x16x32_bf16 v[100:103], v[144:147], v[188:191], v[100:103]
  buffer_load_dwordx4 v21, s[36:39], s66 offen offset:3072 lds
  v_mfma_f32_16x16x32_bf16 v[104:107], v[148:151], v[184:187], v[104:107]
  ds_read_b64_tr_b16 v[170:171], v12 offset:1024
  s_add_u32 m0, s67, 32768
  v_mfma_f32_16x16x32_bf16 v[108:111], v[148:151], v[188:191], v[108:111]
  ds_read_b64_tr_b16 v[172:173], v13 offset:0
  s_movk_i32 s65, 896
  v_mfma_f32_16x16x32_bf16 v[112:115], v[152:155], v[184:187], v[112:115]
  ds_read_b64_tr_b16 v[174:175], v13 offset:1024
  v_mfma_f32_16x16x32_bf16 v[116:119], v[152:155], v[188:191], v[116:119]
  buffer_load_dwordx4 v14, s[32:35], s65 offen offset:0 lds
  v_mfma_f32_16x16x32_bf16 v[120:123], v[156:159], v[184:187], v[120:123]
  buffer_load_dwordx4 v15, s[32:35], s65 offen offset:1024 lds
  v_mfma_f32_16x16x32_bf16 v[124:127], v[156:159], v[188:191], v[124:127]
  buffer_load_dwordx4 v16, s[32:35], s65 offen offset:2048 lds
  s_waitcnt lgkmcnt(9)
  v_mfma_f32_16x16x32_bf16 v[64:67], v[128:131], v[160:163], v[64:67]
  ds_read_b64_tr_b16 v[176:177], v10 offset:8192
  s_waitcnt lgkmcnt(8)
  v_mfma_f32_16x16x32_bf16 v[68:71], v[128:131], v[164:167], v[68:71]
  ds_read_b64_tr_b16 v[178:179], v10 offset:9216
  s_waitcnt lgkmcnt(8)
  v_mfma_f32_16x16x32_bf16 v[72:75], v[132:135], v[160:163], v[72:75]
  ds_read_b128 v[144:147], v5 offset:0
  v_mfma_f32_16x16x32_bf16 v[76:79], v[132:135], v[164:167], v[76:79]
  buffer_load_dwordx4 v17, s[32:35], s65 offen offset:3072 lds
  s_add_u32 m0, s67, 49152
  s_waitcnt lgkmcnt(8)
  v_mfma_f32_16x16x32_bf16 v[80:83], v[136:139], v[160:163], v[80:83]
  ds_read_b64_tr_b16 v[180:181], v11 offset:8192
  s_mov_b32 s66, 1720320
  v_mfma_f32_16x16x32_bf16 v[40:43], v[56:59], v[160:163], v[40:43]
  ds_read_b64_tr_b16 v[182:183], v11 offset:9216
  v_mfma_f32_16x16x32_bf16 v[84:87], v[136:139], v[164:167], v[84:87]
  ds_read_b128 v[148:151], v5 offset:2048
  s_waitcnt lgkmcnt(10)
  v_mfma_f32_16x16x32_bf16 v[88:91], v[140:143], v[160:163], v[88:91]
  buffer_load_dwordx4 v18, s[36:39], s66 offen offset:0 lds
  v_mfma_f32_16x16x32_bf16 v[92:95], v[140:143], v[164:167], v[92:95]
  ds_read_b128 v[152:155], v5 offset:4096
  s_waitcnt lgkmcnt(9)
  v_mfma_f32_16x16x32_bf16 v[96:99], v[128:131], v[168:171], v[96:99]
  ds_read_b128 v[156:159], v5 offset:6144
  v_mfma_f32_16x16x32_bf16 v[44:47], v[56:59], v[164:167], v[44:47]
  ds_read_b64_tr_b16 v[184:185], v12 offset:8192
  s_waitcnt lgkmcnt(9)
  v_mfma_f32_16x16x32_bf16 v[100:103], v[128:131], v[172:175], v[100:103]
  buffer_load_dwordx4 v19, s[36:39], s66 offen offset:1024 lds
  v_mfma_f32_16x16x32_bf16 v[104:107], v[132:135], v[168:171], v[104:107]
  ds_read_b64_tr_b16 v[186:187], v12 offset:9216
  v_mfma_f32_16x16x32_bf16 v[108:111], v[132:135], v[172:175], v[108:111]
  ds_read_b64_tr_b16 v[188:189], v13 offset:8192
  v_mfma_f32_16x16x32_bf16 v[112:115], v[136:139], v[168:171], v[112:115]
  ds_read_b64_tr_b16 v[190:191], v13 offset:9216
  v_mfma_f32_16x16x32_bf16 v[116:119], v[136:139], v[172:175], v[116:119]
  buffer_load_dwordx4 v20, s[36:39], s66 offen offset:2048 lds
  v_mfma_f32_16x16x32_bf16 v[120:123], v[140:143], v[168:171], v[120:123]
  buffer_load_dwordx4 v21, s[36:39], s66 offen offset:3072 lds
  v_mfma_f32_16x16x32_bf16 v[124:127], v[140:143], v[172:175], v[124:127]
  s_waitcnt lgkmcnt(0)
  s_waitcnt vmcnt(16)
  s_barrier
  v_mfma_f32_16x16x32_bf16 v[64:67], v[144:147], v[176:179], v[64:67]
  ds_read_b64_tr_b16 v[160:161], v10 offset:32768
  s_add_u32 m0, s67, 65536
  v_mfma_f32_16x16x32_bf16 v[68:71], v[144:147], v[180:183], v[68:71]
  ds_read_b64_tr_b16 v[162:163], v10 offset:33792
  s_movk_i32 s65, 1024
  v_mfma_f32_16x16x32_bf16 v[72:75], v[148:151], v[176:179], v[72:75]
  ds_read_b128 v[128:131], v4 offset:32768
  v_mfma_f32_16x16x32_bf16 v[76:79], v[148:151], v[180:183], v[76:79]
  buffer_load_dwordx4 v14, s[32:35], s65 offen offset:0 lds
  v_mfma_f32_16x16x32_bf16 v[80:83], v[152:155], v[176:179], v[80:83]
  ds_read_b64_tr_b16 v[164:165], v11 offset:32768
  v_mfma_f32_16x16x32_bf16 v[40:43], v[56:59], v[176:179], v[40:43]
  ds_read_b64_tr_b16 v[166:167], v11 offset:33792
  v_mfma_f32_16x16x32_bf16 v[84:87], v[152:155], v[180:183], v[84:87]
  ds_read_b128 v[132:135], v4 offset:34816
  v_mfma_f32_16x16x32_bf16 v[88:91], v[156:159], v[176:179], v[88:91]
  buffer_load_dwordx4 v15, s[32:35], s65 offen offset:1024 lds
  v_mfma_f32_16x16x32_bf16 v[92:95], v[156:159], v[180:183], v[92:95]
  ds_read_b128 v[136:139], v4 offset:36864
  v_mfma_f32_16x16x32_bf16 v[96:99], v[144:147], v[184:187], v[96:99]
  ds_read_b128 v[140:143], v4 offset:38912
  v_mfma_f32_16x16x32_bf16 v[44:47], v[56:59], v[180:183], v[44:47]
  ds_read_b64_tr_b16 v[168:169], v12 offset:32768
  v_mfma_f32_16x16x32_bf16 v[100:103], v[144:147], v[188:191], v[100:103]
  buffer_load_dwordx4 v16, s[32:35], s65 offen offset:2048 lds
  v_mfma_f32_16x16x32_bf16 v[104:107], v[148:151], v[184:187], v[104:107]
  ds_read_b64_tr_b16 v[170:171], v12 offset:33792
  v_mfma_f32_16x16x32_bf16 v[108:111], v[148:151], v[188:191], v[108:111]
  ds_read_b64_tr_b16 v[172:173], v13 offset:32768
  v_mfma_f32_16x16x32_bf16 v[112:115], v[152:155], v[184:187], v[112:115]
  ds_read_b64_tr_b16 v[174:175], v13 offset:33792
  v_mfma_f32_16x16x32_bf16 v[116:119], v[152:155], v[188:191], v[116:119]
  buffer_load_dwordx4 v17, s[32:35], s65 offen offset:3072 lds
  s_add_u32 m0, s67, 81920
  v_mfma_f32_16x16x32_bf16 v[120:123], v[156:159], v[184:187], v[120:123]
  s_mov_b32 s66, 1966080
  v_mfma_f32_16x16x32_bf16 v[124:127], v[156:159], v[188:191], v[124:127]
  buffer_load_dwordx4 v18, s[36:39], s66 offen offset:0 lds
  s_waitcnt lgkmcnt(9)
  v_mfma_f32_16x16x32_bf16 v[64:67], v[128:131], v[160:163], v[64:67]
  ds_read_b64_tr_b16 v[176:177], v10 offset:40960
  s_waitcnt lgkmcnt(8)
  v_mfma_f32_16x16x32_bf16 v[68:71], v[128:131], v[164:167], v[68:71]
  ds_read_b64_tr_b16 v[178:179], v10 offset:41984
  s_waitcnt lgkmcnt(8)
  v_mfma_f32_16x16x32_bf16 v[72:75], v[132:135], v[160:163], v[72:75]
  ds_read_b128 v[144:147], v5 offset:32768
  v_mfma_f32_16x16x32_bf16 v[76:79], v[132:135], v[164:167], v[76:79]
  buffer_load_dwordx4 v19, s[36:39], s66 offen offset:1024 lds
  s_waitcnt lgkmcnt(8)
  v_mfma_f32_16x16x32_bf16 v[80:83], v[136:139], v[160:163], v[80:83]
  ds_read_b64_tr_b16 v[180:181], v11 offset:40960
  v_mfma_f32_16x16x32_bf16 v[40:43], v[56:59], v[160:163], v[40:43]
  ds_read_b64_tr_b16 v[182:183], v11 offset:41984
  v_mfma_f32_16x16x32_bf16 v[84:87], v[136:139], v[164:167], v[84:87]
  ds_read_b128 v[148:151], v5 offset:34816
  s_waitcnt lgkmcnt(10)
  v_mfma_f32_16x16x32_bf16 v[88:91], v[140:143], v[160:163], v[88:91]
  buffer_load_dwordx4 v20, s[36:39], s66 offen offset:2048 lds
  v_mfma_f32_16x16x32_bf16 v[92:95], v[140:143], v[164:167], v[92:95]
  ds_read_b128 v[152:155], v5 offset:36864
  s_waitcnt lgkmcnt(9)
  v_mfma_f32_16x16x32_bf16 v[96:99], v[128:131], v[168:171], v[96:99]
  ds_read_b128 v[156:159], v5 offset:38912
  v_mfma_f32_16x16x32_bf16 v[44:47], v[56:59], v[164:167], v[44:47]
  ds_read_b64_tr_b16 v[184:185], v12 offset:40960
  s_waitcnt lgkmcnt(9)
  v_mfma_f32_16x16x32_bf16 v[100:103], v[128:131], v[172:175], v[100:103]
  buffer_load_dwordx4 v21, s[36:39], s66 offen offset:3072 lds
  v_mfma_f32_16x16x32_bf16 v[104:107], v[132:135], v[168:171], v[104:107]
  ds_read_b64_tr_b16 v[186:187], v12 offset:41984
  v_mfma_f32_16x16x32_bf16 v[108:111], v[132:135], v[172:175], v[108:111]
  ds_read_b64_tr_b16 v[188:189], v13 offset:40960
  v_mfma_f32_16x16x32_bf16 v[112:115], v[136:139], v[168:171], v[112:115]
  ds_read_b64_tr_b16 v[190:191], v13 offset:41984
  v_mfma_f32_16x16x32_bf16 v[116:119], v[136:139], v[172:175], v[116:119]
  v_mfma_f32_16x16x32_bf16 v[120:123], v[140:143], v[168:171], v[120:123]
  v_mfma_f32_16x16x32_bf16 v[124:127], v[140:143], v[172:175], v[124:127]
  s_waitcnt lgkmcnt(0)
  s_waitcnt vmcnt(16)
  s_barrier
  v_mfma_f32_16x16x32_bf16 v[64:67], v[144:147], v[176:179], v[64:67]
  ds_read_b64_tr_b16 v[160:161], v6 offset:0
  s_add_u32 m0, s67, 98304
  v_mfma_f32_16x16x32_bf16 v[68:71], v[144:147], v[180:183], v[68:71]
  ds_read_b64_tr_b16 v[162:163], v6 offset:1024
  s_movk_i32 s65, 1152
  v_mfma_f32_16x16x32_bf16 v[72:75], v[148:151], v[176:179], v[72:75]
  ds_read_b128 v[128:131], v2 offset:0
  v_mfma_f32_16x16x32_bf16 v[76:79], v[148:151], v[180:183], v[76:79]
  buffer_load_dwordx4 v14, s[32:35], s65 offen offset:0 lds
  v_mfma_f32_16x16x32_bf16 v[80:83], v[152:155], v[176:179], v[80:83]
  ds_read_b64_tr_b16 v[164:165], v7 offset:0
  v_mfma_f32_16x16x32_bf16 v[40:43], v[56:59], v[176:179], v[40:43]
  ds_read_b64_tr_b16 v[166:167], v7 offset:1024
  v_mfma_f32_16x16x32_bf16 v[84:87], v[152:155], v[180:183], v[84:87]
  ds_read_b128 v[132:135], v2 offset:2048
  v_mfma_f32_16x16x32_bf16 v[88:91], v[156:159], v[176:179], v[88:91]
  buffer_load_dwordx4 v15, s[32:35], s65 offen offset:1024 lds
  v_mfma_f32_16x16x32_bf16 v[92:95], v[156:159], v[180:183], v[92:95]
  ds_read_b128 v[136:139], v2 offset:4096
  v_mfma_f32_16x16x32_bf16 v[96:99], v[144:147], v[184:187], v[96:99]
  ds_read_b128 v[140:143], v2 offset:6144
  v_mfma_f32_16x16x32_bf16 v[44:47], v[56:59], v[180:183], v[44:47]
  ds_read_b64_tr_b16 v[168:169], v8 offset:0
  v_mfma_f32_16x16x32_bf16 v[100:103], v[144:147], v[188:191], v[100:103]
  buffer_load_dwordx4 v16, s[32:35], s65 offen offset:2048 lds
  v_mfma_f32_16x16x32_bf16 v[104:107], v[148:151], v[184:187], v[104:107]
  ds_read_b64_tr_b16 v[170:171], v8 offset:1024
  v_mfma_f32_16x16x32_bf16 v[108:111], v[148:151], v[188:191], v[108:111]
  ds_read_b64_tr_b16 v[172:173], v9 offset:0
  v_mfma_f32_16x16x32_bf16 v[112:115], v[152:155], v[184:187], v[112:115]
  ds_read_b64_tr_b16 v[174:175], v9 offset:1024
  v_mfma_f32_16x16x32_bf16 v[116:119], v[152:155], v[188:191], v[116:119]
  buffer_load_dwordx4 v17, s[32:35], s65 offen offset:3072 lds
  s_add_u32 m0, s67, 114688
  v_mfma_f32_16x16x32_bf16 v[120:123], v[156:159], v[184:187], v[120:123]
  s_mov_b32 s66, 2211840
  v_mfma_f32_16x16x32_bf16 v[124:127], v[156:159], v[188:191], v[124:127]
  buffer_load_dwordx4 v18, s[36:39], s66 offen offset:0 lds
  s_waitcnt lgkmcnt(9)
  v_mfma_f32_16x16x32_bf16 v[64:67], v[128:131], v[160:163], v[64:67]
  ds_read_b64_tr_b16 v[176:177], v6 offset:8192
  s_waitcnt lgkmcnt(8)
  v_mfma_f32_16x16x32_bf16 v[68:71], v[128:131], v[164:167], v[68:71]
  ds_read_b64_tr_b16 v[178:179], v6 offset:9216
  s_waitcnt lgkmcnt(8)
  v_mfma_f32_16x16x32_bf16 v[72:75], v[132:135], v[160:163], v[72:75]
  ds_read_b128 v[144:147], v3 offset:0
  v_mfma_f32_16x16x32_bf16 v[76:79], v[132:135], v[164:167], v[76:79]
  buffer_load_dwordx4 v19, s[36:39], s66 offen offset:1024 lds
  s_waitcnt lgkmcnt(8)
  v_mfma_f32_16x16x32_bf16 v[80:83], v[136:139], v[160:163], v[80:83]
  ds_read_b64_tr_b16 v[180:181], v7 offset:8192
  v_mfma_f32_16x16x32_bf16 v[40:43], v[56:59], v[160:163], v[40:43]
  ds_read_b64_tr_b16 v[182:183], v7 offset:9216
  v_mfma_f32_16x16x32_bf16 v[84:87], v[136:139], v[164:167], v[84:87]
  ds_read_b128 v[148:151], v3 offset:2048
  s_waitcnt lgkmcnt(10)
  v_mfma_f32_16x16x32_bf16 v[88:91], v[140:143], v[160:163], v[88:91]
  buffer_load_dwordx4 v20, s[36:39], s66 offen offset:2048 lds
  v_mfma_f32_16x16x32_bf16 v[92:95], v[140:143], v[164:167], v[92:95]
  ds_read_b128 v[152:155], v3 offset:4096
  s_waitcnt lgkmcnt(9)
  v_mfma_f32_16x16x32_bf16 v[96:99], v[128:131], v[168:171], v[96:99]
  ds_read_b128 v[156:159], v3 offset:6144
  v_mfma_f32_16x16x32_bf16 v[44:47], v[56:59], v[164:167], v[44:47]
  ds_read_b64_tr_b16 v[184:185], v8 offset:8192
  s_waitcnt lgkmcnt(9)
  v_mfma_f32_16x16x32_bf16 v[100:103], v[128:131], v[172:175], v[100:103]
  buffer_load_dwordx4 v21, s[36:39], s66 offen offset:3072 lds
  v_mfma_f32_16x16x32_bf16 v[104:107], v[132:135], v[168:171], v[104:107]
  ds_read_b64_tr_b16 v[186:187], v8 offset:9216
  v_mfma_f32_16x16x32_bf16 v[108:111], v[132:135], v[172:175], v[108:111]
  ds_read_b64_tr_b16 v[188:189], v9 offset:8192
  v_mfma_f32_16x16x32_bf16 v[112:115], v[136:139], v[168:171], v[112:115]
  ds_read_b64_tr_b16 v[190:191], v9 offset:9216
  v_mfma_f32_16x16x32_bf16 v[116:119], v[136:139], v[172:175], v[116:119]
  v_mfma_f32_16x16x32_bf16 v[120:123], v[140:143], v[168:171], v[120:123]
  v_mfma_f32_16x16x32_bf16 v[124:127], v[140:143], v[172:175], v[124:127]
  s_waitcnt lgkmcnt(0)
  s_waitcnt vmcnt(16)
  s_barrier
  v_mfma_f32_16x16x32_bf16 v[64:67], v[144:147], v[176:179], v[64:67]
  ds_read_b64_tr_b16 v[160:161], v6 offset:32768
  v_mfma_f32_16x16x32_bf16 v[68:71], v[144:147], v[180:183], v[68:71]
  ds_read_b64_tr_b16 v[162:163], v6 offset:33792
  v_mfma_f32_16x16x32_bf16 v[72:75], v[148:151], v[176:179], v[72:75]
  ds_read_b128 v[128:131], v2 offset:32768
  v_mfma_f32_16x16x32_bf16 v[76:79], v[148:151], v[180:183], v[76:79]
  v_mfma_f32_16x16x32_bf16 v[80:83], v[152:155], v[176:179], v[80:83]
  ds_read_b64_tr_b16 v[164:165], v7 offset:32768
  v_mfma_f32_16x16x32_bf16 v[40:43], v[56:59], v[176:179], v[40:43]
  ds_read_b64_tr_b16 v[166:167], v7 offset:33792
  v_mfma_f32_16x16x32_bf16 v[84:87], v[152:155], v[180:183], v[84:87]
  ds_read_b128 v[132:135], v2 offset:34816
  v_mfma_f32_16x16x32_bf16 v[88:91], v[156:159], v[176:179], v[88:91]
  v_mfma_f32_16x16x32_bf16 v[92:95], v[156:159], v[180:183], v[92:95]
  ds_read_b128 v[136:139], v2 offset:36864
  v_mfma_f32_16x16x32_bf16 v[96:99], v[144:147], v[184:187], v[96:99]
  ds_read_b128 v[140:143], v2 offset:38912
  v_mfma_f32_16x16x32_bf16 v[44:47], v[56:59], v[180:183], v[44:47]
  ds_read_b64_tr_b16 v[168:169], v8 offset:32768
  v_mfma_f32_16x16x32_bf16 v[100:103], v[144:147], v[188:191], v[100:103]
  v_mfma_f32_16x16x32_bf16 v[104:107], v[148:151], v[184:187], v[104:107]
  ds_read_b64_tr_b16 v[170:171], v8 offset:33792
  v_mfma_f32_16x16x32_bf16 v[108:111], v[148:151], v[188:191], v[108:111]
  ds_read_b64_tr_b16 v[172:173], v9 offset:32768
  v_mfma_f32_16x16x32_bf16 v[112:115], v[152:155], v[184:187], v[112:115]
  ds_read_b64_tr_b16 v[174:175], v9 offset:33792
  v_mfma_f32_16x16x32_bf16 v[116:119], v[152:155], v[188:191], v[116:119]
  v_mfma_f32_16x16x32_bf16 v[120:123], v[156:159], v[184:187], v[120:123]
  v_mfma_f32_16x16x32_bf16 v[124:127], v[156:159], v[188:191], v[124:127]
  buffer_load_dwordx4 v[36:39], v28, s[28:31], 0 offen sc1
  s_lshl2_add_u32 s17, s60, s58
  v_min_u32 v61, 6, v1
  s_mul_i32 s17, s17, 896
  v_lshlrev_b32 v61, 7, v61
  buffer_load_dword v61, v61, s[40:43], s17 offen
  s_mul_i32 s17, s12, 44
  v_min_u32 v60, 43, v1
  s_add_u32 s17, s17, 0
  v_add_u32 v60, s17, v60
  v_mul_u32_u24 v60, 3456, v60
  buffer_load_dword v60, v60, s[44:47], s6 offen
  s_waitcnt lgkmcnt(9)
  v_mfma_f32_16x16x32_bf16 v[64:67], v[128:131], v[160:163], v[64:67]
  ds_read_b64_tr_b16 v[176:177], v6 offset:40960
  s_waitcnt lgkmcnt(8)
  v_mfma_f32_16x16x32_bf16 v[68:71], v[128:131], v[164:167], v[68:71]
  ds_read_b64_tr_b16 v[178:179], v6 offset:41984
  s_waitcnt lgkmcnt(8)
  v_mfma_f32_16x16x32_bf16 v[72:75], v[132:135], v[160:163], v[72:75]
  ds_read_b128 v[144:147], v3 offset:32768
  v_mfma_f32_16x16x32_bf16 v[76:79], v[132:135], v[164:167], v[76:79]
  s_waitcnt lgkmcnt(8)
  v_mfma_f32_16x16x32_bf16 v[80:83], v[136:139], v[160:163], v[80:83]
  ds_read_b64_tr_b16 v[180:181], v7 offset:40960
  v_mfma_f32_16x16x32_bf16 v[40:43], v[56:59], v[160:163], v[40:43]
  ds_read_b64_tr_b16 v[182:183], v7 offset:41984
  v_mfma_f32_16x16x32_bf16 v[84:87], v[136:139], v[164:167], v[84:87]
  ds_read_b128 v[148:151], v3 offset:34816
  s_waitcnt lgkmcnt(10)
  v_mfma_f32_16x16x32_bf16 v[88:91], v[140:143], v[160:163], v[88:91]
  v_mfma_f32_16x16x32_bf16 v[92:95], v[140:143], v[164:167], v[92:95]
  ds_read_b128 v[152:155], v3 offset:36864
  s_waitcnt lgkmcnt(9)
  v_mfma_f32_16x16x32_bf16 v[96:99], v[128:131], v[168:171], v[96:99]
  ds_read_b128 v[156:159], v3 offset:38912
  v_mfma_f32_16x16x32_bf16 v[44:47], v[56:59], v[164:167], v[44:47]
  ds_read_b64_tr_b16 v[184:185], v8 offset:40960
  s_waitcnt lgkmcnt(9)
  v_mfma_f32_16x16x32_bf16 v[100:103], v[128:131], v[172:175], v[100:103]
  v_mfma_f32_16x16x32_bf16 v[104:107], v[132:135], v[168:171], v[104:107]
  ds_read_b64_tr_b16 v[186:187], v8 offset:41984
  v_mfma_f32_16x16x32_bf16 v[108:111], v[132:135], v[172:175], v[108:111]
  ds_read_b64_tr_b16 v[188:189], v9 offset:40960
  v_mfma_f32_16x16x32_bf16 v[112:115], v[136:139], v[168:171], v[112:115]
  ds_read_b64_tr_b16 v[190:191], v9 offset:41984
  v_mfma_f32_16x16x32_bf16 v[116:119], v[136:139], v[172:175], v[116:119]
  v_mfma_f32_16x16x32_bf16 v[120:123], v[140:143], v[168:171], v[120:123]
  v_mfma_f32_16x16x32_bf16 v[124:127], v[140:143], v[172:175], v[124:127]
  s_waitcnt lgkmcnt(0)
  s_waitcnt vmcnt(11)
  s_barrier
  v_mfma_f32_16x16x32_bf16 v[64:67], v[144:147], v[176:179], v[64:67]
  ds_read_b64_tr_b16 v[160:161], v10 offset:0
  v_mfma_f32_16x16x32_bf16 v[68:71], v[144:147], v[180:183], v[68:71]
  ds_read_b64_tr_b16 v[162:163], v10 offset:1024
  v_mfma_f32_16x16x32_bf16 v[72:75], v[148:151], v[176:179], v[72:75]
  ds_read_b128 v[128:131], v4 offset:0
  v_mfma_f32_16x16x32_bf16 v[76:79], v[148:151], v[180:183], v[76:79]
  v_mfma_f32_16x16x32_bf16 v[80:83], v[152:155], v[176:179], v[80:83]
  ds_read_b64_tr_b16 v[164:165], v11 offset:0
  v_mfma_f32_16x16x32_bf16 v[40:43], v[56:59], v[176:179], v[40:43]
  ds_read_b64_tr_b16 v[166:167], v11 offset:1024
  v_mfma_f32_16x16x32_bf16 v[84:87], v[152:155], v[180:183], v[84:87]
  ds_read_b128 v[132:135], v4 offset:2048
  v_mfma_f32_16x16x32_bf16 v[88:91], v[156:159], v[176:179], v[88:91]
  v_mfma_f32_16x16x32_bf16 v[92:95], v[156:159], v[180:183], v[92:95]
  ds_read_b128 v[136:139], v4 offset:4096
  v_mfma_f32_16x16x32_bf16 v[96:99], v[144:147], v[184:187], v[96:99]
  ds_read_b128 v[140:143], v4 offset:6144
  v_mfma_f32_16x16x32_bf16 v[44:47], v[56:59], v[180:183], v[44:47]
  ds_read_b64_tr_b16 v[168:169], v12 offset:0
  v_mfma_f32_16x16x32_bf16 v[100:103], v[144:147], v[188:191], v[100:103]
  v_mfma_f32_16x16x32_bf16 v[104:107], v[148:151], v[184:187], v[104:107]
  ds_read_b64_tr_b16 v[170:171], v12 offset:1024
  v_mfma_f32_16x16x32_bf16 v[108:111], v[148:151], v[188:191], v[108:111]
  ds_read_b64_tr_b16 v[172:173], v13 offset:0
  v_mfma_f32_16x16x32_bf16 v[112:115], v[152:155], v[184:187], v[112:115]
  ds_read_b64_tr_b16 v[174:175], v13 offset:1024
  v_mfma_f32_16x16x32_bf16 v[116:119], v[152:155], v[188:191], v[116:119]
  v_mfma_f32_16x16x32_bf16 v[120:123], v[156:159], v[184:187], v[120:123]
  v_mfma_f32_16x16x32_bf16 v[124:127], v[156:159], v[188:191], v[124:127]
  s_waitcnt vmcnt(2)
  v_cmp_ne_u32 vcc, s59, v38
  s_cbranch_vccz Ld4
Lp3:
  buffer_load_dwordx4 v[36:39], v28, s[28:31], 0 offen sc1
  s_waitcnt vmcnt(0) lgkmcnt(0)
  v_cmp_ne_u32 vcc, s59, v38
  s_cbranch_vccz Ld4
  s_sub_u32 s61, s61, 1
  s_cbranch_scc0 Lp3
  s_branch Lexit
Ld4:
  v_mul_f32 v36, s68, v36
  ds_write2_b32 v29, v36, v37 offset1:128
  s_waitcnt lgkmcnt(10)
  v_mfma_f32_16x16x32_bf16 v[64:67], v[128:131], v[160:163], v[64:67]
  ds_read_b64_tr_b16 v[176:177], v10 offset:8192
  s_waitcnt lgkmcnt(9)
  v_mfma_f32_16x16x32_bf16 v[68:71], v[128:131], v[164:167], v[68:71]
  ds_read_b64_tr_b16 v[178:179], v10 offset:9216
  s_waitcnt lgkmcnt(9)
  v_mfma_f32_16x16x32_bf16 v[72:75], v[132:135], v[160:163], v[72:75]
  ds_read_b128 v[144:147], v5 offset:0
  v_mfma_f32_16x16x32_bf16 v[76:79], v[132:135], v[164:167], v[76:79]
  s_waitcnt lgkmcnt(9)
  v_mfma_f32_16x16x32_bf16 v[80:83], v[136:139], v[160:163], v[80:83]
  ds_read_b64_tr_b16 v[180:181], v11 offset:8192
  v_mfma_f32_16x16x32_bf16 v[40:43], v[56:59], v[160:163], v[40:43]
  ds_read_b64_tr_b16 v[182:183], v11 offset:9216
  v_mfma_f32_16x16x32_bf16 v[84:87], v[136:139], v[164:167], v[84:87]
  ds_read_b128 v[148:151], v5 offset:2048
  s_waitcnt lgkmcnt(11)
  v_mfma_f32_16x16x32_bf16 v[88:91], v[140:143], v[160:163], v[88:91]
  v_mfma_f32_16x16x32_bf16 v[92:95], v[140:143], v[164:167], v[92:95]
  ds_read_b128 v[152:155], v5 offset:4096
  s_waitcnt lgkmcnt(10)
  v_mfma_f32_16x16x32_bf16 v[96:99], v[128:131], v[168:171], v[96:99]
  ds_read_b128 v[156:159], v5 offset:6144
  v_mfma_f32_16x16x32_bf16 v[44:47], v[56:59], v[164:167], v[44:47]
  ds_read_b64_tr_b16 v[184:185], v12 offset:8192
  s_waitcnt lgkmcnt(10)
  v_mfma_f32_16x16x32_bf16 v[100:103], v[128:131], v[172:175], v[100:103]
  v_mfma_f32_16x16x32_bf16 v[104:107], v[132:135], v[168:171], v[104:107]
  ds_read_b64_tr_b16 v[186:187], v12 offset:9216
  ds_write_b128 v30, v[40:43] offset:0
  v_mfma_f32_16x16x32_bf16 v[108:111], v[132:135], v[172:175], v[108:111]
  ds_read_b64_tr_b16 v[188:189], v13 offset:8192
  v_mfma_f32_16x16x32_bf16 v[112:115], v[136:139], v[168:171], v[112:115]
  ds_read_b64_tr_b16 v[190:191], v13 offset:9216
  ds_write_b128 v30, v[44:47] offset:1024
  v_mfma_f32_16x16x32_bf16 v[116:119], v[136:139], v[172:175], v[116:119]
  v_mfma_f32_16x16x32_bf16 v[120:123], v[140:143], v[168:171], v[120:123]
  v_mfma_f32_16x16x32_bf16 v[124:127], v[140:143], v[172:175], v[124:127]
  s_waitcnt lgkmcnt(0)
  s_barrier
  v_mfma_f32_16x16x32_bf16 v[64:67], v[144:147], v[176:179], v[64:67]
  ds_read_b128 v[48:51], v32 offset:0
  ds_read_b128 v[52:55], v32 offset:1024
  v_mfma_f32_16x16x32_bf16 v[68:71], v[144:147], v[180:183], v[68:71]
  ds_read_b64_tr_b16 v[160:161], v10 offset:32768
  ds_read_b64_tr_b16 v[162:163], v10 offset:33792
  v_mfma_f32_16x16x32_bf16 v[72:75], v[148:151], v[176:179], v[72:75]
  ds_read_b64_tr_b16 v[164:165], v11 offset:32768
  ds_read_b64_tr_b16 v[166:167], v11 offset:33792
  v_mfma_f32_16x16x32_bf16 v[76:79], v[148:151], v[180:183], v[76:79]
  ds_read_b64_tr_b16 v[168:169], v12 offset:32768
  ds_read_b64_tr_b16 v[170:171], v12 offset:33792
  v_mfma_f32_16x16x32_bf16 v[80:83], v[152:155], v[176:179], v[80:83]
  ds_read_b64_tr_b16 v[172:173], v13 offset:32768
  ds_read_b64_tr_b16 v[174:175], v13 offset:33792
  v_mfma_f32_16x16x32_bf16 v[84:87], v[152:155], v[180:183], v[84:87]
  ds_read_b64_tr_b16 v[208:209], v10 offset:40960
  ds_read_b64_tr_b16 v[210:211], v10 offset:41984
  v_mfma_f32_16x16x32_bf16 v[88:91], v[156:159], v[176:179], v[88:91]
  ds_read_b64_tr_b16 v[212:213], v11 offset:40960
  ds_read_b64_tr_b16 v[214:215], v11 offset:41984
  v_mfma_f32_16x16x32_bf16 v[92:95], v[156:159], v[180:183], v[92:95]
  ds_read_b64_tr_b16 v[216:217], v12 offset:40960
  ds_read_b64_tr_b16 v[218:219], v12 offset:41984
  v_mfma_f32_16x16x32_bf16 v[40:43], v[56:59], v[176:179], v[40:43]
  ds_read_b64_tr_b16 v[220:221], v13 offset:40960
  ds_read_b64_tr_b16 v[222:223], v13 offset:41984
  v_mfma_f32_16x16x32_bf16 v[44:47], v[56:59], v[180:183], v[44:47]
  ds_read_b128 v[224:227], v33 offset:512
  ds_read_b128 v[228:231], v33 offset:576
  s_waitcnt lgkmcnt(15)
  v_mfma_f32_16x16x32_bf16 v[48:51], v[56:59], v[184:187], v[48:51]
  ds_read_b128 v[232:235], v33 offset:640
  ds_read_b128 v[236:239], v33 offset:704
  v_mfma_f32_16x16x32_bf16 v[52:55], v[56:59], v[188:191], v[52:55]
  ds_read_b128 v[128:131], v4 offset:32768
  v_mfma_f32_16x16x32_bf16 v[40:43], v[56:59], v[160:163], v[40:43]
  ds_read_b128 v[192:195], v5 offset:32768
  s_waitcnt lgkmcnt(15)
  v_mfma_f32_16x16x32_bf16 v[44:47], v[56:59], v[164:167], v[44:47]
  ds_read_b128 v[132:135], v4 offset:34816
  v_mfma_f32_16x16x32_bf16 v[48:51], v[56:59], v[168:171], v[48:51]
  ds_read_b128 v[196:199], v5 offset:34816
  s_waitcnt lgkmcnt(15)
  v_mfma_f32_16x16x32_bf16 v[52:55], v[56:59], v[172:175], v[52:55]
  ds_read_b128 v[136:139], v4 offset:36864
  s_waitcnt lgkmcnt(15)
  v_mfma_f32_16x16x32_bf16 v[40:43], v[56:59], v[208:211], v[40:43]
  ds_read_b128 v[200:203], v5 offset:36864
  s_waitcnt lgkmcnt(14)
  v_mfma_f32_16x16x32_bf16 v[44:47], v[56:59], v[212:215], v[44:47]
  ds_read_b128 v[140:143], v4 offset:38912
  s_waitcnt lgkmcnt(13)
  v_mfma_f32_16x16x32_bf16 v[48:51], v[56:59], v[216:219], v[48:51]
  ds_read_b128 v[204:207], v5 offset:38912
  s_waitcnt lgkmcnt(12)
  v_mfma_f32_16x16x32_bf16 v[52:55], v[56:59], v[220:223], v[52:55]
  v_mfma_f32_16x16x32_bf16 v[96:99], v[144:147], v[184:187], v[96:99]
  s_waitcnt lgkmcnt(11)
  v_fmac_f32 v64, v40, v224
  v_fmac_f32 v65, v40, v225
  v_fmac_f32 v66, v40, v226
  v_fmac_f32 v67, v40, v227
  v_mfma_f32_16x16x32_bf16 v[100:103], v[144:147], v[188:191], v[100:103]
  v_fmac_f32 v68, v44, v224
  v_fmac_f32 v69, v44, v225
  v_fmac_f32 v70, v44, v226
  v_fmac_f32 v71, v44, v227
  v_mfma_f32_16x16x32_bf16 v[104:107], v[148:151], v[184:187], v[104:107]
  s_waitcnt lgkmcnt(10)
  v_fmac_f32 v72, v40, v228
  v_fmac_f32 v73, v40, v229
  v_fmac_f32 v74, v40, v230
  v_fmac_f32 v75, v40, v231
  v_mfma_f32_16x16x32_bf16 v[108:111], v[148:151], v[188:191], v[108:111]
  v_fmac_f32 v76, v44, v228
  v_fmac_f32 v77, v44, v229
  v_fmac_f32 v78, v44, v230
  v_fmac_f32 v79, v44, v231
  v_mfma_f32_16x16x32_bf16 v[112:115], v[152:155], v[184:187], v[112:115]
  s_waitcnt lgkmcnt(9)
  v_fmac_f32 v80, v40, v232
  v_fmac_f32 v81, v40, v233
  v_fmac_f32 v82, v40, v234
  v_fmac_f32 v83, v40, v235
  v_mfma_f32_16x16x32_bf16 v[116:119], v[152:155], v[188:191], v[116:119]
  v_fmac_f32 v84, v44, v232
  v_fmac_f32 v85, v44, v233
  v_fmac_f32 v86, v44, v234
  v_fmac_f32 v87, v44, v235
  v_mfma_f32_16x16x32_bf16 v[120:123], v[156:159], v[184:187], v[120:123]
  s_waitcnt lgkmcnt(8)
  v_fmac_f32 v88, v40, v236
  v_fmac_f32 v89, v40, v237
  v_fmac_f32 v90, v40, v238
  v_fmac_f32 v91, v40, v239
  v_mfma_f32_16x16x32_bf16 v[124:127], v[156:159], v[188:191], v[124:127]
  v_fmac_f32 v92, v44, v236
  v_fmac_f32 v93, v44, v237
  v_fmac_f32 v94, v44, v238
  v_fmac_f32 v95, v44, v239
  s_waitcnt lgkmcnt(7)
  v_mfma_f32_16x16x32_bf16 v[64:67], v[128:131], v[160:163], v[64:67]
  ds_read_b128 v[144:147], v33 offset:0
  ds_read_b128 v[148:151], v33 offset:64
  v_mfma_f32_16x16x32_bf16 v[68:71], v[128:131], v[164:167], v[68:71]
  ds_read_b128 v[152:155], v33 offset:128
  ds_read_b128 v[156:159], v33 offset:192
  v_fmac_f32 v96, v48, v224
  v_fmac_f32 v97, v48, v225
  v_fmac_f32 v98, v48, v226
  v_fmac_f32 v99, v48, v227
  s_waitcnt lgkmcnt(10)
  v_mfma_f32_16x16x32_bf16 v[64:67], v[192:195], v[208:211], v[64:67]
  v_fmac_f32 v100, v52, v224
  v_fmac_f32 v101, v52, v225
  v_fmac_f32 v102, v52, v226
  v_fmac_f32 v103, v52, v227
  v_mfma_f32_16x16x32_bf16 v[68:71], v[192:195], v[212:215], v[68:71]
  v_fmac_f32 v104, v48, v228
  v_fmac_f32 v105, v48, v229
  v_fmac_f32 v106, v48, v230
  v_fmac_f32 v107, v48, v231
  s_waitcnt lgkmcnt(9)
  v_mfma_f32_16x16x32_bf16 v[72:75], v[132:135], v[160:163], v[72:75]
  v_fmac_f32 v108, v52, v228
  v_fmac_f32 v109, v52, v229
  v_fmac_f32 v110, v52, v230
  v_fmac_f32 v111, v52, v231
  v_mfma_f32_16x16x32_bf16 v[76:79], v[132:135], v[164:167], v[76:79]
  v_fmac_f32 v112, v48, v232
  v_fmac_f32 v113, v48, v233
  v_fmac_f32 v114, v48, v234
  v_fmac_f32 v115, v48, v235
  s_waitcnt lgkmcnt(8)
  v_mfma_f32_16x16x32_bf16 v[72:75], v[196:199], v[208:211], v[72:75]
  v_fmac_f32 v116, v52, v232
  v_fmac_f32 v117, v52, v233
  v_fmac_f32 v118, v52, v234
  v_fmac_f32 v119, v52, v235
  v_mfma_f32_16x16x32_bf16 v[76:79], v[196:199], v[212:215], v[76:79]
  s_waitcnt lgkmcnt(3)
  v_mul_f32 v64, v64, v144
  v_mul_f32 v65, v65, v145
  v_mul_f32 v68, v68, v144
  v_mul_f32 v69, v69, v145
  v_mfma_f32_16x16x32_bf16 v[80:83], v[136:139], v[160:163], v[80:83]
  v_mul_f32 v66, v66, v146
  v_mul_f32 v67, v67, v147
  v_cvt_pk_bf16_f32 v64, v64, v65
  v_mul_f32 v70, v70, v146
  v_mfma_f32_16x16x32_bf16 v[84:87], v[136:139], v[164:167], v[84:87]
  v_mul_f32 v71, v71, v147
  v_cvt_pk_bf16_f32 v65, v66, v67
  v_cvt_pk_bf16_f32 v66, v68, v69
  v_cvt_pk_bf16_f32 v67, v70, v71
  v_mfma_f32_16x16x32_bf16 v[80:83], v[200:203], v[208:211], v[80:83]
  v_permlane16_swap_b32 v64, v66
  v_permlane16_swap_b32 v65, v67
  buffer_store_dwordx4 v[64:67], v31, s[28:31], s72 offen sc1
  v_fmac_f32 v120, v48, v236
  v_mfma_f32_16x16x32_bf16 v[84:87], v[200:203], v[212:215], v[84:87]
  v_fmac_f32 v121, v48, v237
  v_fmac_f32 v122, v48, v238
  v_fmac_f32 v123, v48, v239
  v_fmac_f32 v124, v52, v236
  v_mfma_f32_16x16x32_bf16 v[88:91], v[140:143], v[160:163], v[88:91]
  v_fmac_f32 v125, v52, v237
  v_fmac_f32 v126, v52, v238
  v_fmac_f32 v127, v52, v239
  s_waitcnt lgkmcnt(2)
  v_mul_f32 v72, v72, v148
  v_mfma_f32_16x16x32_bf16 v[92:95], v[140:143], v[164:167], v[92:95]
  v_mul_f32 v73, v73, v149
  v_mul_f32 v76, v76, v148
  v_mul_f32 v77, v77, v149
  v_mul_f32 v74, v74, v150
  v_mfma_f32_16x16x32_bf16 v[88:91], v[204:207], v[208:211], v[88:91]
  v_mul_f32 v75, v75, v151
  v_cvt_pk_bf16_f32 v72, v72, v73
  v_mul_f32 v78, v78, v150
  v_mul_f32 v79, v79, v151
  v_mfma_f32_16x16x32_bf16 v[92:95], v[204:207], v[212:215], v[92:95]
  v_cvt_pk_bf16_f32 v73, v74, v75
  v_cvt_pk_bf16_f32 v74, v76, v77
  v_cvt_pk_bf16_f32 v75, v78, v79
  s_nop 0
  v_permlane16_swap_b32 v72, v74
  v_mfma_f32_16x16x32_bf16 v[96:99], v[128:131], v[168:171], v[96:99]
  v_permlane16_swap_b32 v73, v75
  buffer_store_dwordx4 v[72:75], v31, s[28:31], s73 offen sc1
  s_waitcnt lgkmcnt(1)
  v_mul_f32 v80, v80, v152
  v_mul_f32 v81, v81, v153
  v_mfma_f32_16x16x32_bf16 v[100:103], v[128:131], v[172:175], v[100:103]
  v_mul_f32 v84, v84, v152
  v_mul_f32 v85, v85, v153
  v_mul_f32 v82, v82, v154
  v_mul_f32 v83, v83, v155
  v_mfma_f32_16x16x32_bf16 v[96:99], v[192:195], v[216:219], v[96:99]
  v_cvt_pk_bf16_f32 v80, v80, v81
  v_mul_f32 v86, v86, v154
  v_mul_f32 v87, v87, v155
  v_cvt_pk_bf16_f32 v81, v82, v83
  v_mfma_f32_16x16x32_bf16 v[100:103], v[192:195], v[220:223], v[100:103]
  v_cvt_pk_bf16_f32 v82, v84, v85
  v_cvt_pk_bf16_f32 v83, v86, v87
  s_nop 0
  v_permlane16_swap_b32 v80, v82
  v_permlane16_swap_b32 v81, v83
  v_mfma_f32_16x16x32_bf16 v[104:107], v[132:135], v[168:171], v[104:107]
  buffer_store_dwordx4 v[80:83], v31, s[28:31], s74 offen sc1
  s_waitcnt lgkmcnt(0)
  v_mul_f32 v88, v88, v156
  v_mul_f32 v89, v89, v157
  v_mul_f32 v92, v92, v156
  v_mfma_f32_16x16x32_bf16 v[108:111], v[132:135], v[172:175], v[108:111]
  v_mul_f32 v93, v93, v157
  v_mul_f32 v90, v90, v158
  v_mul_f32 v91, v91, v159
  v_cvt_pk_bf16_f32 v88, v88, v89
  v_mfma_f32_16x16x32_bf16 v[104:107], v[196:199], v[216:219], v[104:107]
  v_mul_f32 v94, v94, v158
  v_mul_f32 v95, v95, v159
  v_cvt_pk_bf16_f32 v89, v90, v91
  v_cvt_pk_bf16_f32 v90, v92, v93
  v_mfma_f32_16x16x32_bf16 v[108:111], v[196:199], v[220:223], v[108:111]
  v_cvt_pk_bf16_f32 v91, v94, v95
  v_permlane16_swap_b32 v88, v90
  s_nop 0
  v_permlane16_swap_b32 v89, v91
  buffer_store_dwordx4 v[88:91], v31, s[28:31], s75 offen sc1
  v_mfma_f32_16x16x32_bf16 v[112:115], v[136:139], v[168:171], v[112:115]
  v_mul_f32 v96, v96, v144
  v_mul_f32 v97, v97, v145
  v_mul_f32 v100, v100, v144
  v_mul_f32 v101, v101, v145
  v_mfma_f32_16x16x32_bf16 v[116:119], v[136:139], v[172:175], v[116:119]
  v_mul_f32 v98, v98, v146
  v_mul_f32 v99, v99, v147
  v_cvt_pk_bf16_f32 v96, v96, v97
  v_mul_f32 v102, v102, v146
  v_mfma_f32_16x16x32_bf16 v[112:115], v[200:203], v[216:219], v[112:115]
  v_mul_f32 v103, v103, v147
  v_cvt_pk_bf16_f32 v97, v98, v99
  v_cvt_pk_bf16_f32 v98, v100, v101
  v_cvt_pk_bf16_f32 v99, v102, v103
  v_mfma_f32_16x16x32_bf16 v[116:119], v[200:203], v[220:223], v[116:119]
  v_permlane16_swap_b32 v96, v98
  v_permlane16_swap_b32 v97, v99
  buffer_store_dwordx4 v[96:99], v34, s[28:31], s72 offen sc1
  v_mul_f32 v104, v104, v148
  v_mfma_f32_16x16x32_bf16 v[120:123], v[140:143], v[168:171], v[120:123]
  v_mul_f32 v105, v105, v149
  v_mul_f32 v108, v108, v148
  v_mul_f32 v109, v109, v149
  v_mul_f32 v106, v106, v150
  v_mfma_f32_16x16x32_bf16 v[124:127], v[140:143], v[172:175], v[124:127]
  v_mul_f32 v107, v107, v151
  v_cvt_pk_bf16_f32 v104, v104, v105
  v_mul_f32 v110, v110, v150
  v_mul_f32 v111, v111, v151
  v_mfma_f32_16x16x32_bf16 v[120:123], v[204:207], v[216:219], v[120:123]
  v_cvt_pk_bf16_f32 v105, v106, v107
  v_cvt_pk_bf16_f32 v106, v108, v109
  v_cvt_pk_bf16_f32 v107, v110, v111
  s_nop 0
  v_permlane16_swap_b32 v104, v106
  v_mfma_f32_16x16x32_bf16 v[124:127], v[204:207], v[220:223], v[124:127]
  v_permlane16_swap_b32 v105, v107
  buffer_store_dwordx4 v[104:107], v34, s[28:31], s73 offen sc1
  v_mul_f32 v112, v112, v152
  v_mul_f32 v113, v113, v153
  v_mul_f32 v116, v116, v152
  v_mul_f32 v117, v117, v153
  v_mul_f32 v114, v114, v154
  v_mul_f32 v115, v115, v155
  v_cvt_pk_bf16_f32 v112, v112, v113
  v_mul_f32 v118, v118, v154
  v_mul_f32 v119, v119, v155
  v_cvt_pk_bf16_f32 v113, v114, v115
  v_cvt_pk_bf16_f32 v114, v116, v117
  v_cvt_pk_bf16_f32 v115, v118, v119
  s_nop 0
  v_permlane16_swap_b32 v112, v114
  v_permlane16_swap_b32 v113, v115
  buffer_store_dwordx4 v[112:115], v34, s[28:31], s74 offen sc1
  v_mul_f32 v120, v120, v156
  v_mul_f32 v121, v121, v157
  v_mul_f32 v124, v124, v156
  v_mul_f32 v125, v125, v157
  v_mul_f32 v122, v122, v158
  v_mul_f32 v123, v123, v159
  v_cvt_pk_bf16_f32 v120, v120, v121
  v_mul_f32 v126, v126, v158
  v_mul_f32 v127, v127, v159
  v_cvt_pk_bf16_f32 v121, v122, v123
  v_cvt_pk_bf16_f32 v122, v124, v125
  v_cvt_pk_bf16_f32 v123, v126, v127
  s_nop 0
  v_permlane16_swap_b32 v120, v122
  v_permlane16_swap_b32 v121, v123
  buffer_store_dwordx4 v[120:123], v34, s[28:31], s75 offen sc1
Lp1flag:
  s_lshl4_add_u32 s72, s62, s63
  s_lshl_b32 s70, s72, 7
  s_add_u32 s70, s70, 4096
  v_mov_b32 v16, s59
  s_waitcnt vmcnt(0) lgkmcnt(0)
  s_cmp_lg_u32 s58, 0
  s_barrier
  s_cbranch_scc1 Lfl5
  s_mov_b64 exec, 1
  buffer_store_dword v16, off, s[28:31], s70 sc1
  s_mov_b64 exec, -1
Lfl5:
Lp1end:
  s_mul_i32 s3, s58, 25600
  s_mul_i32 s4, s12, 1536
  s_add_u32 s3, s3, 0
  s_and_b32 s4, s4, 0xfffff800
  v_add_u32 v248, 0, v244
  v_add_u32 v249, 0, v245
  s_add_u32 m0, s4, s3
  s_mul_i32 s5, s4, 27
  buffer_load_dwordx4 v248, s[44:47], s5 offen lds
  buffer_load_dwordx4 v249, s[44:47], s5 offen offset:1024 lds
  s_addk_i32 s4, 2048
  s_cmpk_eq_u32 s4, 12288
  s_cmovk_i32 s4, 0
  s_add_u32 m0, s4, s3
  s_mul_i32 s5, s4, 27
  buffer_load_dwordx4 v248, s[44:47], s5 offen lds
  buffer_load_dwordx4 v249, s[44:47], s5 offen offset:1024 lds
  s_addk_i32 s4, 2048
  s_cmpk_eq_u32 s4, 12288
  s_cmovk_i32 s4, 0
  s_add_u32 m0, s4, s3
  s_mul_i32 s5, s4, 27
  buffer_load_dwordx4 v248, s[44:47], s5 offen lds
  buffer_load_dwordx4 v249, s[44:47], s5 offen offset:1024 lds
  s_addk_i32 s4, 2048
  s_cmpk_eq_u32 s4, 12288
  s_cmovk_i32 s4, 0
  s_add_u32 m0, s4, s3
  s_mul_i32 s5, s4, 27
  buffer_load_dwordx4 v248, s[44:47], s5 offen lds
  buffer_load_dwordx4 v249, s[44:47], s5 offen offset:1024 lds
  s_addk_i32 s4, 2048
  s_cmpk_eq_u32 s4, 12288
  s_cmovk_i32 s4, 0
  s_add_u32 m0, s4, s3
  s_mul_i32 s5, s4, 27
  buffer_load_dwordx4 v248, s[44:47], s5 offen lds
  buffer_load_dwordx4 v249, s[44:47], s5 offen offset:1024 lds
  s_addk_i32 s4, 2048
  s_cmpk_eq_u32 s4, 12288
  s_cmovk_i32 s4, 0
  s_add_u32 m0, s4, s3
  s_mul_i32 s5, s4, 27
  buffer_load_dwordx4 v248, s[44:47], s5 offen lds
  buffer_load_dwordx4 v249, s[44:47], s5 offen offset:1024 lds
  s_and_b32 s70, s56, 7
  s_lshl_b32 s70, s70, 2
  s_and_b32 s71, s57, 3
  s_lshr_b32 s72, s57, 2
  s_add_u32 s57, s70, s71
  s_and_b32 s56, s56, 0
  s_add_u32 s56, s56, s72
  s_lshl_b32 s13, s56, 5
  s_add_u32 s13, s13, s57
  v_mov_b32 v7, 0
  s_mov_b32 s78, s59
  s_mov_b32 s79, s59
  s_lshr_b32 s70, s57, 1
  s_and_b32 s71, s57, 1
  s_mul_i32 s70, s70, 5
  s_add_u32 s73, s70, 2
  s_mul_i32 s72, s71, 3
  s_add_u32 s72, s72, s70
  s_lshl_b32 s26, s71, 1
  s_add_u32 s26, s26, s70
  s_lshl_b32 s75, s56, 1
  s_add_u32 s74, s75, s58
  s_sub_u32 s74, s74, 2
  s_cselect_b32 s74, s58, s74
  s_lshr_b32 s27, s58, 1
  s_add_u32 s75, s75, s27
  s_lshl_b32 s62, s74, 4
  s_lshl_b32 s63, s75, 4
  s_lshr_b32 s64, s26, 4
  s_add_u32 s65, s26, 2
  s_lshr_b32 s65, s65, 4
  s_mul_i32 s66, s57, 20
  s_add_u32 s67, s66, 19
  s_lshr_b32 s68, s66, 7
  s_lshr_b32 s67, s67, 7
  s_add_u32 s69, s64, s62
  s_add_u32 s69, s69, 37
  s_lshl_b32 s69, s69, 7
  v_writelane_b32 v7, s69, 0
  s_add_u32 s69, s65, s62
  s_add_u32 s69, s69, 37
  s_lshl_b32 s69, s69, 7
  v_writelane_b32 v7, s69, 1
  s_add_u32 s69, s68, s62
  s_add_u32 s69, s69, 42
  s_lshl_b32 s69, s69, 7
  v_writelane_b32 v7, s69, 2
  s_add_u32 s69, s67, s62
  s_add_u32 s69, s69, 42
  s_lshl_b32 s69, s69, 7
  v_writelane_b32 v7, s69, 3
  s_add_u32 s69, s64, s63
  s_add_u32 s69, s69, 32
  s_lshl_b32 s69, s69, 7
  v_writelane_b32 v7, s69, 4
  s_add_u32 s69, s65, s63
  s_add_u32 s69, s69, 32
  s_lshl_b32 s69, s69, 7
  v_writelane_b32 v7, s69, 5
  v_lshrrev_b32 v16, 5, v1
  v_and_b32 v17, 31, v1
  s_mov_b32 s69, 33280
  v_add_u32 v18, s72, v16
  v_mul_u32_u24 v18, s69, v18
  v_lshl_add_u32 v18, v17, 4, v18
  s_lshl_b32 s62, s74, 11
  v_add_u32 v24, s62, v18
  s_mul_i32 s63, s73, 33280
  s_add_u32 s62, s62, s63
  v_lshl_add_u32 v25, v1, 4, s62
  s_lshl_b32 s62, s56, 2
  s_add_u32 s62, s62, s58
  s_lshl_b32 s62, s62, 10
  v_add_u32 v31, s62, v18
  s_lshl3_add_u32 s63, s71, s63
  s_add_u32 s63, s63, s62
  v_lshl_add_u32 v32, v17, 4, s63
  s_lshl_b32 s63, s57, 1
  v_add_u32 v18, s63, v16
  v_mul_u32_u24 v18, s69, v18
  v_lshl_add_u32 v18, v17, 4, v18
  v_add_u32 v5, s62, v18
  s_mul_i32 s63, s57, 16640
  s_lshr_b32 s62, s62, 1
  s_add_u32 s62, s62, s63
  v_lshl_add_u32 v6, v17, 3, s62
  s_mul_i32 s62, s74, 163840
  s_lshl4_add_u32 s62, s66, s62
  v_add_u32 v18, 0, v1
  v_mul_u32_u24 v19, 3277, v18
  v_lshrrev_b32 v19, 16, v19
  v_mul_u32_u24 v19, 9920, v19
  v_lshl_add_u32 v19, v18, 4, v19
  s_sub_u32 s63, s62, 0
  v_add_u32 v26, s63, v19
  v_add_u32 v18, 64, v1
  v_mul_u32_u24 v19, 3277, v18
  v_lshrrev_b32 v19, 16, v19
  v_mul_u32_u24 v19, 9920, v19
  v_lshl_add_u32 v19, v18, 4, v19
  s_sub_u32 s63, s62, 1024
  v_add_u32 v27, s63, v19
  v_add_u32 v18, 128, v1
  v_mul_u32_u24 v19, 3277, v18
  v_lshrrev_b32 v19, 16, v19
  v_mul_u32_u24 v19, 9920, v19
  v_lshl_add_u32 v19, v18, 4, v19
  s_sub_u32 s63, s62, 2048
  v_add_u32 v28, s63, v19
  v_add_u32 v18, 192, v1
  v_mul_u32_u24 v19, 3277, v18
  v_lshrrev_b32 v19, 16, v19
  v_mul_u32_u24 v19, 9920, v19
  v_lshl_add_u32 v19, v18, 4, v19
  s_sub_u32 s63, s62, 3072
  v_add_u32 v29, s63, v19
  v_add_u32 v18, 256, v1
  v_mul_u32_u24 v19, 3277, v18
  v_lshrrev_b32 v19, 16, v19
  v_mul_u32_u24 v19, 9920, v19
  v_lshl_add_u32 v19, v18, 4, v19
  s_sub_u32 s63, s62, 0
  v_add_u32 v30, s63, v19
  v_lshrrev_b32 v18, 1, v17
  v_xor_b32 v18, v18, v17
  v_bfe_u32 v18, v18, 2, 1
  v_mul_u32_u24 v18, 12, v18
  v_xor_b32 v18, v18, v17
  v_lshlrev_b32 v18, 4, v18
  s_lshl_b32 s62, s58, 11
  s_add_u32 s62, s62, 114688
  v_lshl_add_u32 v19, v16, 9, v18
  v_add_u32 v2, s62, v19
  s_lshl_b32 s62, s58, 10
  s_lshl3_add_u32 s62, s71, s62
  s_add_u32 s62, s62, 131072
  v_add_u32 v3, s62, v18
  s_mul_i32 s62, s58, 2560
  s_add_u32 s62, s62, 139264
  v_mul_u32_u24 v19, 320, v16
  v_lshl_add_u32 v19, v17, 4, v19
  v_add_u32 v4, s62, v19
  v_lshlrev_b32 v16, 3, v16
  v_sub_u32 v16, v17, v16
  v_mov_b32 v17, 0xf149f2ca
  v_cmp_le_i32 vcc, 0, v16
  s_nop 1
  v_cndmask_b32 v160, 0, v17, vcc
  v_sub_f32 v144, v17, v160
  v_cmp_le_i32 vcc, 1, v16
  s_nop 1
  v_cndmask_b32 v161, 0, v17, vcc
  v_sub_f32 v145, v17, v161
  v_cmp_le_i32 vcc, 2, v16
  s_nop 1
  v_cndmask_b32 v162, 0, v17, vcc
  v_sub_f32 v146, v17, v162
  v_cmp_le_i32 vcc, 3, v16
  s_nop 1
  v_cndmask_b32 v163, 0, v17, vcc
  v_sub_f32 v147, v17, v163
  v_cmp_le_i32 vcc, 4, v16
  s_nop 1
  v_cndmask_b32 v164, 0, v17, vcc
  v_sub_f32 v148, v17, v164
  v_cmp_le_i32 vcc, 5, v16
  s_nop 1
  v_cndmask_b32 v165, 0, v17, vcc
  v_sub_f32 v149, v17, v165
  v_cmp_le_i32 vcc, 6, v16
  s_nop 1
  v_cndmask_b32 v166, 0, v17, vcc
  v_sub_f32 v150, v17, v166
  v_cmp_le_i32 vcc, 7, v16
  s_nop 1
  v_cndmask_b32 v167, 0, v17, vcc
  v_sub_f32 v151, v17, v167
  v_cmp_le_i32 vcc, 16, v16
  s_nop 1
  v_cndmask_b32 v168, 0, v17, vcc
  v_sub_f32 v152, v17, v168
  v_cmp_le_i32 vcc, 17, v16
  s_nop 1
  v_cndmask_b32 v169, 0, v17, vcc
  v_sub_f32 v153, v17, v169
  v_cmp_le_i32 vcc, 18, v16
  s_nop 1
  v_cndmask_b32 v170, 0, v17, vcc
  v_sub_f32 v154, v17, v170
  v_cmp_le_i32 vcc, 19, v16
  s_nop 1
  v_cndmask_b32 v171, 0, v17, vcc
  v_sub_f32 v155, v17, v171
  v_cmp_le_i32 vcc, 20, v16
  s_nop 1
  v_cndmask_b32 v172, 0, v17, vcc
  v_sub_f32 v156, v17, v172
  v_cmp_le_i32 vcc, 21, v16
  s_nop 1
  v_cndmask_b32 v173, 0, v17, vcc
  v_sub_f32 v157, v17, v173
  v_cmp_le_i32 vcc, 22, v16
  s_nop 1
  v_cndmask_b32 v174, 0, v17, vcc
  v_sub_f32 v158, v17, v174
  v_cmp_le_i32 vcc, 23, v16
  s_nop 1
  v_cndmask_b32 v175, 0, v17, vcc
  v_sub_f32 v159, v17, v175
  v_mov_b32 v188, 0x3f803f80
  v_mov_b32 v189, 0x3f803f80
  v_mov_b32 v190, 0x3f803f80
  v_mov_b32 v191, 0x3f803f80
  v_mov_b32 v192, 0x3f803f80
  v_mov_b32 v193, 0x3f803f80
  v_mov_b32 v194, 0x3f803f80
  v_mov_b32 v195, 0x3f803f80
  v_mov_b32 v196, 0x3f803f80
  v_mov_b32 v197, 0x3f803f80
  v_mov_b32 v198, 0x3f803f80
  v_mov_b32 v199, 0x3f803f80
  v_mov_b32 v200, 0x3f803f80
  v_mov_b32 v201, 0x3f803f80
  v_mov_b32 v202, 0x3f803f80
  v_mov_b32 v203, 0x3f803f80
  v_mov_b32 v185, 0x3f803f80
  v_mov_b32 v187, 0x3f803f80
  v_mov_b32 v212, 0x3f80
  v_mov_b32 v213, 0
  v_mov_b32 v214, 0x3f80
  v_mov_b32 v215, 0
  s_mul_i32 s70, s9, 160
  v_add_u32 v16, 0, v1
  v_mul_u32_u24 v17, 6554, v16
  v_lshrrev_b32 v17, 16, v17
  v_mul_u32_u24 v17, 1120, v17
  v_lshl_add_u32 v17, v16, 4, v17
  s_sub_u32 s71, s70, 0
  v_add_u32 v8, s71, v17
  v_add_u32 v16, 64, v1
  v_mul_u32_u24 v17, 6554, v16
  v_lshrrev_b32 v17, 16, v17
  v_mul_u32_u24 v17, 1120, v17
  v_lshl_add_u32 v17, v16, 4, v17
  s_sub_u32 s71, s70, 1024
  v_add_u32 v9, s71, v17
  v_add_u32 v16, 128, v1
  v_mul_u32_u24 v17, 6554, v16
  v_lshrrev_b32 v17, 16, v17
  v_mul_u32_u24 v17, 1120, v17
  v_lshl_add_u32 v17, v16, 4, v17
  s_sub_u32 s71, s70, 2048
  v_add_u32 v10, s71, v17
  v_add_u32 v16, 192, v1
  v_mul_u32_u24 v17, 6554, v16
  v_lshrrev_b32 v17, 16, v17
  v_mul_u32_u24 v17, 1120, v17
  v_lshl_add_u32 v17, v16, 4, v17
  s_sub_u32 s71, s70, 3072
  v_add_u32 v11, s71, v17
  v_add_u32 v16, 256, v1
  v_mul_u32_u24 v17, 6554, v16
  v_lshrrev_b32 v17, 16, v17
  v_mul_u32_u24 v17, 1120, v17
  v_lshl_add_u32 v17, v16, 4, v17
  s_sub_u32 s71, s70, 0
  v_add_u32 v12, s71, v17
  s_mov_b32 s62, 0xfffff
  s_mov_b32 s63, 0xfffff
  s_mov_b32 s64, 0
  s_lshl_b32 s66, s58, 1
  s_add_u32 s66, s66, 2
  s_cmp_eq_u32 s56, 0
  s_cselect_b32 s66, s66, 99
  s_mov_b32 s72, 3710976
  s_mov_b32 s73, 6815744
  s_mov_b32 s74, 1048576
  s_mov_b64 exec, 0x3f
  buffer_load_dword v20, v7, s[28:31], 0 offen sc1
  s_waitcnt vmcnt(0)
  v_cmp_ne_u32 vcc, s59, v20
  s_cbranch_vccz Ld7
Lp6:
  buffer_load_dword v20, v7, s[28:31], 0 offen sc1
  s_waitcnt vmcnt(0) lgkmcnt(0)
  v_cmp_ne_u32 vcc, s59, v20
  s_cbranch_vccz Ld7
  s_sub_u32 s61, s61, 1
  s_cbranch_scc0 Lp6
  s_branch Lexit
Ld7:
  s_mov_b64 exec, -1
  s_lshl_b32 s75, s58, 12
  s_add_u32 m0, s75, 114688
  s_nop 0
  buffer_load_dwordx4 v24, s[28:31], s72 offen offset:0 lds
  s_add_u32 m0, s75, 115200
  s_nop 0
  buffer_load_dwordx4 v24, s[28:31], s72 offen offset:512 lds
  s_add_u32 m0, s75, 115712
  s_nop 0
  buffer_load_dwordx4 v24, s[28:31], s72 offen offset:1024 lds
  s_add_u32 m0, s75, 116224
  s_nop 0
  buffer_load_dwordx4 v24, s[28:31], s72 offen offset:1536 lds
  s_lshl_b32 s75, s58, 11
  s_add_u32 m0, s75, 131072
  s_nop 0
  buffer_load_dwordx4 v25, s[28:31], s72 offen offset:0 lds
  buffer_load_dwordx4 v25, s[28:31], s72 offen offset:1024 lds
  buffer_load_dwordx4 v[204:207], v31, s[28:31], s74 offen offset:0
  buffer_load_dwordx4 v[208:211], v31, s[28:31], s74 offen offset:512
  s_mov_b32 exec_hi, 0
  buffer_load_dwordx2 v[212:213], v32, s[28:31], s74 offen offset:0
  buffer_load_dwordx2 v[214:215], v32, s[28:31], s74 offen offset:512
  s_mov_b64 exec, -1
  s_mul_i32 s75, s58, 5120
  s_add_u32 m0, s75, 139264
  s_nop 0
  buffer_load_dwordx4 v26, s[28:31], s73 offen offset:0 lds
  buffer_load_dwordx4 v27, s[28:31], s73 offen offset:1024 lds
  buffer_load_dwordx4 v28, s[28:31], s73 offen offset:2048 lds
  buffer_load_dwordx4 v29, s[28:31], s73 offen offset:3072 lds
  s_add_u32 m0, s75, 143360
  s_nop 0
  buffer_load_dwordx4 v30, s[28:31], s73 offen lds
  s_mul_i32 s3, s58, 25600
  s_mul_i32 s4, s12, 1536
  s_add_u32 s3, s3, 13312
  s_and_b32 s4, s4, 0xfffff800
  v_add_u32 v248, 331776, v244
  v_add_u32 v249, 331776, v245
  s_mul_i32 s17, s58, 25600
  s_add_u32 s17, s17, 0
  v_add_u32 v252, s17, v250
  v_xor_b32 v253, 32, v252
  v_xor_b32 v254, 64, v252
  v_xor_b32 v255, 96, v252
  ds_read_b64_tr_b16 a[0:1], v252 offset:0
  s_add_u32 m0, s4, s3
  s_mul_i32 s5, s4, 27
  buffer_load_dwordx4 v248, s[44:47], s5 offen lds
  ds_read_b64_tr_b16 a[2:3], v252 offset:512
  ds_read_b64_tr_b16 a[4:5], v253 offset:0
  buffer_load_dwordx4 v249, s[44:47], s5 offen offset:1024 lds
  s_addk_i32 s4, 2048
  s_cmpk_eq_u32 s4, 12288
  s_cmovk_i32 s4, 0
  ds_read_b64_tr_b16 a[6:7], v253 offset:512
  ds_read_b64_tr_b16 a[8:9], v254 offset:0
  s_add_u32 m0, s4, s3
  s_mul_i32 s5, s4, 27
  buffer_load_dwordx4 v248, s[44:47], s5 offen lds
  ds_read_b64_tr_b16 a[10:11], v254 offset:512
  ds_read_b64_tr_b16 a[12:13], v255 offset:0
  buffer_load_dwordx4 v249, s[44:47], s5 offen offset:1024 lds
  s_addk_i32 s4, 2048
  s_cmpk_eq_u32 s4, 12288
  s_cmovk_i32 s4, 0
  ds_read_b64_tr_b16 a[14:15], v255 offset:512
  ds_read_b64_tr_b16 a[16:17], v252 offset:4096
  s_add_u32 m0, s4, s3
  s_mul_i32 s5, s4, 27
  buffer_load_dwordx4 v248, s[44:47], s5 offen lds
  ds_read_b64_tr_b16 a[18:19], v252 offset:4608
  ds_read_b64_tr_b16 a[20:21], v253 offset:4096
  buffer_load_dwordx4 v249, s[44:47], s5 offen offset:1024 lds
  s_addk_i32 s4, 2048
  s_cmpk_eq_u32 s4, 12288
  s_cmovk_i32 s4, 0
  ds_read_b64_tr_b16 a[22:23], v253 offset:4608
  ds_read_b64_tr_b16 a[24:25], v254 offset:4096
  s_add_u32 m0, s4, s3
  s_mul_i32 s5, s4, 27
  buffer_load_dwordx4 v248, s[44:47], s5 offen lds
  ds_read_b64_tr_b16 a[26:27], v254 offset:4608
  ds_read_b64_tr_b16 a[28:29], v255 offset:4096
  buffer_load_dwordx4 v249, s[44:47], s5 offen offset:1024 lds
  s_addk_i32 s4, 2048
  s_cmpk_eq_u32 s4, 12288
  s_cmovk_i32 s4, 0
  ds_read_b64_tr_b16 a[30:31], v255 offset:4608
  ds_read_b64_tr_b16 a[32:33], v252 offset:8192
  s_add_u32 m0, s4, s3
  s_mul_i32 s5, s4, 27
  buffer_load_dwordx4 v248, s[44:47], s5 offen lds
  ds_read_b64_tr_b16 a[34:35], v252 offset:8704
  ds_read_b64_tr_b16 a[36:37], v253 offset:8192
  buffer_load_dwordx4 v249, s[44:47], s5 offen offset:1024 lds
  s_addk_i32 s4, 2048
  s_cmpk_eq_u32 s4, 12288
  s_cmovk_i32 s4, 0
  ds_read_b64_tr_b16 a[38:39], v253 offset:8704
  ds_read_b64_tr_b16 a[40:41], v254 offset:8192
  s_add_u32 m0, s4, s3
  s_mul_i32 s5, s4, 27
  buffer_load_dwordx4 v248, s[44:47], s5 offen lds
  ds_read_b64_tr_b16 a[42:43], v254 offset:8704
  ds_read_b64_tr_b16 a[44:45], v255 offset:8192
  buffer_load_dwordx4 v249, s[44:47], s5 offen offset:1024 lds
  ds_read_b64_tr_b16 a[46:47], v255 offset:8704
  s_waitcnt lgkmcnt(0)
  s_waitcnt vmcnt(12)
  s_barrier
Latt:
  s_cmp_gt_u32 s66, 0
  s_cselect_b32 s65, 1.0, 0x3f80f149
  v_mov_b32 v184, s65
  s_mov_b32 exec_hi, 0
  ds_read_b64 v[184:185], v3 offset:4608
  s_mov_b64 exec, -1
  ds_read_b128 v[176:179], v2 offset:9216
  s_cmp_gt_u32 s66, 1
  s_cselect_b32 s65, 1.0, 0x3f80f149
  v_mov_b32 v186, s65
  s_mov_b32 exec_hi, 0
  ds_read_b64 v[186:187], v3 offset:4096
  s_mov_b64 exec, -1
  ds_read_b128 v[180:183], v2 offset:8192
  s_mov_b64 exec, s[62:63]
  ds_read_b128 v[188:191], v4 offset:11520
  ds_read_b128 v[192:195], v4 offset:12160
  s_mov_b64 exec, -1
  s_waitcnt lgkmcnt(4)
  v_mfma_f32_32x32x16_bf16 v[64:79], v[176:179], v[208:211], v[144:159]
  v_mfma_f32_32x32x8bf16_1k v[64:79], v[184:185], v[214:215], v[64:79]
  s_waitcnt lgkmcnt(2)
  v_mfma_f32_32x32x16_bf16 v[80:95], v[180:183], v[204:207], v[144:159]
  s_nop 7
  s_nop 1
  v_exp_f32 v64, v64
  v_exp_f32 v65, v65
  v_exp_f32 v66, v66
  v_exp_f32 v67, v67
  v_cvt_pk_bf16_f32 v96, v64, v65
  v_exp_f32 v68, v68
  v_exp_f32 v69, v69
  v_cvt_pk_bf16_f32 v97, v66, v67
  v_exp_f32 v70, v70
  v_exp_f32 v71, v71
  v_cvt_pk_bf16_f32 v98, v68, v69
  v_exp_f32 v72, v72
  s_mul_i32 s17, s12, 20
  v_min_u32 v232, 19, v1
  s_add_u32 s17, s17, 352
  v_add_u32 v232, s17, v232
  v_mul_u32_u24 v232, 3456, v232
  v_mfma_f32_32x32x8bf16_1k v[80:95], v[186:187], v[212:213], v[80:95]
  buffer_load_dword v231, v232, s[44:47], s6 offen
  s_lshl2_add_u32 s17, s11, s58
  v_and_b32 v62, 32, v1
  s_lshl_b32 s17, s17, 8
  v_lshlrev_b32 v62, 2, v62
  s_add_u32 s17, s17, 720896
  buffer_load_dword v62, v62, s[28:31], s17 offen sc1
  s_lshl2_add_u32 s67, s10, s58
  s_mul_i32 s67, s67, 20480
  s_mul_i32 s68, s58, 2560
  s_add_u32 m0, s68, 102400
  s_nop 0
  buffer_load_dwordx4 v8, s[32:35], s67 offen offset:0 lds
  v_exp_f32 v73, v73
  v_cvt_pk_bf16_f32 v99, v70, v71
  v_exp_f32 v74, v74
  v_exp_f32 v75, v75
  v_cvt_pk_bf16_f32 v100, v72, v73
  v_exp_f32 v76, v76
  v_exp_f32 v77, v77
  v_cvt_pk_bf16_f32 v101, v74, v75
  v_exp_f32 v78, v78
  v_exp_f32 v79, v79
  v_cvt_pk_bf16_f32 v102, v76, v77
  v_cvt_pk_bf16_f32 v103, v78, v79
  v_mfma_f32_32x32x16_bf16 v[64:79], v[180:183], v[208:211], 0
  ds_read_b128 v[176:179], v2 offset:7168
  v_exp_f32 v80, v80
  v_exp_f32 v81, v81
  v_exp_f32 v82, v82
  v_exp_f32 v83, v83
  v_cvt_pk_bf16_f32 v104, v80, v81
  v_exp_f32 v84, v84
  s_cmp_gt_u32 s66, 2
  s_cselect_b32 s65, 1.0, 0x3f80f149
  v_mov_b32 v184, s65
  s_mul_i32 s17, s58, 25600
  s_add_u32 s17, s17, 13312
  v_add_u32 v252, s17, v250
  v_xor_b32 v253, 32, v252
  v_xor_b32 v254, 64, v252
  v_xor_b32 v255, 96, v252
  v_mfma_f32_32x32x8bf16_1k v[64:79], v[186:187], v[214:215], v[64:79]
  s_mov_b32 exec_hi, 0
  ds_read_b64 v[184:185], v3 offset:3584
  s_mov_b64 exec, -1
  s_waitcnt vmcnt(3)
  ds_read_b64_tr_b16 a[48:49], v252 offset:0
  ds_read_b64_tr_b16 a[50:51], v252 offset:512
  ds_read_b64_tr_b16 a[52:53], v253 offset:0
  ds_read_b64_tr_b16 a[54:55], v253 offset:512
  v_exp_f32 v85, v85
  v_cvt_pk_bf16_f32 v105, v82, v83
  v_exp_f32 v86, v86
  v_exp_f32 v87, v87
  v_cvt_pk_bf16_f32 v106, v84, v85
  v_exp_f32 v88, v88
  s_waitcnt lgkmcnt(7)
  v_mfma_f32_32x32x16_bf16 v[128:143], v[188:191], v[96:99], 0
  s_mov_b64 exec, s[62:63]
  ds_read_b128 v[196:199], v4 offset:10240
  ds_read_b128 v[200:203], v4 offset:10880
  s_mov_b64 exec, -1
  ds_read_b64_tr_b16 a[56:57], v254 offset:0
  ds_read_b64_tr_b16 a[58:59], v254 offset:512
  ds_read_b64_tr_b16 a[60:61], v255 offset:0
  v_exp_f32 v89, v89
  v_cvt_pk_bf16_f32 v107, v86, v87
  v_exp_f32 v90, v90
  v_exp_f32 v91, v91
  v_cvt_pk_bf16_f32 v108, v88, v89
  v_exp_f32 v92, v92
  s_waitcnt lgkmcnt(11)
  v_mfma_f32_32x32x16_bf16 v[128:143], v[192:195], v[100:103], v[128:143]
  ds_read_b64_tr_b16 a[62:63], v255 offset:512
  buffer_load_dwordx4 v9, s[32:35], s67 offen offset:1024 lds
  s_mov_b32 exec_hi, 0
  buffer_load_dwordx4 v10, s[32:35], s67 offen offset:2048 lds
  s_mov_b64 exec, -1
  v_exp_f32 v93, v93
  v_cvt_pk_bf16_f32 v109, v90, v91
  v_exp_f32 v94, v94
  v_exp_f32 v95, v95
  v_cvt_pk_bf16_f32 v110, v92, v93
  v_cvt_pk_bf16_f32 v111, v94, v95
  s_waitcnt lgkmcnt(11)
  v_mfma_f32_32x32x16_bf16 v[80:95], v[176:179], v[204:207], 0
  ds_read_b64_tr_b16 a[64:65], v252 offset:4096
  ds_read_b64_tr_b16 a[66:67], v252 offset:4608
  ds_read_b64_tr_b16 a[68:69], v253 offset:4096
  v_exp_f32 v64, v64
  v_exp_f32 v65, v65
  v_exp_f32 v66, v66
  v_exp_f32 v67, v67
  v_cvt_pk_bf16_f32 v96, v64, v65
  v_exp_f32 v68, v68
  s_waitcnt lgkmcnt(13)
  v_mfma_f32_32x32x8bf16_1k v[80:95], v[184:185], v[212:213], v[80:95]
  ds_read_b64_tr_b16 a[70:71], v253 offset:4608
  ds_read_b64_tr_b16 a[72:73], v254 offset:4096
  ds_read_b64_tr_b16 a[74:75], v254 offset:4608
  v_exp_f32 v69, v69
  v_cvt_pk_bf16_f32 v97, v66, v67
  v_exp_f32 v70, v70
  v_exp_f32 v71, v71
  v_cvt_pk_bf16_f32 v98, v68, v69
  v_exp_f32 v72, v72
  s_waitcnt lgkmcnt(11)
  v_mfma_f32_32x32x16_bf16 v[112:127], v[196:199], v[104:107], 0
  ds_read_b64_tr_b16 a[76:77], v255 offset:4096
  ds_read_b64_tr_b16 a[78:79], v255 offset:4608
  s_mul_i32 s68, s58, 204800
  v_exp_f32 v73, v73
  v_cvt_pk_bf16_f32 v99, v70, v71
  v_exp_f32 v74, v74
  v_exp_f32 v75, v75
  v_cvt_pk_bf16_f32 v100, v72, v73
  v_exp_f32 v76, v76
  s_waitcnt lgkmcnt(12)
  v_mfma_f32_32x32x16_bf16 v[112:127], v[200:203], v[108:111], v[112:127]
  v_exp_f32 v77, v77
  v_cvt_pk_bf16_f32 v101, v74, v75
  v_exp_f32 v78, v78
  v_exp_f32 v79, v79
  v_cvt_pk_bf16_f32 v102, v76, v77
  v_cvt_pk_bf16_f32 v103, v78, v79
  v_mfma_f32_32x32x16_bf16 v[64:79], v[176:179], v[208:211], 0
  ds_read_b128 v[180:183], v2 offset:6144
  ds_read_b64_tr_b16 a[80:81], v252 offset:8192
  ds_read_b64_tr_b16 a[82:83], v252 offset:8704
  ds_read_b64_tr_b16 a[84:85], v253 offset:8192
  v_exp_f32 v80, v80
  v_exp_f32 v81, v81
  v_exp_f32 v82, v82
  v_exp_f32 v83, v83
  v_cvt_pk_bf16_f32 v104, v80, v81
  v_exp_f32 v84, v84
  s_cmp_gt_u32 s66, 3
  s_cselect_b32 s65, 1.0, 0x3f80f149
  v_mov_b32 v186, s65
  v_mfma_f32_32x32x8bf16_1k v[64:79], v[184:185], v[214:215], v[64:79]
  s_mov_b32 exec_hi, 0
  ds_read_b64 v[186:187], v3 offset:3072
  s_mov_b64 exec, -1
  ds_read_b64_tr_b16 a[86:87], v253 offset:8704
  v_exp_f32 v85, v85
  v_cvt_pk_bf16_f32 v105, v82, v83
  v_exp_f32 v86, v86
  v_exp_f32 v87, v87
  v_cvt_pk_bf16_f32 v106, v84, v85
  v_exp_f32 v88, v88
  v_mfma_f32_32x32x16_bf16 v[128:143], v[196:199], v[96:99], v[128:143]
  s_mov_b64 exec, s[62:63]
  ds_read_b128 v[188:191], v4 offset:8960
  ds_read_b128 v[192:195], v4 offset:9600
  s_mov_b64 exec, -1
  v_exp_f32 v89, v89
  v_cvt_pk_bf16_f32 v107, v86, v87
  v_exp_f32 v90, v90
  v_exp_f32 v91, v91
  v_cvt_pk_bf16_f32 v108, v88, v89
  v_exp_f32 v92, v92
  v_mfma_f32_32x32x16_bf16 v[128:143], v[200:203], v[100:103], v[128:143]
  ds_read_b64_tr_b16 a[88:89], v254 offset:8192
  ds_read_b64_tr_b16 a[90:91], v254 offset:8704
  ds_read_b64_tr_b16 a[92:93], v255 offset:8192
  ds_read_b64_tr_b16 a[94:95], v255 offset:8704
  v_exp_f32 v93, v93
  v_cvt_pk_bf16_f32 v109, v90, v91
  v_exp_f32 v94, v94
  v_exp_f32 v95, v95
  v_cvt_pk_bf16_f32 v110, v92, v93
  v_cvt_pk_bf16_f32 v111, v94, v95
  s_waitcnt lgkmcnt(11)
  v_mfma_f32_32x32x16_bf16 v[80:95], v[180:183], v[204:207], 0
  s_waitcnt lgkmcnt(0)
  s_add_u32 s67, s68, 163840
  s_add_u32 m0, s8, 20480
  s_nop 0
  buffer_load_dwordx4 v8, s[40:43], s67 offen offset:0 lds
  v_exp_f32 v64, v64
  v_exp_f32 v65, v65
  v_exp_f32 v66, v66
  v_exp_f32 v67, v67
  v_cvt_pk_bf16_f32 v96, v64, v65
  v_exp_f32 v68, v68
  v_mfma_f32_32x32x8bf16_1k v[80:95], v[186:187], v[212:213], v[80:95]
  buffer_load_dwordx4 v9, s[40:43], s67 offen offset:1024 lds
  buffer_load_dwordx4 v10, s[40:43], s67 offen offset:2048 lds
  buffer_load_dwordx4 v11, s[40:43], s67 offen offset:3072 lds
  v_exp_f32 v69, v69
  v_cvt_pk_bf16_f32 v97, v66, v67
  v_exp_f32 v70, v70
  v_exp_f32 v71, v71
  v_cvt_pk_bf16_f32 v98, v68, v69
  v_exp_f32 v72, v72
  v_mfma_f32_32x32x16_bf16 v[112:127], v[188:191], v[104:107], v[112:127]
  s_add_u32 m0, s8, 24576
  s_nop 0
  buffer_load_dwordx4 v12, s[40:43], s67 offen lds
  v_exp_f32 v73, v73
  v_cvt_pk_bf16_f32 v99, v70, v71
  v_exp_f32 v74, v74
  v_exp_f32 v75, v75
  v_cvt_pk_bf16_f32 v100, v72, v73
  v_exp_f32 v76, v76
  v_mfma_f32_32x32x16_bf16 v[112:127], v[192:195], v[108:111], v[112:127]
  v_exp_f32 v77, v77
  v_cvt_pk_bf16_f32 v101, v74, v75
  v_exp_f32 v78, v78
  v_exp_f32 v79, v79
  v_cvt_pk_bf16_f32 v102, v76, v77
  v_cvt_pk_bf16_f32 v103, v78, v79
  v_mfma_f32_32x32x16_bf16 v[64:79], v[180:183], v[208:211], 0
  ds_read_b128 v[176:179], v2 offset:5120
  s_add_u32 s67, s68, 122880
  s_add_u32 m0, s8, 15360
  v_exp_f32 v80, v80
  v_exp_f32 v81, v81
  v_exp_f32 v82, v82
  v_exp_f32 v83, v83
  v_cvt_pk_bf16_f32 v104, v80, v81
  v_exp_f32 v84, v84
  s_cmp_gt_u32 s66, 4
  s_cselect_b32 s65, 1.0, 0x3f80f149
  v_mov_b32 v184, s65
  v_mfma_f32_32x32x8bf16_1k v[64:79], v[186:187], v[214:215], v[64:79]
  s_mov_b32 exec_hi, 0
  ds_read_b64 v[184:185], v3 offset:2560
  s_mov_b64 exec, -1
  v_exp_f32 v85, v85
  v_cvt_pk_bf16_f32 v105, v82, v83
  v_exp_f32 v86, v86
  v_exp_f32 v87, v87
  v_cvt_pk_bf16_f32 v106, v84, v85
  v_exp_f32 v88, v88
  v_mfma_f32_32x32x16_bf16 v[128:143], v[188:191], v[96:99], v[128:143]
  s_mov_b64 exec, s[62:63]
  ds_read_b128 v[196:199], v4 offset:7680
  ds_read_b128 v[200:203], v4 offset:8320
  s_mov_b64 exec, -1
  v_exp_f32 v89, v89
  v_cvt_pk_bf16_f32 v107, v86, v87
  v_exp_f32 v90, v90
  v_exp_f32 v91, v91
  v_cvt_pk_bf16_f32 v108, v88, v89
  v_exp_f32 v92, v92
  v_mfma_f32_32x32x16_bf16 v[128:143], v[192:195], v[100:103], v[128:143]
  buffer_load_dwordx4 v8, s[40:43], s67 offen offset:0 lds
  buffer_load_dwordx4 v9, s[40:43], s67 offen offset:1024 lds
  v_exp_f32 v93, v93
  v_cvt_pk_bf16_f32 v109, v90, v91
  v_exp_f32 v94, v94
  v_exp_f32 v95, v95
  v_cvt_pk_bf16_f32 v110, v92, v93
  v_cvt_pk_bf16_f32 v111, v94, v95
  s_waitcnt lgkmcnt(3)
  v_mfma_f32_32x32x16_bf16 v[80:95], v[176:179], v[204:207], 0
  buffer_load_dwordx4 v10, s[40:43], s67 offen offset:2048 lds
  v_exp_f32 v64, v64
  v_exp_f32 v65, v65
  v_exp_f32 v66, v66
  v_exp_f32 v67, v67
  v_cvt_pk_bf16_f32 v96, v64, v65
  v_exp_f32 v68, v68
  s_waitcnt lgkmcnt(2)
  v_mfma_f32_32x32x8bf16_1k v[80:95], v[184:185], v[212:213], v[80:95]
  buffer_load_dwordx4 v11, s[40:43], s67 offen offset:3072 lds
  v_exp_f32 v69, v69
  v_cvt_pk_bf16_f32 v97, v66, v67
  v_exp_f32 v70, v70
  v_exp_f32 v71, v71
  v_cvt_pk_bf16_f32 v98, v68, v69
  v_exp_f32 v72, v72
  s_waitcnt lgkmcnt(1)
  v_mfma_f32_32x32x16_bf16 v[112:127], v[196:199], v[104:107], v[112:127]
  v_exp_f32 v73, v73
  v_cvt_pk_bf16_f32 v99, v70, v71
  v_exp_f32 v74, v74
  v_exp_f32 v75, v75
  v_cvt_pk_bf16_f32 v100, v72, v73
  v_exp_f32 v76, v76
  s_waitcnt lgkmcnt(0)
  v_mfma_f32_32x32x16_bf16 v[112:127], v[200:203], v[108:111], v[112:127]
  v_exp_f32 v77, v77
  v_cvt_pk_bf16_f32 v101, v74, v75
  v_exp_f32 v78, v78
  v_exp_f32 v79, v79
  v_cvt_pk_bf16_f32 v102, v76, v77
  v_cvt_pk_bf16_f32 v103, v78, v79
  v_mfma_f32_32x32x16_bf16 v[64:79], v[176:179], v[208:211], 0
  ds_read_b128 v[180:183], v2 offset:4096
  s_add_u32 m0, s8, 19456
  s_nop 0
  buffer_load_dwordx4 v12, s[40:43], s67 offen lds
  s_add_u32 s67, s68, 81920
  v_exp_f32 v80, v80
  v_exp_f32 v81, v81
  v_exp_f32 v82, v82
  v_exp_f32 v83, v83
  v_cvt_pk_bf16_f32 v104, v80, v81
  v_exp_f32 v84, v84
  s_cmp_gt_u32 s66, 5
  s_cselect_b32 s65, 1.0, 0x3f80f149
  v_mov_b32 v186, s65
  v_mfma_f32_32x32x8bf16_1k v[64:79], v[184:185], v[214:215], v[64:79]
  s_mov_b32 exec_hi, 0
  ds_read_b64 v[186:187], v3 offset:2048
  s_mov_b64 exec, -1
  s_add_u32 m0, s8, 10240
  v_exp_f32 v85, v85
  v_cvt_pk_bf16_f32 v105, v82, v83
  v_exp_f32 v86, v86
  v_exp_f32 v87, v87
  v_cvt_pk_bf16_f32 v106, v84, v85
  v_exp_f32 v88, v88
  v_mfma_f32_32x32x16_bf16 v[128:143], v[196:199], v[96:99], v[128:143]
  s_mov_b64 exec, s[62:63]
  ds_read_b128 v[188:191], v4 offset:6400
  ds_read_b128 v[192:195], v4 offset:7040
  s_mov_b64 exec, -1
  v_exp_f32 v89, v89
  v_cvt_pk_bf16_f32 v107, v86, v87
  v_exp_f32 v90, v90
  v_exp_f32 v91, v91
  v_cvt_pk_bf16_f32 v108, v88, v89
  v_exp_f32 v92, v92
  v_mfma_f32_32x32x16_bf16 v[128:143], v[200:203], v[100:103], v[128:143]
  buffer_load_dwordx4 v8, s[40:43], s67 offen offset:0 lds
  v_exp_f32 v93, v93
  v_cvt_pk_bf16_f32 v109, v90, v91
  v_exp_f32 v94, v94
  v_exp_f32 v95, v95
  v_cvt_pk_bf16_f32 v110, v92, v93
  v_cvt_pk_bf16_f32 v111, v94, v95
  s_waitcnt lgkmcnt(3)
  v_mfma_f32_32x32x16_bf16 v[80:95], v[180:183], v[204:207], 0
  buffer_load_dwordx4 v9, s[40:43], s67 offen offset:1024 lds
  v_exp_f32 v64, v64
  v_exp_f32 v65, v65
  v_exp_f32 v66, v66
  v_exp_f32 v67, v67
  v_cvt_pk_bf16_f32 v96, v64, v65
  v_exp_f32 v68, v68
  s_waitcnt lgkmcnt(2)
  v_mfma_f32_32x32x8bf16_1k v[80:95], v[186:187], v[212:213], v[80:95]
  buffer_load_dwordx4 v10, s[40:43], s67 offen offset:2048 lds
  v_exp_f32 v69, v69
  v_cvt_pk_bf16_f32 v97, v66, v67
  v_exp_f32 v70, v70
  v_exp_f32 v71, v71
  v_cvt_pk_bf16_f32 v98, v68, v69
  v_exp_f32 v72, v72
  s_waitcnt lgkmcnt(1)
  v_mfma_f32_32x32x16_bf16 v[112:127], v[188:191], v[104:107], v[112:127]
  v_exp_f32 v73, v73
  v_cvt_pk_bf16_f32 v99, v70, v71
  v_exp_f32 v74, v74
  v_exp_f32 v75, v75
  v_cvt_pk_bf16_f32 v100, v72, v73
  v_exp_f32 v76, v76
  s_waitcnt lgkmcnt(0)
  v_mfma_f32_32x32x16_bf16 v[112:127], v[192:195], v[108:111], v[112:127]
  v_exp_f32 v77, v77
  v_cvt_pk_bf16_f32 v101, v74, v75
  v_exp_f32 v78, v78
  v_exp_f32 v79, v79
  v_cvt_pk_bf16_f32 v102, v76, v77
  v_cvt_pk_bf16_f32 v103, v78, v79
  v_mfma_f32_32x32x16_bf16 v[64:79], v[180:183], v[208:211], 0
  ds_read_b128 v[176:179], v2 offset:3072
  buffer_load_dwordx4 v11, s[40:43], s67 offen offset:3072 lds
  s_add_u32 m0, s8, 14336
  v_exp_f32 v80, v80
  v_exp_f32 v81, v81
  v_exp_f32 v82, v82
  v_exp_f32 v83, v83
  v_cvt_pk_bf16_f32 v104, v80, v81
  v_exp_f32 v84, v84
  s_cmp_gt_u32 s66, 6
  s_cselect_b32 s65, 1.0, 0x3f80f149
  v_mov_b32 v184, s65
  v_mfma_f32_32x32x8bf16_1k v[64:79], v[186:187], v[214:215], v[64:79]
  s_mov_b32 exec_hi, 0
  ds_read_b64 v[184:185], v3 offset:1536
  s_mov_b64 exec, -1
  v_exp_f32 v85, v85
  v_cvt_pk_bf16_f32 v105, v82, v83
  v_exp_f32 v86, v86
  v_exp_f32 v87, v87
  v_cvt_pk_bf16_f32 v106, v84, v85
  v_exp_f32 v88, v88
  v_mfma_f32_32x32x16_bf16 v[128:143], v[188:191], v[96:99], v[128:143]
  s_mov_b64 exec, s[62:63]
  ds_read_b128 v[196:199], v4 offset:5120
  ds_read_b128 v[200:203], v4 offset:5760
  s_mov_b64 exec, -1
  v_exp_f32 v89, v89
  v_cvt_pk_bf16_f32 v107, v86, v87
  v_exp_f32 v90, v90
  v_exp_f32 v91, v91
  v_cvt_pk_bf16_f32 v108, v88, v89
  v_exp_f32 v92, v92
  v_mfma_f32_32x32x16_bf16 v[128:143], v[192:195], v[100:103], v[128:143]
  buffer_load_dwordx4 v12, s[40:43], s67 offen lds
  v_exp_f32 v93, v93
  v_cvt_pk_bf16_f32 v109, v90, v91
  v_exp_f32 v94, v94
  v_exp_f32 v95, v95
  v_cvt_pk_bf16_f32 v110, v92, v93
  v_cvt_pk_bf16_f32 v111, v94, v95
  s_waitcnt lgkmcnt(3)
  v_mfma_f32_32x32x16_bf16 v[80:95], v[176:179], v[204:207], 0
  s_add_u32 s67, s68, 40960
  v_exp_f32 v64, v64
  v_exp_f32 v65, v65
  v_exp_f32 v66, v66
  v_exp_f32 v67, v67
  v_cvt_pk_bf16_f32 v96, v64, v65
  v_exp_f32 v68, v68
  s_waitcnt lgkmcnt(2)
  v_mfma_f32_32x32x8bf16_1k v[80:95], v[184:185], v[212:213], v[80:95]
  s_add_u32 m0, s8, 5120
  v_exp_f32 v69, v69
  v_cvt_pk_bf16_f32 v97, v66, v67
  v_exp_f32 v70, v70
  v_exp_f32 v71, v71
  v_cvt_pk_bf16_f32 v98, v68, v69
  v_exp_f32 v72, v72
  s_waitcnt lgkmcnt(1)
  v_mfma_f32_32x32x16_bf16 v[112:127], v[196:199], v[104:107], v[112:127]
  buffer_load_dwordx4 v8, s[40:43], s67 offen offset:0 lds
  v_exp_f32 v73, v73
  v_cvt_pk_bf16_f32 v99, v70, v71
  v_exp_f32 v74, v74
  v_exp_f32 v75, v75
  v_cvt_pk_bf16_f32 v100, v72, v73
  v_exp_f32 v76, v76
  s_waitcnt lgkmcnt(0)
  v_mfma_f32_32x32x16_bf16 v[112:127], v[200:203], v[108:111], v[112:127]
  v_exp_f32 v77, v77
  v_cvt_pk_bf16_f32 v101, v74, v75
  v_exp_f32 v78, v78
  v_exp_f32 v79, v79
  v_cvt_pk_bf16_f32 v102, v76, v77
  v_cvt_pk_bf16_f32 v103, v78, v79
  v_mfma_f32_32x32x16_bf16 v[64:79], v[176:179], v[208:211], 0
  ds_read_b128 v[180:183], v2 offset:2048
  buffer_load_dwordx4 v9, s[40:43], s67 offen offset:1024 lds
  buffer_load_dwordx4 v10, s[40:43], s67 offen offset:2048 lds
  v_exp_f32 v80, v80
  v_exp_f32 v81, v81
  v_exp_f32 v82, v82
  v_exp_f32 v83, v83
  v_cvt_pk_bf16_f32 v104, v80, v81
  v_exp_f32 v84, v84
  s_cmp_gt_u32 s66, 7
  s_cselect_b32 s65, 1.0, 0x3f80f149
  v_mov_b32 v186, s65
  v_mfma_f32_32x32x8bf16_1k v[64:79], v[184:185], v[214:215], v[64:79]
  s_mov_b32 exec_hi, 0
  ds_read_b64 v[186:187], v3 offset:1024
  s_mov_b64 exec, -1
  v_exp_f32 v85, v85
  v_cvt_pk_bf16_f32 v105, v82, v83
  v_exp_f32 v86, v86
  v_exp_f32 v87, v87
  v_cvt_pk_bf16_f32 v106, v84, v85
  v_exp_f32 v88, v88
  v_mfma_f32_32x32x16_bf16 v[128:143], v[196:199], v[96:99], v[128:143]
  s_mov_b64 exec, s[62:63]
  ds_read_b128 v[188:191], v4 offset:3840
  ds_read_b128 v[192:195], v4 offset:4480
  s_mov_b64 exec, -1
  v_exp_f32 v89, v89
  v_cvt_pk_bf16_f32 v107, v86, v87
  v_exp_f32 v90, v90
  v_exp_f32 v91, v91
  v_cvt_pk_bf16_f32 v108, v88, v89
  v_exp_f32 v92, v92
  v_mfma_f32_32x32x16_bf16 v[128:143], v[200:203], v[100:103], v[128:143]
  v_exp_f32 v93, v93
  v_cvt_pk_bf16_f32 v109, v90, v91
  v_exp_f32 v94, v94
  v_exp_f32 v95, v95
  v_cvt_pk_bf16_f32 v110, v92, v93
  v_cvt_pk_bf16_f32 v111, v94, v95
  s_waitcnt lgkmcnt(3)
  v_mfma_f32_32x32x16_bf16 v[80:95], v[180:183], v[204:207], 0
  buffer_load_dwordx4 v11, s[40:43], s67 offen offset:3072 lds
  v_exp_f32 v64, v64
  v_exp_f32 v65, v65
  v_exp_f32 v66, v66
  v_exp_f32 v67, v67
  v_cvt_pk_bf16_f32 v96, v64, v65
  v_exp_f32 v68, v68
  s_waitcnt lgkmcnt(2)
  v_mfma_f32_32x32x8bf16_1k v[80:95], v[186:187], v[212:213], v[80:95]
  s_add_u32 m0, s8, 9216
  v_exp_f32 v69, v69
  v_cvt_pk_bf16_f32 v97, v66, v67
  v_exp_f32 v70, v70
  v_exp_f32 v71, v71
  v_cvt_pk_bf16_f32 v98, v68, v69
  v_exp_f32 v72, v72
  s_waitcnt lgkmcnt(1)
  v_mfma_f32_32x32x16_bf16 v[112:127], v[188:191], v[104:107], v[112:127]
  buffer_load_dwordx4 v12, s[40:43], s67 offen lds
  v_exp_f32 v73, v73
  v_cvt_pk_bf16_f32 v99, v70, v71
  v_exp_f32 v74, v74
  v_exp_f32 v75, v75
  v_cvt_pk_bf16_f32 v100, v72, v73
  v_exp_f32 v76, v76
  s_waitcnt lgkmcnt(0)
  v_mfma_f32_32x32x16_bf16 v[112:127], v[192:195], v[108:111], v[112:127]
  v_exp_f32 v77, v77
  v_cvt_pk_bf16_f32 v101, v74, v75
  v_exp_f32 v78, v78
  v_exp_f32 v79, v79
  v_cvt_pk_bf16_f32 v102, v76, v77
  v_cvt_pk_bf16_f32 v103, v78, v79
  v_mfma_f32_32x32x16_bf16 v[64:79], v[180:183], v[208:211], 0
  ds_read_b128 v[176:179], v2 offset:1024
  s_add_u32 s67, s68, 0
  s_add_u32 m0, s8, 0
  v_exp_f32 v80, v80
  v_exp_f32 v81, v81
  v_exp_f32 v82, v82
  v_exp_f32 v83, v83
  v_cvt_pk_bf16_f32 v104, v80, v81
  v_exp_f32 v84, v84
  s_cmp_gt_u32 s66, 8
  s_cselect_b32 s65, 1.0, 0x3f80f149
  v_mov_b32 v184, s65
  v_mfma_f32_32x32x8bf16_1k v[64:79], v[186:187], v[214:215], v[64:79]
  s_mov_b32 exec_hi, 0
  ds_read_b64 v[184:185], v3 offset:512
  s_mov_b64 exec, -1
  v_exp_f32 v85, v85
  v_cvt_pk_bf16_f32 v105, v82, v83
  v_exp_f32 v86, v86
  v_exp_f32 v87, v87
  v_cvt_pk_bf16_f32 v106, v84, v85
  v_exp_f32 v88, v88
  v_mfma_f32_32x32x16_bf16 v[128:143], v[188:191], v[96:99], v[128:143]
  s_mov_b64 exec, s[62:63]
  ds_read_b128 v[196:199], v4 offset:2560
  ds_read_b128 v[200:203], v4 offset:3200
  s_mov_b64 exec, -1
  v_exp_f32 v89, v89
  v_cvt_pk_bf16_f32 v107, v86, v87
  v_exp_f32 v90, v90
  v_exp_f32 v91, v91
  v_cvt_pk_bf16_f32 v108, v88, v89
  v_exp_f32 v92, v92
  v_mfma_f32_32x32x16_bf16 v[128:143], v[192:195], v[100:103], v[128:143]
  buffer_load_dwordx4 v8, s[40:43], s67 offen offset:0 lds
  buffer_load_dwordx4 v9, s[40:43], s67 offen offset:1024 lds
  v_exp_f32 v93, v93
  v_cvt_pk_bf16_f32 v109, v90, v91
  v_exp_f32 v94, v94
  v_exp_f32 v95, v95
  v_cvt_pk_bf16_f32 v110, v92, v93
  v_cvt_pk_bf16_f32 v111, v94, v95
  s_waitcnt lgkmcnt(3)
  v_mfma_f32_32x32x16_bf16 v[80:95], v[176:179], v[204:207], 0
  buffer_load_dwordx4 v10, s[40:43], s67 offen offset:2048 lds
  v_exp_f32 v64, v64
  v_exp_f32 v65, v65
  v_exp_f32 v66, v66
  v_exp_f32 v67, v67
  v_cvt_pk_bf16_f32 v96, v64, v65
  v_exp_f32 v68, v68
  s_waitcnt lgkmcnt(2)
  v_mfma_f32_32x32x8bf16_1k v[80:95], v[184:185], v[212:213], v[80:95]
  buffer_load_dwordx4 v11, s[40:43], s67 offen offset:3072 lds
  v_exp_f32 v69, v69
  v_cvt_pk_bf16_f32 v97, v66, v67
  v_exp_f32 v70, v70
  v_exp_f32 v71, v71
  v_cvt_pk_bf16_f32 v98, v68, v69
  v_exp_f32 v72, v72
  s_waitcnt lgkmcnt(1)
  v_mfma_f32_32x32x16_bf16 v[112:127], v[196:199], v[104:107], v[112:127]
  v_exp_f32 v73, v73
  v_cvt_pk_bf16_f32 v99, v70, v71
  v_exp_f32 v74, v74
  v_exp_f32 v75, v75
  v_cvt_pk_bf16_f32 v100, v72, v73
  v_exp_f32 v76, v76
  s_waitcnt lgkmcnt(0)
  v_mfma_f32_32x32x16_bf16 v[112:127], v[200:203], v[108:111], v[112:127]
  v_exp_f32 v77, v77
  v_cvt_pk_bf16_f32 v101, v74, v75
  v_exp_f32 v78, v78
  v_exp_f32 v79, v79
  v_cvt_pk_bf16_f32 v102, v76, v77
  v_cvt_pk_bf16_f32 v103, v78, v79
  v_mfma_f32_32x32x16_bf16 v[64:79], v[176:179], v[208:211], v[160:175]
  ds_read_b128 v[180:183], v2 offset:0
  s_add_u32 m0, s8, 4096
  s_nop 0
  buffer_load_dwordx4 v12, s[40:43], s67 offen lds
  v_exp_f32 v80, v80
  v_exp_f32 v81, v81
  v_exp_f32 v82, v82
  v_exp_f32 v83, v83
  v_cvt_pk_bf16_f32 v104, v80, v81
  v_exp_f32 v84, v84
  s_cmp_gt_u32 s66, 9
  s_cselect_b32 s65, 1.0, 0x3f80f149
  v_mov_b32 v186, s65
  v_mfma_f32_32x32x8bf16_1k v[64:79], v[184:185], v[214:215], v[64:79]
  s_mov_b32 exec_hi, 0
  ds_read_b64 v[186:187], v3 offset:0
  s_mov_b64 exec, -1
  v_exp_f32 v85, v85
  v_cvt_pk_bf16_f32 v105, v82, v83
  v_exp_f32 v86, v86
  v_exp_f32 v87, v87
  v_cvt_pk_bf16_f32 v106, v84, v85
  v_exp_f32 v88, v88
  v_mfma_f32_32x32x16_bf16 v[128:143], v[196:199], v[96:99], v[128:143]
  s_mov_b64 exec, s[62:63]
  ds_read_b128 v[188:191], v4 offset:1280
  ds_read_b128 v[192:195], v4 offset:1920
  s_mov_b64 exec, -1
  v_exp_f32 v89, v89
  v_cvt_pk_bf16_f32 v107, v86, v87
  v_exp_f32 v90, v90
  v_exp_f32 v91, v91
  v_cvt_pk_bf16_f32 v108, v88, v89
  v_exp_f32 v92, v92
  v_mfma_f32_32x32x16_bf16 v[128:143], v[200:203], v[100:103], v[128:143]
  v_exp_f32 v93, v93
  v_cvt_pk_bf16_f32 v109, v90, v91
  v_exp_f32 v94, v94
  v_exp_f32 v95, v95
  v_cvt_pk_bf16_f32 v110, v92, v93
  v_cvt_pk_bf16_f32 v111, v94, v95
  s_waitcnt lgkmcnt(3)
  v_mfma_f32_32x32x16_bf16 v[80:95], v[180:183], v[204:207], v[160:175]
  v_exp_f32 v64, v64
  v_exp_f32 v65, v65
  v_exp_f32 v66, v66
  v_exp_f32 v67, v67
  v_cvt_pk_bf16_f32 v96, v64, v65
  v_exp_f32 v68, v68
  s_waitcnt lgkmcnt(2)
  v_mfma_f32_32x32x8bf16_1k v[80:95], v[186:187], v[212:213], v[80:95]
  v_exp_f32 v69, v69
  v_cvt_pk_bf16_f32 v97, v66, v67
  v_exp_f32 v70, v70
  v_exp_f32 v71, v71
  v_cvt_pk_bf16_f32 v98, v68, v69
  v_exp_f32 v72, v72
  s_waitcnt lgkmcnt(1)
  v_mfma_f32_32x32x16_bf16 v[112:127], v[188:191], v[104:107], v[112:127]
  v_exp_f32 v73, v73
  v_cvt_pk_bf16_f32 v99, v70, v71
  v_exp_f32 v74, v74
  v_exp_f32 v75, v75
  v_cvt_pk_bf16_f32 v100, v72, v73
  v_exp_f32 v76, v76
  s_waitcnt lgkmcnt(0)
  v_mfma_f32_32x32x16_bf16 v[112:127], v[192:195], v[108:111], v[112:127]
  v_exp_f32 v77, v77
  v_cvt_pk_bf16_f32 v101, v74, v75
  v_exp_f32 v78, v78
  v_exp_f32 v79, v79
  v_cvt_pk_bf16_f32 v102, v76, v77
  v_cvt_pk_bf16_f32 v103, v78, v79
  v_mfma_f32_32x32x16_bf16 v[128:143], v[188:191], v[96:99], v[128:143]
  s_mov_b64 exec, s[62:63]
  ds_read_b128 v[196:199], v4 offset:0
  ds_read_b128 v[200:203], v4 offset:640
  s_mov_b64 exec, -1
  v_exp_f32 v80, v80
  v_exp_f32 v81, v81
  v_exp_f32 v82, v82
  v_exp_f32 v83, v83
  v_cvt_pk_bf16_f32 v104, v80, v81
  v_exp_f32 v84, v84
  v_exp_f32 v85, v85
  v_cvt_pk_bf16_f32 v105, v82, v83
  v_exp_f32 v86, v86
  v_exp_f32 v87, v87
  v_cvt_pk_bf16_f32 v106, v84, v85
  v_exp_f32 v88, v88
  v_mfma_f32_32x32x16_bf16 v[128:143], v[192:195], v[100:103], v[128:143]
  v_exp_f32 v89, v89
  v_cvt_pk_bf16_f32 v107, v86, v87
  v_exp_f32 v90, v90
  v_exp_f32 v91, v91
  v_cvt_pk_bf16_f32 v108, v88, v89
  v_exp_f32 v92, v92
  v_exp_f32 v93, v93
  v_cvt_pk_bf16_f32 v109, v90, v91
  v_exp_f32 v94, v94
  v_exp_f32 v95, v95
  v_cvt_pk_bf16_f32 v110, v92, v93
  v_cvt_pk_bf16_f32 v111, v94, v95
  s_waitcnt lgkmcnt(1)
  v_mfma_f32_32x32x16_bf16 v[112:127], v[196:199], v[104:107], v[112:127]
  s_waitcnt lgkmcnt(0)
  v_mfma_f32_32x32x16_bf16 v[112:127], v[200:203], v[108:111], v[112:127]
  s_mov_b32 s70, 0x25800000
  v_mov_b32 v16, 0x5d800000
  v_med3_f32 v17, v140, s70, v16
  v_rcp_f32 v19, v140
  v_cmp_neq_f32 s[72:73], v17, v140
  s_nop 6
  v_med3_f32 v17, v124, s70, v16
  v_rcp_f32 v18, v124
  v_cmp_neq_f32 vcc, v17, v124
  s_nop 0
  s_or_b64 vcc, vcc, s[72:73]
  s_cbranch_vccnz Lslow
Lattok:
  s_mov_b32 s72, 9437184
  s_mov_b32 s73, 11796480
  v_pk_mul_f32 v[128:129], v[128:129], v[18:19] op_sel:[0,1] op_sel_hi:[1,1]
  v_pk_mul_f32 v[130:131], v[130:131], v[18:19] op_sel:[0,1] op_sel_hi:[1,1]
  v_pk_mul_f32 v[132:133], v[132:133], v[18:19] op_sel:[0,1] op_sel_hi:[1,1]
  v_pk_mul_f32 v[134:135], v[134:135], v[18:19] op_sel:[0,1] op_sel_hi:[1,1]
  v_pk_mul_f32 v[136:137], v[136:137], v[18:19] op_sel:[0,1] op_sel_hi:[1,1]
  v_pk_mul_f32 v[138:139], v[138:139], v[18:19] op_sel:[0,1] op_sel_hi:[1,1]
  v_cvt_pk_bf16_f32 v128, v128, v129
  v_cvt_pk_bf16_f32 v129, v130, v131
  v_cvt_pk_bf16_f32 v130, v132, v133
  v_cvt_pk_bf16_f32 v131, v134, v135
  v_cvt_pk_bf16_f32 v132, v136, v137
  v_cvt_pk_bf16_f32 v133, v138, v139
  buffer_store_dwordx4 v[128:131], v5, s[28:31], s72 offen offset:512 sc1
  s_mov_b32 exec_hi, 0
  buffer_store_dwordx2 v[132:133], v6, s[28:31], s73 offen offset:256 sc1
  s_mov_b64 exec, -1
  v_pk_mul_f32 v[112:113], v[112:113], v[18:19] op_sel:[0,0] op_sel_hi:[1,0]
  v_pk_mul_f32 v[114:115], v[114:115], v[18:19] op_sel:[0,0] op_sel_hi:[1,0]
  v_pk_mul_f32 v[116:117], v[116:117], v[18:19] op_sel:[0,0] op_sel_hi:[1,0]
  v_pk_mul_f32 v[118:119], v[118:119], v[18:19] op_sel:[0,0] op_sel_hi:[1,0]
  v_pk_mul_f32 v[120:121], v[120:121], v[18:19] op_sel:[0,0] op_sel_hi:[1,0]
  v_pk_mul_f32 v[122:123], v[122:123], v[18:19] op_sel:[0,0] op_sel_hi:[1,0]
  v_cvt_pk_bf16_f32 v112, v112, v113
  v_cvt_pk_bf16_f32 v113, v114, v115
  v_cvt_pk_bf16_f32 v114, v116, v117
  v_cvt_pk_bf16_f32 v115, v118, v119
  v_cvt_pk_bf16_f32 v116, v120, v121
  v_cvt_pk_bf16_f32 v117, v122, v123
  buffer_store_dwordx4 v[112:115], v5, s[28:31], s72 offen offset:0 sc1
  s_mov_b32 exec_hi, 0
  buffer_store_dwordx2 v[116:117], v6, s[28:31], s73 offen offset:0 sc1
  s_mov_b64 exec, -1
  s_lshl2_add_u32 s70, s13, s58
  s_lshl_b32 s70, s70, 7
  s_add_u32 s70, s70, 524288
  v_mov_b32 v16, s59
  s_waitcnt vmcnt(0)
  s_mov_b64 exec, 1
  buffer_store_dword v16, off, s[28:31], s70 sc1
  s_mov_b64 exec, -1
  s_barrier
  s_mul_i32 s3, s58, 12288
  s_mul_i32 s4, s12, 1536
  s_add_u32 s3, s3, 114688
  s_and_b32 s4, s4, 0xfffff800
  v_add_u32 v248, 663552, v244
  v_add_u32 v249, 663552, v245
  s_add_u32 m0, s4, s3
  s_mul_i32 s5, s4, 27
  buffer_load_dwordx4 v248, s[44:47], s5 offen lds
  buffer_load_dwordx4 v249, s[44:47], s5 offen offset:1024 lds
  s_addk_i32 s4, 2048
  s_cmpk_eq_u32 s4, 12288
  s_cmovk_i32 s4, 0
  s_add_u32 m0, s4, s3
  s_mul_i32 s5, s4, 27
  buffer_load_dwordx4 v248, s[44:47], s5 offen lds
  buffer_load_dwordx4 v249, s[44:47], s5 offen offset:1024 lds
  s_addk_i32 s4, 2048
  s_cmpk_eq_u32 s4, 12288
  s_cmovk_i32 s4, 0
  s_add_u32 m0, s4, s3
  s_mul_i32 s5, s4, 27
  buffer_load_dwordx4 v248, s[44:47], s5 offen lds
  buffer_load_dwordx4 v249, s[44:47], s5 offen offset:1024 lds
  s_addk_i32 s4, 2048
  s_cmpk_eq_u32 s4, 12288
  s_cmovk_i32 s4, 0
  s_add_u32 m0, s4, s3
  s_mul_i32 s5, s4, 27
  buffer_load_dwordx4 v248, s[44:47], s5 offen lds
  buffer_load_dwordx4 v249, s[44:47], s5 offen offset:1024 lds
  s_addk_i32 s4, 2048
  s_cmpk_eq_u32 s4, 12288
  s_cmovk_i32 s4, 0
  s_add_u32 m0, s4, s3
  s_mul_i32 s5, s4, 27
  buffer_load_dwordx4 v248, s[44:47], s5 offen lds
  buffer_load_dwordx4 v249, s[44:47], s5 offen offset:1024 lds
  s_addk_i32 s4, 2048
  s_cmpk_eq_u32 s4, 12288
  s_cmovk_i32 s4, 0
  s_add_u32 m0, s4, s3
  s_mul_i32 s5, s4, 27
  buffer_load_dwordx4 v248, s[44:47], s5 offen lds
  buffer_load_dwordx4 v249, s[44:47], s5 offen offset:1024 lds
  s_lshr_b32 s70, s10, 2
  s_lshl_b32 s70, s70, 5
  s_lshl3_add_u32 s70, s58, s70
  v_and_b32 v16, 7, v1
  v_add_lshl_u32 v2, s70, v16, 9
  s_and_b32 s72, s10, 3
  s_lshl_b32 s72, s72, 7
  s_add_u32 s72, s72, 524288
  s_mov_b64 exec, 0xff
  buffer_load_dword v20, v2, s[28:31], s72 offen sc1
  s_mov_b64 exec, -1
  v_lshrrev_b32 v16, 4, v1
  v_and_b32 v17, 15, v1
  s_lshl2_add_u32 s73, s10, s58
  s_lshl_b32 s70, s73, 4
  v_add_u32 v18, s70, v17
  v_mul_u32_u24 v19, 33280, v16
  v_lshl_add_u32 v3, v18, 4, v19
  v_lshrrev_b32 v21, 1, v16
  v_and_b32 v22, 1, v16
  v_lshl_add_u32 v19, v21, 2, v22
  v_mul_u32_u24 v19, 16640, v19
  v_lshl_add_u32 v4, v18, 3, v19
  v_lshlrev_b32 v19, 8, v21
  v_lshl_add_u32 v19, v17, 4, v19
  v_lshl_add_u32 v13, v22, 3, v19
  s_lshl_b32 s70, s73, 9
  v_add_u32 v10, s70, v13
  v_bfe_u32 v23, v1, 2, 2
  v_and_b32 v24, 3, v1
  v_lshlrev_b32 v24, 3, v24
  v_mad_u32_u24 v19, v21, 20, v23
  v_lshl_add_u32 v19, v22, 2, v19
  s_movk_i32 s70, 160
  v_mad_u32_u24 v19, v19, s70, v24
  v_add_u32 v5, 0, v19
  v_add_u32 v6, 51200, v19
  v_lshl_add_u32 v19, v21, 2, v22
  v_mad_u32_u24 v19, v19, 20, v23
  v_mad_u32_u24 v19, v19, s70, v24
  v_add_u32 v7, 2560, v19
  v_add_u32 v8, 53760, v19
  s_mul_i32 s71, s58, 2560
  s_add_u32 s71, s71, 102400
  v_lshrrev_b32 v19, 2, v1
  v_mad_u32_u24 v25, v19, s70, v24
  v_add_u32 v9, s71, v25
  v_lshlrev_b32 v25, 3, v16
  v_lshl_add_u32 v25, v17, 5, v25
  v_add_u32 v11, s71, v25
  v_lshl_add_u32 v12, v1, 3, s71
  v_lshlrev_b32 v14, 4, v19
  v_lshl_add_u32 v15, v24, 8, v14
  ds_read_b64_tr_b16 v[26:27], v9 offset:0
  ds_read_b64_tr_b16 v[28:29], v9 offset:32
  ds_read_b64_tr_b16 v[30:31], v9 offset:64
  ds_read_b64_tr_b16 v[32:33], v9 offset:96
  ds_read_b64_tr_b16 v[34:35], v9 offset:128
  v_add_u32 v224, 0, v3
  s_mov_b32 s62, 9437184
  s_mov_b32 s66, 11796480
  v_add_u32 v225, 133120, v3
  s_mov_b32 s63, 9969664
  s_mov_b32 s67, 11929600
  v_add_u32 v226, 266240, v3
  s_mov_b32 s64, 10502144
  s_mov_b32 s68, 12062720
  v_add_u32 v227, 399360, v3
  s_mov_b32 s65, 11034624
  s_mov_b32 s69, 12195840
  v_mov_b32 v228, v4
  v_add_u32 v229, 33280, v4
  s_waitcnt lgkmcnt(4)
  v_lshlrev_b32 v40, 16, v26
  v_and_b32 v41, 0xffff0000, v26
  v_lshlrev_b32 v42, 16, v27
  v_and_b32 v43, 0xffff0000, v27
  s_waitcnt lgkmcnt(3)
  v_lshlrev_b32 v44, 16, v28
  v_and_b32 v45, 0xffff0000, v28
  v_lshlrev_b32 v46, 16, v29
  v_and_b32 v47, 0xffff0000, v29
  s_waitcnt lgkmcnt(2)
  v_lshlrev_b32 v48, 16, v30
  v_and_b32 v49, 0xffff0000, v30
  v_lshlrev_b32 v50, 16, v31
  v_and_b32 v51, 0xffff0000, v31
  s_waitcnt lgkmcnt(1)
  v_lshlrev_b32 v52, 16, v32
  v_and_b32 v53, 0xffff0000, v32
  v_lshlrev_b32 v54, 16, v33
  v_and_b32 v55, 0xffff0000, v33
  s_waitcnt lgkmcnt(0)
  v_lshlrev_b32 v56, 16, v34
  v_and_b32 v57, 0xffff0000, v34
  v_lshlrev_b32 v58, 16, v35
  v_and_b32 v59, 0xffff0000, v35
  ds_read_b64_tr_b16 v[144:145], v5 offset:0
  ds_read_b64_tr_b16 v[146:147], v5 offset:1280
  ds_read_b64_tr_b16 v[148:149], v5 offset:32
  ds_read_b64_tr_b16 v[150:151], v5 offset:1312
  ds_read_b64_tr_b16 v[152:153], v5 offset:64
  ds_read_b64_tr_b16 v[154:155], v5 offset:1344
  ds_read_b64_tr_b16 v[156:157], v5 offset:96
  ds_read_b64_tr_b16 v[158:159], v5 offset:1376
  ds_read_b64_tr_b16 v[160:161], v5 offset:128
  ds_read_b64_tr_b16 v[162:163], v5 offset:1408
  ds_read_b64_tr_b16 v[164:165], v5 offset:6400
  ds_read_b64_tr_b16 v[166:167], v5 offset:7680
  ds_read_b64_tr_b16 v[168:169], v5 offset:6432
  ds_read_b64_tr_b16 v[170:171], v5 offset:7712
  ds_read_b64_tr_b16 v[172:173], v5 offset:6464
  ds_read_b64_tr_b16 v[174:175], v5 offset:7744
  ds_read_b64_tr_b16 v[176:177], v5 offset:6496
  ds_read_b64_tr_b16 v[178:179], v5 offset:7776
  ds_read_b64_tr_b16 v[180:181], v5 offset:6528
  ds_read_b64_tr_b16 v[182:183], v5 offset:7808
  ds_read_b64_tr_b16 v[184:185], v5 offset:12800
  ds_read_b64_tr_b16 v[186:187], v5 offset:14080
  ds_read_b64_tr_b16 v[188:189], v5 offset:12832
  ds_read_b64_tr_b16 v[190:191], v5 offset:14112
  ds_read_b64_tr_b16 v[192:193], v5 offset:12864
  ds_read_b64_tr_b16 v[194:195], v5 offset:14144
  ds_read_b64_tr_b16 v[196:197], v5 offset:12896
  ds_read_b64_tr_b16 v[198:199], v5 offset:14176
  ds_read_b64_tr_b16 v[200:201], v5 offset:12928
  ds_read_b64_tr_b16 v[202:203], v5 offset:14208
  ds_read_b64_tr_b16 v[204:205], v5 offset:19200
  ds_read_b64_tr_b16 v[206:207], v5 offset:20480
  ds_read_b64_tr_b16 v[208:209], v5 offset:19232
  ds_read_b64_tr_b16 v[210:211], v5 offset:20512
  ds_read_b64_tr_b16 v[212:213], v5 offset:19264
  ds_read_b64_tr_b16 v[214:215], v5 offset:20544
  ds_read_b64_tr_b16 v[216:217], v5 offset:19296
  ds_read_b64_tr_b16 v[218:219], v5 offset:20576
  ds_read_b64_tr_b16 v[220:221], v5 offset:19328
  ds_read_b64_tr_b16 v[222:223], v5 offset:20608
  s_mov_b64 exec, 0xff
  s_waitcnt vmcnt(0)
  v_cmp_ne_u32 vcc, s59, v20
  s_cbranch_vccz Ld10
Lp9:
  buffer_load_dword v20, v2, s[28:31], s72 offen sc1
  s_waitcnt vmcnt(0) lgkmcnt(0)
  v_cmp_ne_u32 vcc, s59, v20
  s_cbranch_vccz Ld10
  s_sub_u32 s61, s61, 1
  s_cbranch_scc0 Lp9
  s_branch Lexit
Ld10:
  s_mov_b64 exec, -1
  s_barrier
  buffer_load_dwordx4 v[64:67], v224, s[28:31], s62 offen
  buffer_load_dwordx4 v[68:71], v225, s[28:31], s62 offen
  buffer_load_dwordx4 v[72:75], v226, s[28:31], s62 offen
  buffer_load_dwordx4 v[76:79], v227, s[28:31], s62 offen
  buffer_load_dwordx4 v[80:83], v224, s[28:31], s63 offen
  buffer_load_dwordx4 v[84:87], v225, s[28:31], s63 offen
  buffer_load_dwordx4 v[88:91], v226, s[28:31], s63 offen
  buffer_load_dwordx4 v[92:95], v227, s[28:31], s63 offen
  buffer_load_dwordx4 v[96:99], v224, s[28:31], s64 offen
  buffer_load_dwordx4 v[100:103], v225, s[28:31], s64 offen
  buffer_load_dwordx4 v[104:107], v226, s[28:31], s64 offen
  buffer_load_dwordx4 v[108:111], v227, s[28:31], s64 offen
  s_mul_i32 s17, s58, 12288
  s_add_u32 s17, s17, 114688
  v_add_u32 v252, s17, v250
  v_xor_b32 v253, 32, v252
  v_xor_b32 v254, 64, v252
  v_xor_b32 v255, 96, v252
  ds_read_b64_tr_b16 a[96:97], v252 offset:0
  ds_read_b64_tr_b16 a[98:99], v252 offset:512
  ds_read_b64_tr_b16 a[100:101], v253 offset:0
  ds_read_b64_tr_b16 a[102:103], v253 offset:512
  ds_read_b64_tr_b16 a[104:105], v254 offset:0
  ds_read_b64_tr_b16 a[106:107], v254 offset:512
  ds_read_b64_tr_b16 a[108:109], v255 offset:0
  ds_read_b64_tr_b16 a[110:111], v255 offset:512
  ds_read_b64_tr_b16 a[112:113], v252 offset:4096
  ds_read_b64_tr_b16 a[114:115], v252 offset:4608
  ds_read_b64_tr_b16 a[116:117], v253 offset:4096
  ds_read_b64_tr_b16 a[118:119], v253 offset:4608
  ds_read_b64_tr_b16 a[120:121], v254 offset:4096
  ds_read_b64_tr_b16 a[122:123], v254 offset:4608
  ds_read_b64_tr_b16 a[124:125], v255 offset:4096
  ds_read_b64_tr_b16 a[126:127], v255 offset:4608
  ds_read_b64_tr_b16 a[128:129], v252 offset:8192
  ds_read_b64_tr_b16 a[130:131], v252 offset:8704
  ds_read_b64_tr_b16 a[132:133], v253 offset:8192
  ds_read_b64_tr_b16 a[134:135], v253 offset:8704
  ds_read_b64_tr_b16 a[136:137], v254 offset:8192
  ds_read_b64_tr_b16 a[138:139], v254 offset:8704
  ds_read_b64_tr_b16 a[140:141], v255 offset:8192
  ds_read_b64_tr_b16 a[142:143], v255 offset:8704
  s_waitcnt vmcnt(11) lgkmcnt(15)
  v_mfma_f32_16x16x32_bf16 v[40:43], v[64:67], v[144:147], v[40:43]
  ds_read_b64_tr_b16 v[144:145], v5 offset:25600
  ds_read_b64_tr_b16 v[146:147], v5 offset:26880
  v_mfma_f32_16x16x32_bf16 v[44:47], v[64:67], v[148:151], v[44:47]
  ds_read_b64_tr_b16 v[148:149], v5 offset:25632
  ds_read_b64_tr_b16 v[150:151], v5 offset:26912
  buffer_load_dwordx4 v[112:115], v224, s[28:31], s65 offen
  v_mfma_f32_16x16x32_bf16 v[48:51], v[64:67], v[152:155], v[48:51]
  ds_read_b64_tr_b16 v[152:153], v5 offset:25664
  ds_read_b64_tr_b16 v[154:155], v5 offset:26944
  v_mfma_f32_16x16x32_bf16 v[52:55], v[64:67], v[156:159], v[52:55]
  ds_read_b64_tr_b16 v[156:157], v5 offset:25696
  ds_read_b64_tr_b16 v[158:159], v5 offset:26976
  buffer_load_dwordx4 v[116:119], v225, s[28:31], s65 offen
  v_mfma_f32_16x16x32_bf16 v[56:59], v[64:67], v[160:163], v[56:59]
  ds_read_b64_tr_b16 v[160:161], v5 offset:25728
  ds_read_b64_tr_b16 v[162:163], v5 offset:27008
  s_waitcnt vmcnt(12)
  v_mfma_f32_16x16x32_bf16 v[40:43], v[68:71], v[164:167], v[40:43]
  ds_read_b64_tr_b16 v[164:165], v5 offset:32000
  ds_read_b64_tr_b16 v[166:167], v5 offset:33280
  v_mfma_f32_16x16x32_bf16 v[44:47], v[68:71], v[168:171], v[44:47]
  ds_read_b64_tr_b16 v[168:169], v5 offset:32032
  ds_read_b64_tr_b16 v[170:171], v5 offset:33312
  buffer_load_dwordx4 v[120:123], v226, s[28:31], s65 offen
  v_mfma_f32_16x16x32_bf16 v[48:51], v[68:71], v[172:175], v[48:51]
  ds_read_b64_tr_b16 v[172:173], v5 offset:32064
  ds_read_b64_tr_b16 v[174:175], v5 offset:33344
  v_mfma_f32_16x16x32_bf16 v[52:55], v[68:71], v[176:179], v[52:55]
  ds_read_b64_tr_b16 v[176:177], v5 offset:32096
  ds_read_b64_tr_b16 v[178:179], v5 offset:33376
  buffer_load_dwordx4 v[124:127], v227, s[28:31], s65 offen
  v_mfma_f32_16x16x32_bf16 v[56:59], v[68:71], v[180:183], v[56:59]
  ds_read_b64_tr_b16 v[180:181], v5 offset:32128
  ds_read_b64_tr_b16 v[182:183], v5 offset:33408
  s_waitcnt vmcnt(13)
  v_mfma_f32_16x16x32_bf16 v[40:43], v[72:75], v[184:187], v[40:43]
  ds_read_b64_tr_b16 v[184:185], v5 offset:38400
  ds_read_b64_tr_b16 v[186:187], v5 offset:39680
  v_mfma_f32_16x16x32_bf16 v[44:47], v[72:75], v[188:191], v[44:47]
  ds_read_b64_tr_b16 v[188:189], v5 offset:38432
  ds_read_b64_tr_b16 v[190:191], v5 offset:39712
  buffer_load_dwordx2 v[128:129], v228, s[28:31], s66 offen
  v_mfma_f32_16x16x32_bf16 v[48:51], v[72:75], v[192:195], v[48:51]
  ds_read_b64_tr_b16 v[192:193], v5 offset:38464
  ds_read_b64_tr_b16 v[194:195], v5 offset:39744
  v_mfma_f32_16x16x32_bf16 v[52:55], v[72:75], v[196:199], v[52:55]
  ds_read_b64_tr_b16 v[196:197], v5 offset:38496
  ds_read_b64_tr_b16 v[198:199], v5 offset:39776
  buffer_load_dwordx2 v[130:131], v229, s[28:31], s66 offen
  v_mfma_f32_16x16x32_bf16 v[56:59], v[72:75], v[200:203], v[56:59]
  ds_read_b64_tr_b16 v[200:201], v5 offset:38528
  ds_read_b64_tr_b16 v[202:203], v5 offset:39808
  s_waitcnt vmcnt(14)
  v_mfma_f32_16x16x32_bf16 v[40:43], v[76:79], v[204:207], v[40:43]
  ds_read_b64_tr_b16 v[204:205], v5 offset:44800
  ds_read_b64_tr_b16 v[206:207], v5 offset:46080
  v_mfma_f32_16x16x32_bf16 v[44:47], v[76:79], v[208:211], v[44:47]
  ds_read_b64_tr_b16 v[208:209], v5 offset:44832
  ds_read_b64_tr_b16 v[210:211], v5 offset:46112
  buffer_load_dwordx2 v[132:133], v228, s[28:31], s67 offen
  v_mfma_f32_16x16x32_bf16 v[48:51], v[76:79], v[212:215], v[48:51]
  ds_read_b64_tr_b16 v[212:213], v5 offset:44864
  ds_read_b64_tr_b16 v[214:215], v5 offset:46144
  v_mfma_f32_16x16x32_bf16 v[52:55], v[76:79], v[216:219], v[52:55]
  ds_read_b64_tr_b16 v[216:217], v5 offset:44896
  ds_read_b64_tr_b16 v[218:219], v5 offset:46176
  buffer_load_dwordx2 v[134:135], v229, s[28:31], s67 offen
  v_mfma_f32_16x16x32_bf16 v[56:59], v[76:79], v[220:223], v[56:59]
  ds_read_b64_tr_b16 v[220:221], v5 offset:44928
  ds_read_b64_tr_b16 v[222:223], v5 offset:46208
  s_waitcnt vmcnt(15) lgkmcnt(15)
  v_mfma_f32_16x16x32_bf16 v[40:43], v[80:83], v[144:147], v[40:43]
  ds_read_b64_tr_b16 v[144:145], v6 offset:0
  ds_read_b64_tr_b16 v[146:147], v6 offset:1280
  v_mfma_f32_16x16x32_bf16 v[44:47], v[80:83], v[148:151], v[44:47]
  ds_read_b64_tr_b16 v[148:149], v6 offset:32
  ds_read_b64_tr_b16 v[150:151], v6 offset:1312
  buffer_load_dwordx2 v[136:137], v228, s[28:31], s68 offen
  v_mfma_f32_16x16x32_bf16 v[48:51], v[80:83], v[152:155], v[48:51]
  ds_read_b64_tr_b16 v[152:153], v6 offset:64
  ds_read_b64_tr_b16 v[154:155], v6 offset:1344
  v_mfma_f32_16x16x32_bf16 v[52:55], v[80:83], v[156:159], v[52:55]
  ds_read_b64_tr_b16 v[156:157], v6 offset:96
  ds_read_b64_tr_b16 v[158:159], v6 offset:1376
  buffer_load_dwordx2 v[138:139], v229, s[28:31], s68 offen
  v_mfma_f32_16x16x32_bf16 v[56:59], v[80:83], v[160:163], v[56:59]
  ds_read_b64_tr_b16 v[160:161], v6 offset:128
  ds_read_b64_tr_b16 v[162:163], v6 offset:1408
  s_waitcnt vmcnt(16)
  v_mfma_f32_16x16x32_bf16 v[40:43], v[84:87], v[164:167], v[40:43]
  ds_read_b64_tr_b16 v[164:165], v6 offset:6400
  ds_read_b64_tr_b16 v[166:167], v6 offset:7680
  v_mfma_f32_16x16x32_bf16 v[44:47], v[84:87], v[168:171], v[44:47]
  ds_read_b64_tr_b16 v[168:169], v6 offset:6432
  ds_read_b64_tr_b16 v[170:171], v6 offset:7712
  buffer_load_dwordx2 v[140:141], v228, s[28:31], s69 offen
  v_mfma_f32_16x16x32_bf16 v[48:51], v[84:87], v[172:175], v[48:51]
  ds_read_b64_tr_b16 v[172:173], v6 offset:6464
  ds_read_b64_tr_b16 v[174:175], v6 offset:7744
  v_mfma_f32_16x16x32_bf16 v[52:55], v[84:87], v[176:179], v[52:55]
  ds_read_b64_tr_b16 v[176:177], v6 offset:6496
  ds_read_b64_tr_b16 v[178:179], v6 offset:7776
  buffer_load_dwordx2 v[142:143], v229, s[28:31], s69 offen
  v_mfma_f32_16x16x32_bf16 v[56:59], v[84:87], v[180:183], v[56:59]
  ds_read_b64_tr_b16 v[180:181], v6 offset:6528
  ds_read_b64_tr_b16 v[182:183], v6 offset:7808
  s_waitcnt vmcnt(17)
  v_mfma_f32_16x16x32_bf16 v[40:43], v[88:91], v[184:187], v[40:43]
  ds_read_b64_tr_b16 v[184:185], v6 offset:12800
  ds_read_b64_tr_b16 v[186:187], v6 offset:14080
  v_mfma_f32_16x16x32_bf16 v[44:47], v[88:91], v[188:191], v[44:47]
  ds_read_b64_tr_b16 v[188:189], v6 offset:12832
  ds_read_b64_tr_b16 v[190:191], v6 offset:14112
  s_waitcnt lgkmcnt(15)
  v_mfma_f32_16x16x32_bf16 v[48:51], v[88:91], v[192:195], v[48:51]
  ds_read_b64_tr_b16 v[192:193], v6 offset:12864
  ds_read_b64_tr_b16 v[194:195], v6 offset:14144
  v_mfma_f32_16x16x32_bf16 v[52:55], v[88:91], v[196:199], v[52:55]
  ds_read_b64_tr_b16 v[196:197], v6 offset:12896
  ds_read_b64_tr_b16 v[198:199], v6 offset:14176
  s_mul_i32 s3, s58, 12288
  s_mul_i32 s4, s12, 1536
  s_add_u32 s3, s3, 114688
  s_and_b32 s4, s4, 0xfffff800
  v_add_u32 v248, 995328, v244
  v_add_u32 v249, 995328, v245
  v_mfma_f32_16x16x32_bf16 v[56:59], v[88:91], v[200:203], v[56:59]
  ds_read_b64_tr_b16 v[200:201], v6 offset:12928
  ds_read_b64_tr_b16 v[202:203], v6 offset:14208
  s_waitcnt vmcnt(16)
  v_mfma_f32_16x16x32_bf16 v[40:43], v[92:95], v[204:207], v[40:43]
  ds_read_b64_tr_b16 v[204:205], v6 offset:19200
  ds_read_b64_tr_b16 v[206:207], v6 offset:20480
  v_mfma_f32_16x16x32_bf16 v[44:47], v[92:95], v[208:211], v[44:47]
  ds_read_b64_tr_b16 v[208:209], v6 offset:19232
  ds_read_b64_tr_b16 v[210:211], v6 offset:20512
  s_add_u32 m0, s4, s3
  s_mul_i32 s5, s4, 27
  buffer_load_dwordx4 v248, s[44:47], s5 offen lds
  v_mfma_f32_16x16x32_bf16 v[48:51], v[92:95], v[212:215], v[48:51]
  ds_read_b64_tr_b16 v[212:213], v6 offset:19264
  ds_read_b64_tr_b16 v[214:215], v6 offset:20544
  v_mfma_f32_16x16x32_bf16 v[52:55], v[92:95], v[216:219], v[52:55]
  ds_read_b64_tr_b16 v[216:217], v6 offset:19296
  ds_read_b64_tr_b16 v[218:219], v6 offset:20576
  buffer_load_dwordx4 v249, s[44:47], s5 offen offset:1024 lds
  s_addk_i32 s4, 2048
  s_cmpk_eq_u32 s4, 12288
  s_cmovk_i32 s4, 0
  v_mfma_f32_16x16x32_bf16 v[56:59], v[92:95], v[220:223], v[56:59]
  ds_read_b64_tr_b16 v[220:221], v6 offset:19328
  ds_read_b64_tr_b16 v[222:223], v6 offset:20608
  s_waitcnt vmcnt(17)
  v_mfma_f32_16x16x32_bf16 v[40:43], v[96:99], v[144:147], v[40:43]
  ds_read_b64_tr_b16 v[144:145], v6 offset:25600
  ds_read_b64_tr_b16 v[146:147], v6 offset:26880
  v_mfma_f32_16x16x32_bf16 v[44:47], v[96:99], v[148:151], v[44:47]
  ds_read_b64_tr_b16 v[148:149], v6 offset:25632
  ds_read_b64_tr_b16 v[150:151], v6 offset:26912
  s_add_u32 m0, s4, s3
  s_mul_i32 s5, s4, 27
  buffer_load_dwordx4 v248, s[44:47], s5 offen lds
  v_mfma_f32_16x16x32_bf16 v[48:51], v[96:99], v[152:155], v[48:51]
  ds_read_b64_tr_b16 v[152:153], v6 offset:25664
  ds_read_b64_tr_b16 v[154:155], v6 offset:26944
  v_mfma_f32_16x16x32_bf16 v[52:55], v[96:99], v[156:159], v[52:55]
  ds_read_b64_tr_b16 v[156:157], v6 offset:25696
  ds_read_b64_tr_b16 v[158:159], v6 offset:26976
  buffer_load_dwordx4 v249, s[44:47], s5 offen offset:1024 lds
  s_addk_i32 s4, 2048
  s_cmpk_eq_u32 s4, 12288
  s_cmovk_i32 s4, 0
  s_waitcnt lgkmcnt(15)
  v_mfma_f32_16x16x32_bf16 v[56:59], v[96:99], v[160:163], v[56:59]
  ds_read_b64_tr_b16 v[160:161], v6 offset:25728
  ds_read_b64_tr_b16 v[162:163], v6 offset:27008
  s_waitcnt vmcnt(18)
  v_mfma_f32_16x16x32_bf16 v[40:43], v[100:103], v[164:167], v[40:43]
  ds_read_b64_tr_b16 v[164:165], v6 offset:32000
  ds_read_b64_tr_b16 v[166:167], v6 offset:33280
  v_mfma_f32_16x16x32_bf16 v[44:47], v[100:103], v[168:171], v[44:47]
  ds_read_b64_tr_b16 v[168:169], v6 offset:32032
  ds_read_b64_tr_b16 v[170:171], v6 offset:33312
  s_add_u32 m0, s4, s3
  s_mul_i32 s5, s4, 27
  buffer_load_dwordx4 v248, s[44:47], s5 offen lds
  v_mfma_f32_16x16x32_bf16 v[48:51], v[100:103], v[172:175], v[48:51]
  ds_read_b64_tr_b16 v[172:173], v6 offset:32064
  ds_read_b64_tr_b16 v[174:175], v6 offset:33344
  v_mfma_f32_16x16x32_bf16 v[52:55], v[100:103], v[176:179], v[52:55]
  ds_read_b64_tr_b16 v[176:177], v6 offset:32096
  ds_read_b64_tr_b16 v[178:179], v6 offset:33376
  buffer_load_dwordx4 v249, s[44:47], s5 offen offset:1024 lds
  s_addk_i32 s4, 2048
  s_cmpk_eq_u32 s4, 12288
  s_cmovk_i32 s4, 0
  v_mfma_f32_16x16x32_bf16 v[56:59], v[100:103], v[180:183], v[56:59]
  ds_read_b64_tr_b16 v[180:181], v6 offset:32128
  ds_read_b64_tr_b16 v[182:183], v6 offset:33408
  s_waitcnt vmcnt(19)
  v_mfma_f32_16x16x32_bf16 v[40:43], v[104:107], v[184:187], v[40:43]
  ds_read_b64_tr_b16 v[184:185], v6 offset:38400
  ds_read_b64_tr_b16 v[186:187], v6 offset:39680
  v_mfma_f32_16x16x32_bf16 v[44:47], v[104:107], v[188:191], v[44:47]
  ds_read_b64_tr_b16 v[188:189], v6 offset:38432
  ds_read_b64_tr_b16 v[190:191], v6 offset:39712
  s_add_u32 m0, s4, s3
  s_mul_i32 s5, s4, 27
  buffer_load_dwordx4 v248, s[44:47], s5 offen lds
  v_mfma_f32_16x16x32_bf16 v[48:51], v[104:107], v[192:195], v[48:51]
  ds_read_b64_tr_b16 v[192:193], v6 offset:38464
  ds_read_b64_tr_b16 v[194:195], v6 offset:39744
  v_mfma_f32_16x16x32_bf16 v[52:55], v[104:107], v[196:199], v[52:55]
  ds_read_b64_tr_b16 v[196:197], v6 offset:38496
  ds_read_b64_tr_b16 v[198:199], v6 offset:39776
  buffer_load_dwordx4 v249, s[44:47], s5 offen offset:1024 lds
  s_addk_i32 s4, 2048
  s_cmpk_eq_u32 s4, 12288
  s_cmovk_i32 s4, 0
  v_mfma_f32_16x16x32_bf16 v[56:59], v[104:107], v[200:203], v[56:59]
  ds_read_b64_tr_b16 v[200:201], v6 offset:38528
  ds_read_b64_tr_b16 v[202:203], v6 offset:39808
  s_waitcnt vmcnt(20)
  v_mfma_f32_16x16x32_bf16 v[40:43], v[108:111], v[204:207], v[40:43]
  ds_read_b64_tr_b16 v[204:205], v6 offset:44800
  ds_read_b64_tr_b16 v[206:207], v6 offset:46080
  s_waitcnt lgkmcnt(15)
  v_mfma_f32_16x16x32_bf16 v[44:47], v[108:111], v[208:211], v[44:47]
  ds_read_b64_tr_b16 v[208:209], v6 offset:44832
  ds_read_b64_tr_b16 v[210:211], v6 offset:46112
  s_add_u32 m0, s4, s3
  s_mul_i32 s5, s4, 27
  buffer_load_dwordx4 v248, s[44:47], s5 offen lds
  v_mfma_f32_16x16x32_bf16 v[48:51], v[108:111], v[212:215], v[48:51]
  ds_read_b64_tr_b16 v[212:213], v6 offset:44864
  ds_read_b64_tr_b16 v[214:215], v6 offset:46144
  v_mfma_f32_16x16x32_bf16 v[52:55], v[108:111], v[216:219], v[52:55]
  ds_read_b64_tr_b16 v[216:217], v6 offset:44896
  ds_read_b64_tr_b16 v[218:219], v6 offset:46176
  buffer_load_dwordx4 v249, s[44:47], s5 offen offset:1024 lds
  s_addk_i32 s4, 2048
  s_cmpk_eq_u32 s4, 12288
  s_cmovk_i32 s4, 0
  v_mfma_f32_16x16x32_bf16 v[56:59], v[108:111], v[220:223], v[56:59]
  ds_read_b64_tr_b16 v[220:221], v6 offset:44928
  ds_read_b64_tr_b16 v[222:223], v6 offset:46208
  s_waitcnt vmcnt(21)
  v_mfma_f32_16x16x32_bf16 v[40:43], v[112:115], v[144:147], v[40:43]
  ds_read_b64_tr_b16 v[144:145], v7 offset:0
  ds_read_b64_tr_b16 v[146:147], v7 offset:6400
  v_mfma_f32_16x16x32_bf16 v[44:47], v[112:115], v[148:151], v[44:47]
  ds_read_b64_tr_b16 v[148:149], v7 offset:32
  ds_read_b64_tr_b16 v[150:151], v7 offset:6432
  s_add_u32 m0, s4, s3
  s_mul_i32 s5, s4, 27
  buffer_load_dwordx4 v248, s[44:47], s5 offen lds
  v_mfma_f32_16x16x32_bf16 v[48:51], v[112:115], v[152:155], v[48:51]
  ds_read_b64_tr_b16 v[152:153], v7 offset:64
  ds_read_b64_tr_b16 v[154:155], v7 offset:6464
  v_mfma_f32_16x16x32_bf16 v[52:55], v[112:115], v[156:159], v[52:55]
  ds_read_b64_tr_b16 v[156:157], v7 offset:96
  ds_read_b64_tr_b16 v[158:159], v7 offset:6496
  buffer_load_dwordx4 v249, s[44:47], s5 offen offset:1024 lds
  v_mfma_f32_16x16x32_bf16 v[56:59], v[112:115], v[160:163], v[56:59]
  ds_read_b64_tr_b16 v[160:161], v7 offset:128
  ds_read_b64_tr_b16 v[162:163], v7 offset:6528
  s_waitcnt vmcnt(22)
  v_mfma_f32_16x16x32_bf16 v[40:43], v[116:119], v[164:167], v[40:43]
  ds_read_b64_tr_b16 v[164:165], v7 offset:25600
  ds_read_b64_tr_b16 v[166:167], v7 offset:32000
  v_mfma_f32_16x16x32_bf16 v[44:47], v[116:119], v[168:171], v[44:47]
  ds_read_b64_tr_b16 v[168:169], v7 offset:25632
  ds_read_b64_tr_b16 v[170:171], v7 offset:32032
  s_mul_i32 s17, s12, 32
  v_min_u32 v232, 31, v1
  s_add_u32 s17, s17, 0
  v_add_u32 v232, s17, v232
  v_mul_u32_u24 v232, 4096, v232
  buffer_load_dword v233, v232, s[48:51], s25 offen
  v_mfma_f32_16x16x32_bf16 v[48:51], v[116:119], v[172:175], v[48:51]
  ds_read_b64_tr_b16 v[172:173], v7 offset:25664
  ds_read_b64_tr_b16 v[174:175], v7 offset:32064
  s_waitcnt lgkmcnt(15)
  v_mfma_f32_16x16x32_bf16 v[52:55], v[116:119], v[176:179], v[52:55]
  ds_read_b64_tr_b16 v[176:177], v7 offset:25696
  ds_read_b64_tr_b16 v[178:179], v7 offset:32096
  v_mfma_f32_16x16x32_bf16 v[56:59], v[116:119], v[180:183], v[56:59]
  ds_read_b64_tr_b16 v[180:181], v7 offset:25728
  ds_read_b64_tr_b16 v[182:183], v7 offset:32128
  s_waitcnt vmcnt(22)
  v_mfma_f32_16x16x32_bf16 v[40:43], v[120:123], v[184:187], v[40:43]
  ds_read_b64_tr_b16 v[184:185], v8 offset:0
  ds_read_b64_tr_b16 v[186:187], v8 offset:6400
  v_mfma_f32_16x16x32_bf16 v[44:47], v[120:123], v[188:191], v[44:47]
  ds_read_b64_tr_b16 v[188:189], v8 offset:32
  ds_read_b64_tr_b16 v[190:191], v8 offset:6432
  v_mfma_f32_16x16x32_bf16 v[48:51], v[120:123], v[192:195], v[48:51]
  ds_read_b64_tr_b16 v[192:193], v8 offset:64
  ds_read_b64_tr_b16 v[194:195], v8 offset:6464
  v_mfma_f32_16x16x32_bf16 v[52:55], v[120:123], v[196:199], v[52:55]
  ds_read_b64_tr_b16 v[196:197], v8 offset:96
  ds_read_b64_tr_b16 v[198:199], v8 offset:6496
  v_mfma_f32_16x16x32_bf16 v[56:59], v[120:123], v[200:203], v[56:59]
  ds_read_b64_tr_b16 v[200:201], v8 offset:128
  ds_read_b64_tr_b16 v[202:203], v8 offset:6528
  s_waitcnt vmcnt(21)
  v_mfma_f32_16x16x32_bf16 v[40:43], v[124:127], v[204:207], v[40:43]
  ds_read_b64_tr_b16 v[204:205], v8 offset:25600
  ds_read_b64_tr_b16 v[206:207], v8 offset:32000
  v_mfma_f32_16x16x32_bf16 v[44:47], v[124:127], v[208:211], v[44:47]
  ds_read_b64_tr_b16 v[208:209], v8 offset:25632
  ds_read_b64_tr_b16 v[210:211], v8 offset:32032
  v_mfma_f32_16x16x32_bf16 v[48:51], v[124:127], v[212:215], v[48:51]
  ds_read_b64_tr_b16 v[212:213], v8 offset:25664
  ds_read_b64_tr_b16 v[214:215], v8 offset:32064
  v_mfma_f32_16x16x32_bf16 v[52:55], v[124:127], v[216:219], v[52:55]
  ds_read_b64_tr_b16 v[216:217], v8 offset:25696
  ds_read_b64_tr_b16 v[218:219], v8 offset:32096
  v_mfma_f32_16x16x32_bf16 v[56:59], v[124:127], v[220:223], v[56:59]
  ds_read_b64_tr_b16 v[220:221], v8 offset:25728
  ds_read_b64_tr_b16 v[222:223], v8 offset:32128
  s_waitcnt vmcnt(19) lgkmcnt(15)
  v_mfma_f32_16x16x32_bf16 v[40:43], v[128:131], v[144:147], v[40:43]
  v_mfma_f32_16x16x32_bf16 v[44:47], v[128:131], v[148:151], v[44:47]
  v_mfma_f32_16x16x32_bf16 v[48:51], v[128:131], v[152:155], v[48:51]
  v_mfma_f32_16x16x32_bf16 v[52:55], v[128:131], v[156:159], v[52:55]
  v_mfma_f32_16x16x32_bf16 v[56:59], v[128:131], v[160:163], v[56:59]
  s_waitcnt vmcnt(17)
  v_mfma_f32_16x16x32_bf16 v[40:43], v[132:135], v[164:167], v[40:43]
  v_mfma_f32_16x16x32_bf16 v[44:47], v[132:135], v[168:171], v[44:47]
  v_mfma_f32_16x16x32_bf16 v[48:51], v[132:135], v[172:175], v[48:51]
  v_mfma_f32_16x16x32_bf16 v[52:55], v[132:135], v[176:179], v[52:55]
  v_mfma_f32_16x16x32_bf16 v[56:59], v[132:135], v[180:183], v[56:59]
  s_waitcnt vmcnt(15)
  v_mfma_f32_16x16x32_bf16 v[40:43], v[136:139], v[184:187], v[40:43]
  v_mfma_f32_16x16x32_bf16 v[44:47], v[136:139], v[188:191], v[44:47]
  s_waitcnt lgkmcnt(14)
  v_mfma_f32_16x16x32_bf16 v[48:51], v[136:139], v[192:195], v[48:51]
  s_waitcnt lgkmcnt(12)
  v_mfma_f32_16x16x32_bf16 v[52:55], v[136:139], v[196:199], v[52:55]
  s_waitcnt lgkmcnt(10)
  v_mfma_f32_16x16x32_bf16 v[56:59], v[136:139], v[200:203], v[56:59]
  s_waitcnt vmcnt(13) lgkmcnt(8)
  v_mfma_f32_16x16x32_bf16 v[40:43], v[140:143], v[204:207], v[40:43]
  s_waitcnt lgkmcnt(6)
  v_mfma_f32_16x16x32_bf16 v[44:47], v[140:143], v[208:211], v[44:47]
  s_waitcnt lgkmcnt(4)
  v_mfma_f32_16x16x32_bf16 v[48:51], v[140:143], v[212:215], v[48:51]
  s_waitcnt lgkmcnt(2)
  v_mfma_f32_16x16x32_bf16 v[52:55], v[140:143], v[216:219], v[52:55]
  s_waitcnt lgkmcnt(0)
  v_mfma_f32_16x16x32_bf16 v[56:59], v[140:143], v[220:223], v[56:59]
  s_nop 1
  v_pk_add_f32 v[16:17], v[40:41], v[44:45]
  v_pk_mul_f32 v[20:21], v[40:41], v[40:41]
  v_pk_add_f32 v[18:19], v[42:43], v[46:47]
  v_pk_mul_f32 v[22:23], v[42:43], v[42:43]
  v_pk_fma_f32 v[20:21], v[44:45], v[44:45], v[20:21]
  v_pk_fma_f32 v[22:23], v[46:47], v[46:47], v[22:23]
  v_pk_add_f32 v[16:17], v[16:17], v[48:49]
  v_pk_fma_f32 v[20:21], v[48:49], v[48:49], v[20:21]
  v_pk_add_f32 v[18:19], v[18:19], v[50:51]
  v_pk_fma_f32 v[22:23], v[50:51], v[50:51], v[22:23]
  v_pk_add_f32 v[16:17], v[16:17], v[52:53]
  v_pk_fma_f32 v[20:21], v[52:53], v[52:53], v[20:21]
  v_pk_add_f32 v[18:19], v[18:19], v[54:55]
  v_pk_fma_f32 v[22:23], v[54:55], v[54:55], v[22:23]
  v_pk_add_f32 v[16:17], v[16:17], v[56:57]
  v_pk_fma_f32 v[20:21], v[56:57], v[56:57], v[20:21]
  v_pk_add_f32 v[18:19], v[18:19], v[58:59]
  v_pk_fma_f32 v[22:23], v[58:59], v[58:59], v[22:23]
  v_add_f32_dpp v24, v16, v16 row_ror:8 row_mask:0xf bank_mask:0x3
  v_add_f32_dpp v26, v20, v20 row_ror:8 row_mask:0xf bank_mask:0x3
  v_add_f32_dpp v25, v17, v17 row_ror:8 row_mask:0xf bank_mask:0x3
  v_add_f32_dpp v27, v21, v21 row_ror:8 row_mask:0xf bank_mask:0x3
  v_add_f32_dpp v24, v18, v18 row_ror:8 row_mask:0xf bank_mask:0xc
  v_add_f32_dpp v26, v22, v22 row_ror:8 row_mask:0xf bank_mask:0xc
  v_add_f32_dpp v25, v19, v19 row_ror:8 row_mask:0xf bank_mask:0xc
  v_add_f32_dpp v27, v23, v23 row_ror:8 row_mask:0xf bank_mask:0xc
  v_add_f32_dpp v28, v24, v24 row_half_mirror row_mask:0xf bank_mask:0x5
  v_add_f32_dpp v29, v26, v26 row_half_mirror row_mask:0xf bank_mask:0x5
  s_nop 0
  v_add_f32_dpp v28, v25, v25 row_half_mirror row_mask:0xf bank_mask:0xa
  v_add_f32_dpp v29, v27, v27 row_half_mirror row_mask:0xf bank_mask:0xa
  v_mov_b32 v30, s59
  v_mov_b32 v31, s59
  v_add_f32_dpp v28, v28, v28 quad_perm:[1,0,3,2] row_mask:0xf bank_mask:0xf
  v_add_f32_dpp v29, v29, v29 quad_perm:[1,0,3,2] row_mask:0xf bank_mask:0xf
  s_nop 0
  v_add_f32_dpp v28, v28, v28 quad_perm:[2,3,0,1] row_mask:0xf bank_mask:0xf
  v_add_f32_dpp v29, v29, v29 quad_perm:[2,3,0,1] row_mask:0xf bank_mask:0xf
  s_lshl2_add_u32 s70, s11, s58
  s_lshl_b32 s70, s70, 8
  s_add_u32 s72, s70, 167936
  s_and_b32 s70, s70, 0xffffe3ff
  s_add_u32 s73, s70, 167936
  s_mov_b32 exec_lo, 0x11111111
  s_mov_b32 exec_hi, 0x11111111
  s_add_u32 s74, s72, 552960
  buffer_store_dwordx4 v[28:31], v14, s[28:31], s74 offen
  s_mov_b32 s74, s73
  s_add_u32 s73, s73, 552960
  s_mov_b32 s75, 6
  buffer_store_dwordx4 v[28:31], v14, s[28:31], s72 offen sc1
  s_mov_b64 exec, -1
  v_bfe_u32 v32, v1, 4, 1
  v_mul_u32_u24 v32, 65528, v32
  v_add_u32 v32, v32, v10
  v_cvt_pk_bf16_f32 v64, v40, v41
  v_cvt_pk_bf16_f32 v65, v42, v43
  ds_write_b64 v11, v[64:65] offset:0
  v_cvt_pk_bf16_f32 v66, v44, v45
  v_cvt_pk_bf16_f32 v67, v46, v47
  ds_write_b64 v11, v[66:67] offset:512
  v_cvt_pk_bf16_f32 v68, v48, v49
  v_cvt_pk_bf16_f32 v69, v50, v51
  ds_write_b64 v11, v[68:69] offset:1024
  v_cvt_pk_bf16_f32 v70, v52, v53
  v_cvt_pk_bf16_f32 v71, v54, v55
  ds_write_b64 v11, v[70:71] offset:1536
  v_cvt_pk_bf16_f32 v72, v56, v57
  v_cvt_pk_bf16_f32 v73, v58, v59
  ds_write_b64 v11, v[72:73] offset:2048
  s_waitcnt lgkmcnt(0)
  ds_read_b64_tr_b16 v[234:235], v12 offset:0
  ds_read_b64_tr_b16 v[236:237], v12 offset:512
  ds_read_b64_tr_b16 v[238:239], v12 offset:1024
  ds_read_b64_tr_b16 v[240:241], v12 offset:1536
  ds_read_b64_tr_b16 v[242:243], v12 offset:2048
  s_waitcnt lgkmcnt(0)
  s_barrier
  buffer_load_dwordx4 v[16:19], v15, s[28:31], s73 offen sc1
  buffer_load_dwordx4 v[20:23], v15, s[28:31], s73 offen offset:1024 sc1
  s_mul_i32 s3, s58, 28672
  s_mul_i32 s4, s12, 1024
  s_add_u32 s3, s3, 0
  s_and_b32 s4, s4, 0xfffff800
  v_add_u32 v248, 1327104, v244
  v_add_u32 v249, 1327104, v245
  s_add_u32 m0, s4, s3
  s_mul_i32 s5, s4, 27
  buffer_load_dwordx4 v248, s[44:47], s5 offen lds
  buffer_load_dwordx4 v249, s[44:47], s5 offen offset:1024 lds
  s_addk_i32 s4, 2048
  s_bitset0_b32 s4, 13
  s_add_u32 m0, s4, s3
  s_mul_i32 s5, s4, 27
  buffer_load_dwordx4 v248, s[44:47], s5 offen lds
  buffer_load_dwordx4 v249, s[44:47], s5 offen offset:1024 lds
  s_addk_i32 s4, 2048
  s_bitset0_b32 s4, 13
  s_add_u32 m0, s4, s3
  s_mul_i32 s5, s4, 27
  buffer_load_dwordx4 v248, s[44:47], s5 offen lds
  buffer_load_dwordx4 v249, s[44:47], s5 offen offset:1024 lds
  s_addk_i32 s4, 2048
  s_bitset0_b32 s4, 13
  s_add_u32 m0, s4, s3
  s_mul_i32 s5, s4, 27
  buffer_load_dwordx4 v248, s[44:47], s5 offen lds
  buffer_load_dwordx4 v249, s[44:47], s5 offen offset:1024 lds
  s_waitcnt vmcnt(9)
  v_cmp_ne_u32 vcc, s59, v18
  s_waitcnt vmcnt(8)
  v_cmp_ne_u32 s[70:71], s59, v22
  s_nop 0
  s_or_b64 vcc, vcc, s[70:71]
  s_cbranch_vccz Ld12
Lp11:
  s_sub_u32 s75, s75, 1
  s_cselect_b32 s73, s74, s73
  buffer_load_dwordx4 v[16:19], v15, s[28:31], s73 offen sc1
  buffer_load_dwordx4 v[20:23], v15, s[28:31], s73 offen offset:1024 sc1
  s_waitcnt vmcnt(0) lgkmcnt(0)
  v_cmp_ne_u32 vcc, s59, v18
  v_cmp_ne_u32 s[70:71], s59, v22
  s_nop 0
  s_or_b64 vcc, vcc, s[70:71]
  s_cbranch_vccz Ld12
  s_sub_u32 s61, s61, 1
  s_cbranch_scc0 Lp11
  s_branch Lexit
Ld12:
  v_pk_add_f32 v[16:17], v[16:17], v[20:21]
  s_nop 1
  v_add_f32_dpp v16, v16, v16 quad_perm:[1,0,3,2] row_mask:0xf bank_mask:0xf
  v_add_f32_dpp v17, v17, v17 quad_perm:[1,0,3,2] row_mask:0xf bank_mask:0xf
  s_nop 0
  v_add_f32_dpp v16, v16, v16 quad_perm:[2,3,0,1] row_mask:0xf bank_mask:0xf
  v_add_f32_dpp v17, v17, v17 quad_perm:[2,3,0,1] row_mask:0xf bank_mask:0xf
  v_mul_f32 v16, 0xbacccccd, v16
  v_mul_f32 v17, 0x3acccccd, v17
  v_fma_f32 v17, -v16, v16, v17
  v_max_f32 v17, 0, v17
  v_add_f32 v18, 0x3727c5ac, v17
  v_rsq_f32 v18, v18
  v_mov_b32 v20, 0x3727c5ac
  v_mul_f32 v19, v18, v17
  v_fma_f32 v19, v19, v18, v20
  v_rsq_f32 v19, v19
  s_mul_i32 s70, s9, 327680
  v_mul_f32 v18, v18, v19
  v_mul_f32 v16, v16, v18
  s_add_u32 s70, s70, 12582912
  v_mov_b32_dpp v20, v18 row_newbcast:0 row_mask:0xf bank_mask:0xf
  v_mov_b32_dpp v24, v16 row_newbcast:0 row_mask:0xf bank_mask:0xf
  v_mov_b32_dpp v21, v18 row_newbcast:4 row_mask:0xf bank_mask:0xf
  v_mov_b32_dpp v25, v16 row_newbcast:4 row_mask:0xf bank_mask:0xf
  v_mov_b32_dpp v22, v18 row_newbcast:8 row_mask:0xf bank_mask:0xf
  v_mov_b32_dpp v26, v16 row_newbcast:8 row_mask:0xf bank_mask:0xf
  v_mov_b32_dpp v23, v18 row_newbcast:12 row_mask:0xf bank_mask:0xf
  v_mov_b32_dpp v27, v16 row_newbcast:12 row_mask:0xf bank_mask:0xf
  v_pk_fma_f32 v[40:41], v[40:41], v[20:21], v[24:25]
  v_pk_fma_f32 v[42:43], v[42:43], v[22:23], v[26:27]
  v_cvt_pk_bf16_f32 v40, v40, v41
  v_cvt_pk_bf16_f32 v41, v42, v43
  v_pk_fma_f32 v[44:45], v[44:45], v[20:21], v[24:25]
  v_pk_fma_f32 v[46:47], v[46:47], v[22:23], v[26:27]
  v_cvt_pk_bf16_f32 v42, v44, v45
  v_cvt_pk_bf16_f32 v43, v46, v47
  s_nop 0
  v_permlane16_swap_b32 v40, v42
  v_permlane16_swap_b32 v41, v43
  buffer_store_dwordx4 v[40:43], v32, s[28:31], s70 offen sc1
  s_add_u32 s70, s70, 131072
  v_pk_fma_f32 v[48:49], v[48:49], v[20:21], v[24:25]
  v_pk_fma_f32 v[50:51], v[50:51], v[22:23], v[26:27]
  v_cvt_pk_bf16_f32 v48, v48, v49
  v_cvt_pk_bf16_f32 v49, v50, v51
  v_pk_fma_f32 v[52:53], v[52:53], v[20:21], v[24:25]
  v_pk_fma_f32 v[54:55], v[54:55], v[22:23], v[26:27]
  v_cvt_pk_bf16_f32 v50, v52, v53
  v_cvt_pk_bf16_f32 v51, v54, v55
  s_nop 0
  v_permlane16_swap_b32 v48, v50
  v_permlane16_swap_b32 v49, v51
  buffer_store_dwordx4 v[48:51], v32, s[28:31], s70 offen sc1
  s_add_u32 s70, s70, 131072
  v_pk_fma_f32 v[56:57], v[56:57], v[20:21], v[24:25]
  v_pk_fma_f32 v[58:59], v[58:59], v[22:23], v[26:27]
  v_cvt_pk_bf16_f32 v56, v56, v57
  v_cvt_pk_bf16_f32 v57, v58, v59
  buffer_store_dwordx2 v[56:57], v10, s[28:31], s70 offen sc1
  s_lshl_b32 s70, s11, 7
  s_add_u32 s70, s70, 69632
  v_mov_b32 v16, s59
  s_mul_i32 s17, s58, 12288
  s_add_u32 s17, s17, 114688
  v_add_u32 v252, s17, v250
  v_xor_b32 v253, 32, v252
  v_xor_b32 v254, 64, v252
  v_xor_b32 v255, 96, v252
  ds_read_b64_tr_b16 a[144:145], v252 offset:0
  ds_read_b64_tr_b16 a[146:147], v252 offset:512
  ds_read_b64_tr_b16 a[148:149], v253 offset:0
  ds_read_b64_tr_b16 a[150:151], v253 offset:512
  ds_read_b64_tr_b16 a[152:153], v254 offset:0
  ds_read_b64_tr_b16 a[154:155], v254 offset:512
  ds_read_b64_tr_b16 a[156:157], v255 offset:0
  ds_read_b64_tr_b16 a[158:159], v255 offset:512
  ds_read_b64_tr_b16 a[160:161], v252 offset:4096
  ds_read_b64_tr_b16 a[162:163], v252 offset:4608
  ds_read_b64_tr_b16 a[164:165], v253 offset:4096
  ds_read_b64_tr_b16 a[166:167], v253 offset:4608
  ds_read_b64_tr_b16 a[168:169], v254 offset:4096
  ds_read_b64_tr_b16 a[170:171], v254 offset:4608
  ds_read_b64_tr_b16 a[172:173], v255 offset:4096
  ds_read_b64_tr_b16 a[174:175], v255 offset:4608
  ds_read_b64_tr_b16 a[176:177], v252 offset:8192
  ds_read_b64_tr_b16 a[178:179], v252 offset:8704
  ds_read_b64_tr_b16 a[180:181], v253 offset:8192
  ds_read_b64_tr_b16 a[182:183], v253 offset:8704
  ds_read_b64_tr_b16 a[184:185], v254 offset:8192
  ds_read_b64_tr_b16 a[186:187], v254 offset:8704
  ds_read_b64_tr_b16 a[188:189], v255 offset:8192
  ds_read_b64_tr_b16 a[190:191], v255 offset:8704
  s_waitcnt vmcnt(3)
  s_mul_i32 s17, s58, 28672
  s_add_u32 s17, s17, 0
  v_add_u32 v252, s17, v250
  v_xor_b32 v253, 32, v252
  v_xor_b32 v254, 64, v252
  v_xor_b32 v255, 96, v252
  ds_read_b64_tr_b16 a[192:193], v252 offset:0
  ds_read_b64_tr_b16 a[194:195], v252 offset:512
  ds_read_b64_tr_b16 a[196:197], v253 offset:0
  ds_read_b64_tr_b16 a[198:199], v253 offset:512
  ds_read_b64_tr_b16 a[200:201], v254 offset:0
  ds_read_b64_tr_b16 a[202:203], v254 offset:512
  ds_read_b64_tr_b16 a[204:205], v255 offset:0
  ds_read_b64_tr_b16 a[206:207], v255 offset:512
  ds_read_b64_tr_b16 a[208:209], v252 offset:4096
  ds_read_b64_tr_b16 a[210:211], v252 offset:4608
  ds_read_b64_tr_b16 a[212:213], v253 offset:4096
  ds_read_b64_tr_b16 a[214:215], v253 offset:4608
  ds_read_b64_tr_b16 a[216:217], v254 offset:4096
  ds_read_b64_tr_b16 a[218:219], v254 offset:4608
  ds_read_b64_tr_b16 a[220:221], v255 offset:4096
  ds_read_b64_tr_b16 a[222:223], v255 offset:4608
  s_waitcnt vmcnt(0) lgkmcnt(0)
  s_cmp_lg_u32 s58, 0
  s_barrier
  s_cbranch_scc1 Lfl13
  s_mov_b64 exec, 1
  buffer_store_dword v16, off, s[28:31], s70 sc1
  s_mov_b64 exec, -1
Lfl13:
  s_mul_i32 s3, s58, 8192
  s_mul_i32 s4, s12, 1024
  s_add_u32 s3, s3, 131072
  s_and_b32 s4, s4, 0xfffff800
  v_add_u32 v248, 1548288, v244
  v_add_u32 v249, 1548288, v245
  s_add_u32 m0, s4, s3
  s_mul_i32 s5, s4, 27
  buffer_load_dwordx4 v248, s[44:47], s5 offen lds
  buffer_load_dwordx4 v249, s[44:47], s5 offen offset:1024 lds
  s_addk_i32 s4, 2048
  s_bitset0_b32 s4, 13
  s_add_u32 m0, s4, s3
  s_mul_i32 s5, s4, 27
  buffer_load_dwordx4 v248, s[44:47], s5 offen lds
  buffer_load_dwordx4 v249, s[44:47], s5 offen offset:1024 lds
  s_addk_i32 s4, 2048
  s_bitset0_b32 s4, 13
  s_add_u32 m0, s4, s3
  s_mul_i32 s5, s4, 27
  buffer_load_dwordx4 v248, s[44:47], s5 offen lds
  buffer_load_dwordx4 v249, s[44:47], s5 offen offset:1024 lds
  s_addk_i32 s4, 2048
  s_bitset0_b32 s4, 13
  s_add_u32 m0, s4, s3
  s_mul_i32 s5, s4, 27
  buffer_load_dwordx4 v248, s[44:47], s5 offen lds
  buffer_load_dwordx4 v249, s[44:47], s5 offen offset:1024 lds
  s_mul_i32 s3, s58, 32768
  s_mul_i32 s4, s12, 4096
  s_add_u32 s3, s3, 0
  s_and_b32 s4, s4, 0xfffff800
  v_add_u32 v248, 0, v246
  v_add_u32 v249, 0, v247
  s_add_u32 m0, s4, s3
  s_mul_i32 s5, s4, 32
  buffer_load_dwordx4 v248, s[48:51], s5 offen lds
  buffer_load_dwordx4 v249, s[48:51], s5 offen offset:1024 lds
  s_addk_i32 s4, 2048
  s_bitset0_b32 s4, 15
  s_add_u32 m0, s4, s3
  s_mul_i32 s5, s4, 32
  buffer_load_dwordx4 v248, s[48:51], s5 offen lds
  buffer_load_dwordx4 v249, s[48:51], s5 offen offset:1024 lds
  s_addk_i32 s4, 2048
  s_bitset0_b32 s4, 15
  s_add_u32 m0, s4, s3
  s_mul_i32 s5, s4, 32
  buffer_load_dwordx4 v248, s[48:51], s5 offen lds
  buffer_load_dwordx4 v249, s[48:51], s5 offen offset:1024 lds
  s_addk_i32 s4, 2048
  s_bitset0_b32 s4, 15
  s_add_u32 m0, s4, s3
  s_mul_i32 s5, s4, 32
  buffer_load_dwordx4 v248, s[48:51], s5 offen lds
  buffer_load_dwordx4 v249, s[48:51], s5 offen offset:1024 lds
  s_addk_i32 s4, 2048
  s_bitset0_b32 s4, 15
  s_add_u32 m0, s4, s3
  s_mul_i32 s5, s4, 32
  buffer_load_dwordx4 v248, s[48:51], s5 offen lds
  buffer_load_dwordx4 v249, s[48:51], s5 offen offset:1024 lds
  s_addk_i32 s4, 2048
  s_bitset0_b32 s4, 15
  s_add_u32 m0, s4, s3
  s_mul_i32 s5, s4, 32
  buffer_load_dwordx4 v248, s[48:51], s5 offen lds
  buffer_load_dwordx4 v249, s[48:51], s5 offen offset:1024 lds
  s_addk_i32 s4, 2048
  s_bitset0_b32 s4, 15
  s_add_u32 m0, s4, s3
  s_mul_i32 s5, s4, 32
  buffer_load_dwordx4 v248, s[48:51], s5 offen lds
  buffer_load_dwordx4 v249, s[48:51], s5 offen offset:1024 lds
  s_addk_i32 s4, 2048
  s_bitset0_b32 s4, 15
  s_add_u32 m0, s4, s3
  s_mul_i32 s5, s4, 32
  buffer_load_dwordx4 v248, s[48:51], s5 offen lds
  buffer_load_dwordx4 v249, s[48:51], s5 offen offset:1024 lds
  s_addk_i32 s4, 2048
  s_bitset0_b32 s4, 15
  s_add_u32 m0, s4, s3
  s_mul_i32 s5, s4, 32
  buffer_load_dwordx4 v248, s[48:51], s5 offen lds
  buffer_load_dwordx4 v249, s[48:51], s5 offen offset:1024 lds
  s_addk_i32 s4, 2048
  s_bitset0_b32 s4, 15
  s_add_u32 m0, s4, s3
  s_mul_i32 s5, s4, 32
  buffer_load_dwordx4 v248, s[48:51], s5 offen lds
  buffer_load_dwordx4 v249, s[48:51], s5 offen offset:1024 lds
  s_addk_i32 s4, 2048
  s_bitset0_b32 s4, 15
  s_add_u32 m0, s4, s3
  s_mul_i32 s5, s4, 32
  buffer_load_dwordx4 v248, s[48:51], s5 offen lds
  buffer_load_dwordx4 v249, s[48:51], s5 offen offset:1024 lds
  s_addk_i32 s4, 2048
  s_bitset0_b32 s4, 15
  s_lshl_b32 s70, s58, 10
  s_add_u32 s70, s70, 131072
  v_lshl_add_u32 v2, v1, 4, s70
  v_xor_b32 v3, 0x400, v2
  v_xor_b32 v4, 0x800, v2
  v_xor_b32 v5, 0xc00, v2
  s_cmp_ge_u32 s76, 27
  s_cbranch_scc1 Lp4skip
  s_mov_b32 s72, s9
  s_lshl_b32 s70, s58, 6
  s_add_u32 s70, s70, s72
  v_and_b32 v16, 7, v1
  v_lshl_add_u32 v16, v16, 3, s70
  v_lshlrev_b32 v6, 7, v16
  s_mov_b32 s73, 69632
  s_lshl2_add_u32 s70, s76, s58
  s_lshl_b32 s71, s70, 9
  v_add_u32 v10, s71, v13
  s_lshl_b32 s70, s70, 5
  v_lshrrev_b32 v16, 4, v1
  v_lshl_add_u32 v16, v16, 3, s70
  global_load_dwordx2 v[28:29], v16, s[14:15]
  s_mov_b64 exec, 0xff
  buffer_load_dword v20, v6, s[28:31], s73 offen sc1
  s_mov_b64 exec, -1
  s_add_u32 m0, s4, s3
  s_mul_i32 s5, s4, 32
  buffer_load_dwordx4 v248, s[48:51], s5 offen lds
  buffer_load_dwordx4 v249, s[48:51], s5 offen offset:1024 lds
  s_addk_i32 s4, 2048
  s_bitset0_b32 s4, 15
  s_add_u32 m0, s4, s3
  s_mul_i32 s5, s4, 32
  buffer_load_dwordx4 v248, s[48:51], s5 offen lds
  buffer_load_dwordx4 v249, s[48:51], s5 offen offset:1024 lds
  s_addk_i32 s4, 2048
  s_bitset0_b32 s4, 15
  s_add_u32 m0, s4, s3
  s_mul_i32 s5, s4, 32
  buffer_load_dwordx4 v248, s[48:51], s5 offen lds
  buffer_load_dwordx4 v249, s[48:51], s5 offen offset:1024 lds
  s_addk_i32 s4, 2048
  s_bitset0_b32 s4, 15
  s_add_u32 m0, s4, s3
  s_mul_i32 s5, s4, 32
  buffer_load_dwordx4 v248, s[48:51], s5 offen lds
  buffer_load_dwordx4 v249, s[48:51], s5 offen offset:1024 lds
  s_addk_i32 s4, 2048
  s_bitset0_b32 s4, 15
  s_add_u32 m0, s4, s3
  s_mul_i32 s5, s4, 32
  buffer_load_dwordx4 v248, s[48:51], s5 offen lds
  buffer_load_dwordx4 v249, s[48:51], s5 offen offset:1024 lds
  s_mul_i32 s70, s72, 327680
  s_lshl_b32 s71, s58, 14
  s_add_u32 s70, s70, s71
  v_lshl_add_u32 v7, v1, 4, s70
  s_waitcnt vmcnt(11)
  v_lshlrev_b32 v24, 16, v28
  v_and_b32 v25, 0xffff0000, v28
  v_lshlrev_b32 v26, 16, v29
  v_and_b32 v27, 0xffff0000, v29
  s_mov_b32 s62, 0xbdd2d3e8
  v_mov_b32 v30, 0xc0135761
  s_mul_i32 s70, s72, 276480
  v_add_u32 v10, s70, v10
  v_bfe_u32 v11, v1, 4, 1
  v_mul_u32_u24 v11, 55288, v11
  v_add_u32 v11, v11, v10
  v_add_u32 v192, 0, v7
  v_add_u32 v193, 4096, v7
  v_add_u32 v194, 8192, v7
  v_add_u32 v195, 12288, v7
  s_mov_b32 s63, 12582912
  s_mov_b32 s20, 15204352
  s_mov_b32 s64, 12648448
  s_mov_b32 s21, 15259648
  s_mov_b32 s65, 12713984
  s_mov_b32 s22, 15314944
  s_mov_b32 s66, 12779520
  s_mov_b32 s23, 15370240
  s_mov_b32 s67, 12845056
  s_mov_b32 s24, 15425536
  s_mov_b64 exec, 0xff
  s_waitcnt vmcnt(10)
  v_cmp_ne_u32 vcc, s59, v20
  s_cbranch_vccz Ld15
Lp14:
  buffer_load_dword v20, v6, s[28:31], s73 offen sc1
  s_waitcnt vmcnt(0) lgkmcnt(0)
  v_cmp_ne_u32 vcc, s59, v20
  s_cbranch_vccz Ld15
  s_sub_u32 s61, s61, 1
  s_cbranch_scc0 Lp14
  s_branch Lexit
Ld15:
  s_mov_b64 exec, -1
  buffer_load_dwordx4 v[64:67], v192, s[28:31], s63 offen offset:0
  buffer_load_dwordx4 v[68:71], v192, s[28:31], s63 offen offset:1024
  buffer_load_dwordx4 v[72:75], v192, s[28:31], s63 offen offset:2048
  buffer_load_dwordx4 v[76:79], v192, s[28:31], s63 offen offset:3072
  buffer_load_dwordx4 v[80:83], v193, s[28:31], s63 offen offset:0
  buffer_load_dwordx4 v[84:87], v193, s[28:31], s63 offen offset:1024
  buffer_load_dwordx4 v[88:91], v193, s[28:31], s63 offen offset:2048
  buffer_load_dwordx4 v[92:95], v193, s[28:31], s63 offen offset:3072
  buffer_load_dwordx4 v[96:99], v194, s[28:31], s63 offen offset:0
  buffer_load_dwordx4 v[100:103], v194, s[28:31], s63 offen offset:1024
  s_mul_i32 s17, s58, 8192
  s_add_u32 s17, s17, 131072
  v_add_u32 v252, s17, v250
  v_xor_b32 v253, 32, v252
  v_xor_b32 v254, 64, v252
  v_xor_b32 v255, 96, v252
  ds_read_b64_tr_b16 a[224:225], v252 offset:0
  ds_read_b64_tr_b16 a[226:227], v252 offset:512
  ds_read_b64_tr_b16 a[228:229], v253 offset:0
  ds_read_b64_tr_b16 a[230:231], v253 offset:512
  ds_read_b64_tr_b16 a[232:233], v254 offset:0
  ds_read_b64_tr_b16 a[234:235], v254 offset:512
  ds_read_b64_tr_b16 a[236:237], v255 offset:0
  ds_read_b64_tr_b16 a[238:239], v255 offset:512
  ds_read_b64_tr_b16 a[240:241], v252 offset:4096
  ds_read_b64_tr_b16 a[242:243], v252 offset:4608
  ds_read_b64_tr_b16 a[244:245], v253 offset:4096
  ds_read_b64_tr_b16 a[246:247], v253 offset:4608
  ds_read_b64_tr_b16 a[248:249], v254 offset:4096
  ds_read_b64_tr_b16 a[250:251], v254 offset:4608
  ds_read_b64_tr_b16 a[252:253], v255 offset:4096
  ds_read_b64_tr_b16 a[254:255], v255 offset:4608
  s_waitcnt lgkmcnt(0)
  s_barrier
  s_waitcnt vmcnt(9)
  v_mfma_f32_16x16x32_bf16 v[128:131], a[0:3], v[64:67], v[24:27]
  buffer_load_dwordx4 v[104:107], v194, s[28:31], s63 offen offset:2048
  v_mfma_f32_16x16x32_bf16 v[132:135], a[4:7], v[64:67], 0
  v_mfma_f32_16x16x32_bf16 v[136:139], a[8:11], v[64:67], 0
  buffer_load_dwordx4 v[108:111], v194, s[28:31], s63 offen offset:3072
  v_mfma_f32_16x16x32_bf16 v[140:143], a[12:15], v[64:67], 0
  s_waitcnt vmcnt(10)
  v_mfma_f32_16x16x32_bf16 v[128:131], a[16:19], v[68:71], v[128:131]
  buffer_load_dwordx4 v[112:115], v195, s[28:31], s63 offen offset:0
  v_mfma_f32_16x16x32_bf16 v[132:135], a[20:23], v[68:71], v[132:135]
  v_mfma_f32_16x16x32_bf16 v[136:139], a[24:27], v[68:71], v[136:139]
  buffer_load_dwordx4 v[116:119], v195, s[28:31], s63 offen offset:1024
  v_mfma_f32_16x16x32_bf16 v[140:143], a[28:31], v[68:71], v[140:143]
  s_waitcnt vmcnt(11)
  v_mfma_f32_16x16x32_bf16 v[128:131], a[32:35], v[72:75], v[128:131]
  buffer_load_dwordx4 v[120:123], v195, s[28:31], s63 offen offset:2048
  v_mfma_f32_16x16x32_bf16 v[132:135], a[36:39], v[72:75], v[132:135]
  v_mfma_f32_16x16x32_bf16 v[136:139], a[40:43], v[72:75], v[136:139]
  buffer_load_dwordx4 v[124:127], v195, s[28:31], s63 offen offset:3072
  v_mfma_f32_16x16x32_bf16 v[140:143], a[44:47], v[72:75], v[140:143]
  s_waitcnt vmcnt(12)
  v_mfma_f32_16x16x32_bf16 v[128:131], a[48:51], v[76:79], v[128:131]
  buffer_load_dwordx4 v[64:67], v192, s[28:31], s64 offen offset:0
  v_mfma_f32_16x16x32_bf16 v[132:135], a[52:55], v[76:79], v[132:135]
  v_mfma_f32_16x16x32_bf16 v[136:139], a[56:59], v[76:79], v[136:139]
  buffer_load_dwordx4 v[68:71], v192, s[28:31], s64 offen offset:1024
  v_mfma_f32_16x16x32_bf16 v[140:143], a[60:63], v[76:79], v[140:143]
  s_waitcnt vmcnt(13)
  v_mfma_f32_16x16x32_bf16 v[128:131], a[64:67], v[80:83], v[128:131]
  buffer_load_dwordx4 v[72:75], v192, s[28:31], s64 offen offset:2048
  v_mfma_f32_16x16x32_bf16 v[132:135], a[68:71], v[80:83], v[132:135]
  v_mfma_f32_16x16x32_bf16 v[136:139], a[72:75], v[80:83], v[136:139]
  buffer_load_dwordx4 v[76:79], v192, s[28:31], s64 offen offset:3072
  v_mfma_f32_16x16x32_bf16 v[140:143], a[76:79], v[80:83], v[140:143]
  s_waitcnt vmcnt(14)
  v_mfma_f32_16x16x32_bf16 v[128:131], a[80:83], v[84:87], v[128:131]
  buffer_load_dwordx4 v[80:83], v193, s[28:31], s64 offen offset:0
  v_mfma_f32_16x16x32_bf16 v[132:135], a[84:87], v[84:87], v[132:135]
  v_mfma_f32_16x16x32_bf16 v[136:139], a[88:91], v[84:87], v[136:139]
  v_mfma_f32_16x16x32_bf16 v[140:143], a[92:95], v[84:87], v[140:143]
  s_waitcnt vmcnt(14)
  v_mfma_f32_16x16x32_bf16 v[128:131], a[96:99], v[88:91], v[128:131]
  buffer_load_dwordx4 v[84:87], v193, s[28:31], s64 offen offset:1024
  v_mfma_f32_16x16x32_bf16 v[132:135], a[100:103], v[88:91], v[132:135]
  v_mfma_f32_16x16x32_bf16 v[136:139], a[104:107], v[88:91], v[136:139]
  v_mfma_f32_16x16x32_bf16 v[140:143], a[108:111], v[88:91], v[140:143]
  s_waitcnt vmcnt(14)
  v_mfma_f32_16x16x32_bf16 v[128:131], a[112:115], v[92:95], v[128:131]
  buffer_load_dwordx4 v[88:91], v193, s[28:31], s64 offen offset:2048
  v_mfma_f32_16x16x32_bf16 v[132:135], a[116:119], v[92:95], v[132:135]
  v_mfma_f32_16x16x32_bf16 v[136:139], a[120:123], v[92:95], v[136:139]
  v_mfma_f32_16x16x32_bf16 v[140:143], a[124:127], v[92:95], v[140:143]
  s_waitcnt vmcnt(14)
  v_mfma_f32_16x16x32_bf16 v[128:131], a[128:131], v[96:99], v[128:131]
  buffer_load_dwordx4 v[92:95], v193, s[28:31], s64 offen offset:3072
  v_mfma_f32_16x16x32_bf16 v[132:135], a[132:135], v[96:99], v[132:135]
  v_mfma_f32_16x16x32_bf16 v[136:139], a[136:139], v[96:99], v[136:139]
  v_mfma_f32_16x16x32_bf16 v[140:143], a[140:143], v[96:99], v[140:143]
  s_waitcnt vmcnt(14)
  v_mfma_f32_16x16x32_bf16 v[128:131], a[144:147], v[100:103], v[128:131]
  buffer_load_dwordx4 v[96:99], v194, s[28:31], s64 offen offset:0
  v_mfma_f32_16x16x32_bf16 v[132:135], a[148:151], v[100:103], v[132:135]
  v_mfma_f32_16x16x32_bf16 v[136:139], a[152:155], v[100:103], v[136:139]
  v_mfma_f32_16x16x32_bf16 v[140:143], a[156:159], v[100:103], v[140:143]
  s_waitcnt vmcnt(14)
  v_mfma_f32_16x16x32_bf16 v[128:131], a[160:163], v[104:107], v[128:131]
  buffer_load_dwordx4 v[100:103], v194, s[28:31], s64 offen offset:1024
  v_mfma_f32_16x16x32_bf16 v[132:135], a[164:167], v[104:107], v[132:135]
  v_mfma_f32_16x16x32_bf16 v[136:139], a[168:171], v[104:107], v[136:139]
  v_mfma_f32_16x16x32_bf16 v[140:143], a[172:175], v[104:107], v[140:143]
  s_waitcnt vmcnt(14)
  v_mfma_f32_16x16x32_bf16 v[128:131], a[176:179], v[108:111], v[128:131]
  buffer_load_dwordx4 v[104:107], v194, s[28:31], s64 offen offset:2048
  v_mfma_f32_16x16x32_bf16 v[132:135], a[180:183], v[108:111], v[132:135]
  v_mfma_f32_16x16x32_bf16 v[136:139], a[184:187], v[108:111], v[136:139]
  v_mfma_f32_16x16x32_bf16 v[140:143], a[188:191], v[108:111], v[140:143]
  s_waitcnt vmcnt(14)
  v_mfma_f32_16x16x32_bf16 v[128:131], a[192:195], v[112:115], v[128:131]
  buffer_load_dwordx4 v[108:111], v194, s[28:31], s64 offen offset:3072
  v_mfma_f32_16x16x32_bf16 v[132:135], a[196:199], v[112:115], v[132:135]
  v_mfma_f32_16x16x32_bf16 v[136:139], a[200:203], v[112:115], v[136:139]
  v_mfma_f32_16x16x32_bf16 v[140:143], a[204:207], v[112:115], v[140:143]
  s_waitcnt vmcnt(14)
  v_mfma_f32_16x16x32_bf16 v[128:131], a[208:211], v[116:119], v[128:131]
  buffer_load_dwordx4 v[112:115], v195, s[28:31], s64 offen offset:0
  v_mfma_f32_16x16x32_bf16 v[132:135], a[212:215], v[116:119], v[132:135]
  v_mfma_f32_16x16x32_bf16 v[136:139], a[216:219], v[116:119], v[136:139]
  v_mfma_f32_16x16x32_bf16 v[140:143], a[220:223], v[116:119], v[140:143]
  s_waitcnt vmcnt(14)
  v_mfma_f32_16x16x32_bf16 v[128:131], a[224:227], v[120:123], v[128:131]
  buffer_load_dwordx4 v[116:119], v195, s[28:31], s64 offen offset:1024
  v_mfma_f32_16x16x32_bf16 v[132:135], a[228:231], v[120:123], v[132:135]
  v_mfma_f32_16x16x32_bf16 v[136:139], a[232:235], v[120:123], v[136:139]
  v_mfma_f32_16x16x32_bf16 v[140:143], a[236:239], v[120:123], v[140:143]
  s_waitcnt vmcnt(14)
  v_mfma_f32_16x16x32_bf16 v[128:131], a[240:243], v[124:127], v[128:131]
  buffer_load_dwordx4 v[120:123], v195, s[28:31], s64 offen offset:2048
  v_mfma_f32_16x16x32_bf16 v[132:135], a[244:247], v[124:127], v[132:135]
  v_mfma_f32_16x16x32_bf16 v[136:139], a[248:251], v[124:127], v[136:139]
  v_mfma_f32_16x16x32_bf16 v[140:143], a[252:255], v[124:127], v[140:143]
  s_waitcnt vmcnt(14)
  v_mfma_f32_16x16x32_bf16 v[144:147], a[0:3], v[64:67], v[24:27]
  buffer_load_dwordx4 v[124:127], v195, s[28:31], s64 offen offset:3072
  v_mfma_f32_16x16x32_bf16 v[148:151], a[4:7], v[64:67], 0
  s_nop 1
  ds_write_b128 v2, v[132:135] offset:0
  v_mfma_f32_16x16x32_bf16 v[152:155], a[8:11], v[64:67], 0
  v_mfma_f32_16x16x32_bf16 v[156:159], a[12:15], v[64:67], 0
  s_waitcnt vmcnt(14)
  v_mfma_f32_16x16x32_bf16 v[144:147], a[16:19], v[68:71], v[144:147]
  buffer_load_dwordx4 v[64:67], v192, s[28:31], s65 offen offset:0
  v_mfma_f32_16x16x32_bf16 v[148:151], a[20:23], v[68:71], v[148:151]
  ds_write_b128 v2, v[136:139] offset:4096
  v_mfma_f32_16x16x32_bf16 v[152:155], a[24:27], v[68:71], v[152:155]
  v_mfma_f32_16x16x32_bf16 v[156:159], a[28:31], v[68:71], v[156:159]
  s_waitcnt vmcnt(14)
  v_mfma_f32_16x16x32_bf16 v[144:147], a[32:35], v[72:75], v[144:147]
  buffer_load_dwordx4 v[68:71], v192, s[28:31], s65 offen offset:1024
  v_mfma_f32_16x16x32_bf16 v[148:151], a[36:39], v[72:75], v[148:151]
  ds_write_b128 v2, v[140:143] offset:8192
  v_mfma_f32_16x16x32_bf16 v[152:155], a[40:43], v[72:75], v[152:155]
  v_mfma_f32_16x16x32_bf16 v[156:159], a[44:47], v[72:75], v[156:159]
  s_waitcnt vmcnt(14)
  v_mfma_f32_16x16x32_bf16 v[144:147], a[48:51], v[76:79], v[144:147]
  buffer_load_dwordx4 v[72:75], v192, s[28:31], s65 offen offset:2048
  v_mfma_f32_16x16x32_bf16 v[148:151], a[52:55], v[76:79], v[148:151]
  v_mfma_f32_16x16x32_bf16 v[152:155], a[56:59], v[76:79], v[152:155]
  v_mfma_f32_16x16x32_bf16 v[156:159], a[60:63], v[76:79], v[156:159]
  s_waitcnt lgkmcnt(0)
  s_barrier
  s_waitcnt vmcnt(14)
  v_mfma_f32_16x16x32_bf16 v[144:147], a[64:67], v[80:83], v[144:147]
  buffer_load_dwordx4 v[76:79], v192, s[28:31], s65 offen offset:3072
  v_mfma_f32_16x16x32_bf16 v[148:151], a[68:71], v[80:83], v[148:151]
  ds_read_b128 v[160:163], v3 offset:0
  v_mfma_f32_16x16x32_bf16 v[152:155], a[72:75], v[80:83], v[152:155]
  ds_read_b128 v[164:167], v4 offset:4096
  v_mfma_f32_16x16x32_bf16 v[156:159], a[76:79], v[80:83], v[156:159]
  ds_read_b128 v[168:171], v5 offset:8192
  s_waitcnt vmcnt(14)
  v_mfma_f32_16x16x32_bf16 v[144:147], a[80:83], v[84:87], v[144:147]
  buffer_load_dwordx4 v[80:83], v193, s[28:31], s65 offen offset:0
  v_mfma_f32_16x16x32_bf16 v[148:151], a[84:87], v[84:87], v[148:151]
  v_mfma_f32_16x16x32_bf16 v[152:155], a[88:91], v[84:87], v[152:155]
  v_mfma_f32_16x16x32_bf16 v[156:159], a[92:95], v[84:87], v[156:159]
  s_waitcnt vmcnt(14)
  v_mfma_f32_16x16x32_bf16 v[144:147], a[96:99], v[88:91], v[144:147]
  buffer_load_dwordx4 v[84:87], v193, s[28:31], s65 offen offset:1024
  v_mfma_f32_16x16x32_bf16 v[148:151], a[100:103], v[88:91], v[148:151]
  s_waitcnt lgkmcnt(1)
  v_add_f32 v160, v160, v164
  v_add_f32 v161, v161, v165
  v_mfma_f32_16x16x32_bf16 v[152:155], a[104:107], v[88:91], v[152:155]
  v_add_f32 v162, v162, v166
  v_add_f32 v163, v163, v167
  v_mfma_f32_16x16x32_bf16 v[156:159], a[108:111], v[88:91], v[156:159]
  s_waitcnt lgkmcnt(0)
  v_add_f32 v128, v128, v168
  s_waitcnt vmcnt(14)
  v_mfma_f32_16x16x32_bf16 v[144:147], a[112:115], v[92:95], v[144:147]
  buffer_load_dwordx4 v[88:91], v193, s[28:31], s65 offen offset:2048
  v_mfma_f32_16x16x32_bf16 v[148:151], a[116:119], v[92:95], v[148:151]
  v_add_f32 v129, v129, v169
  v_add_f32 v130, v130, v170
  v_mfma_f32_16x16x32_bf16 v[152:155], a[120:123], v[92:95], v[152:155]
  v_add_f32 v131, v131, v171
  v_add_f32 v128, v128, v160
  v_mfma_f32_16x16x32_bf16 v[156:159], a[124:127], v[92:95], v[156:159]
  v_add_f32 v129, v129, v161
  s_waitcnt vmcnt(14)
  v_mfma_f32_16x16x32_bf16 v[144:147], a[128:131], v[96:99], v[144:147]
  buffer_load_dwordx4 v[92:95], v193, s[28:31], s65 offen offset:3072
  v_mfma_f32_16x16x32_bf16 v[148:151], a[132:135], v[96:99], v[148:151]
  v_add_f32 v130, v130, v162
  v_add_f32 v131, v131, v163
  v_mfma_f32_16x16x32_bf16 v[152:155], a[136:139], v[96:99], v[152:155]
  v_mul_f32 v160, v128, v128
  v_mul_f32 v161, v129, v129
  v_mfma_f32_16x16x32_bf16 v[156:159], a[140:143], v[96:99], v[156:159]
  s_waitcnt vmcnt(14)
  v_mfma_f32_16x16x32_bf16 v[144:147], a[144:147], v[100:103], v[144:147]
  buffer_load_dwordx4 v[96:99], v194, s[28:31], s65 offen offset:0
  v_mfma_f32_16x16x32_bf16 v[148:151], a[148:151], v[100:103], v[148:151]
  v_mul_f32 v162, v130, v130
  v_mul_f32 v163, v131, v131
  v_mfma_f32_16x16x32_bf16 v[152:155], a[152:155], v[100:103], v[152:155]
  v_fma_f32 v160, v160, s62, v30
  v_fma_f32 v161, v161, s62, v30
  v_mfma_f32_16x16x32_bf16 v[156:159], a[156:159], v[100:103], v[156:159]
  s_waitcnt vmcnt(14)
  v_mfma_f32_16x16x32_bf16 v[144:147], a[160:163], v[104:107], v[144:147]
  buffer_load_dwordx4 v[100:103], v194, s[28:31], s65 offen offset:1024
  v_mfma_f32_16x16x32_bf16 v[148:151], a[164:167], v[104:107], v[148:151]
  v_fma_f32 v162, v162, s62, v30
  v_fma_f32 v163, v163, s62, v30
  v_mfma_f32_16x16x32_bf16 v[152:155], a[168:171], v[104:107], v[152:155]
  v_mul_f32 v160, v160, v128
  v_mul_f32 v161, v161, v129
  v_mfma_f32_16x16x32_bf16 v[156:159], a[172:175], v[104:107], v[156:159]
  s_waitcnt vmcnt(14)
  v_mfma_f32_16x16x32_bf16 v[144:147], a[176:179], v[108:111], v[144:147]
  buffer_load_dwordx4 v[104:107], v194, s[28:31], s65 offen offset:2048
  v_mfma_f32_16x16x32_bf16 v[148:151], a[180:183], v[108:111], v[148:151]
  v_mul_f32 v162, v162, v130
  v_mul_f32 v163, v163, v131
  v_mfma_f32_16x16x32_bf16 v[152:155], a[184:187], v[108:111], v[152:155]
  v_exp_f32 v160, v160
  v_exp_f32 v161, v161
  v_mfma_f32_16x16x32_bf16 v[156:159], a[188:191], v[108:111], v[156:159]
  s_waitcnt vmcnt(14)
  v_mfma_f32_16x16x32_bf16 v[144:147], a[192:195], v[112:115], v[144:147]
  buffer_load_dwordx4 v[108:111], v194, s[28:31], s65 offen offset:3072
  v_mfma_f32_16x16x32_bf16 v[148:151], a[196:199], v[112:115], v[148:151]
  v_exp_f32 v162, v162
  v_exp_f32 v163, v163
  v_mfma_f32_16x16x32_bf16 v[152:155], a[200:203], v[112:115], v[152:155]
  v_add_f32 v160, 1.0, v160
  v_add_f32 v161, 1.0, v161
  v_mfma_f32_16x16x32_bf16 v[156:159], a[204:207], v[112:115], v[156:159]
  s_waitcnt vmcnt(14)
  v_mfma_f32_16x16x32_bf16 v[144:147], a[208:211], v[116:119], v[144:147]
  buffer_load_dwordx4 v[112:115], v195, s[28:31], s65 offen offset:0
  v_mfma_f32_16x16x32_bf16 v[148:151], a[212:215], v[116:119], v[148:151]
  v_add_f32 v162, 1.0, v162
  v_add_f32 v163, 1.0, v163
  v_mfma_f32_16x16x32_bf16 v[152:155], a[216:219], v[116:119], v[152:155]
  v_rcp_f32 v160, v160
  v_rcp_f32 v161, v161
  v_mfma_f32_16x16x32_bf16 v[156:159], a[220:223], v[116:119], v[156:159]
  s_waitcnt vmcnt(14)
  v_mfma_f32_16x16x32_bf16 v[144:147], a[224:227], v[120:123], v[144:147]
  buffer_load_dwordx4 v[116:119], v195, s[28:31], s65 offen offset:1024
  v_mfma_f32_16x16x32_bf16 v[148:151], a[228:231], v[120:123], v[148:151]
  v_rcp_f32 v162, v162
  v_rcp_f32 v163, v163
  v_mfma_f32_16x16x32_bf16 v[152:155], a[232:235], v[120:123], v[152:155]
  v_mul_f32 v160, v160, v128
  v_mul_f32 v161, v161, v129
  v_mfma_f32_16x16x32_bf16 v[156:159], a[236:239], v[120:123], v[156:159]
  s_waitcnt vmcnt(14)
  v_mfma_f32_16x16x32_bf16 v[144:147], a[240:243], v[124:127], v[144:147]
  buffer_load_dwordx4 v[120:123], v195, s[28:31], s65 offen offset:2048
  v_mfma_f32_16x16x32_bf16 v[148:151], a[244:247], v[124:127], v[148:151]
  v_mul_f32 v162, v162, v130
  v_mul_f32 v163, v163, v131
  v_mfma_f32_16x16x32_bf16 v[152:155], a[248:251], v[124:127], v[152:155]
  v_cvt_pk_bf16_f32 v172, v160, v161
  v_cvt_pk_bf16_f32 v173, v162, v163
  v_mfma_f32_16x16x32_bf16 v[156:159], a[252:255], v[124:127], v[156:159]
  s_waitcnt vmcnt(14)
  v_mfma_f32_16x16x32_bf16 v[128:131], a[0:3], v[64:67], v[24:27]
  buffer_load_dwordx4 v[124:127], v195, s[28:31], s65 offen offset:3072
  v_mfma_f32_16x16x32_bf16 v[132:135], a[4:7], v[64:67], 0
  ds_write_b128 v2, v[148:151] offset:12288
  v_mfma_f32_16x16x32_bf16 v[136:139], a[8:11], v[64:67], 0
  v_mfma_f32_16x16x32_bf16 v[140:143], a[12:15], v[64:67], 0
  s_waitcnt vmcnt(14)
  v_mfma_f32_16x16x32_bf16 v[128:131], a[16:19], v[68:71], v[128:131]
  buffer_load_dwordx4 v[64:67], v192, s[28:31], s66 offen offset:0
  v_mfma_f32_16x16x32_bf16 v[132:135], a[20:23], v[68:71], v[132:135]
  ds_write_b128 v2, v[152:155] offset:16384
  v_mfma_f32_16x16x32_bf16 v[136:139], a[24:27], v[68:71], v[136:139]
  v_mfma_f32_16x16x32_bf16 v[140:143], a[28:31], v[68:71], v[140:143]
  s_waitcnt vmcnt(14)
  v_mfma_f32_16x16x32_bf16 v[128:131], a[32:35], v[72:75], v[128:131]
  buffer_load_dwordx4 v[68:71], v192, s[28:31], s66 offen offset:1024
  v_mfma_f32_16x16x32_bf16 v[132:135], a[36:39], v[72:75], v[132:135]
  ds_write_b128 v2, v[156:159] offset:20480
  v_mfma_f32_16x16x32_bf16 v[136:139], a[40:43], v[72:75], v[136:139]
  v_mfma_f32_16x16x32_bf16 v[140:143], a[44:47], v[72:75], v[140:143]
  s_waitcnt vmcnt(14)
  v_mfma_f32_16x16x32_bf16 v[128:131], a[48:51], v[76:79], v[128:131]
  buffer_load_dwordx4 v[72:75], v192, s[28:31], s66 offen offset:2048
  v_mfma_f32_16x16x32_bf16 v[132:135], a[52:55], v[76:79], v[132:135]
  v_mfma_f32_16x16x32_bf16 v[136:139], a[56:59], v[76:79], v[136:139]
  v_mfma_f32_16x16x32_bf16 v[140:143], a[60:63], v[76:79], v[140:143]
  s_waitcnt lgkmcnt(0)
  s_barrier
  s_waitcnt vmcnt(14)
  v_mfma_f32_16x16x32_bf16 v[128:131], a[64:67], v[80:83], v[128:131]
  buffer_load_dwordx4 v[76:79], v192, s[28:31], s66 offen offset:3072
  v_mfma_f32_16x16x32_bf16 v[132:135], a[68:71], v[80:83], v[132:135]
  ds_read_b128 v[160:163], v3 offset:12288
  v_mfma_f32_16x16x32_bf16 v[136:139], a[72:75], v[80:83], v[136:139]
  ds_read_b128 v[164:167], v4 offset:16384
  v_mfma_f32_16x16x32_bf16 v[140:143], a[76:79], v[80:83], v[140:143]
  ds_read_b128 v[168:171], v5 offset:20480
  s_waitcnt vmcnt(14)
  v_mfma_f32_16x16x32_bf16 v[128:131], a[80:83], v[84:87], v[128:131]
  buffer_load_dwordx4 v[80:83], v193, s[28:31], s66 offen offset:0
  v_mfma_f32_16x16x32_bf16 v[132:135], a[84:87], v[84:87], v[132:135]
  v_mfma_f32_16x16x32_bf16 v[136:139], a[88:91], v[84:87], v[136:139]
  v_mfma_f32_16x16x32_bf16 v[140:143], a[92:95], v[84:87], v[140:143]
  s_waitcnt vmcnt(14)
  v_mfma_f32_16x16x32_bf16 v[128:131], a[96:99], v[88:91], v[128:131]
  buffer_load_dwordx4 v[84:87], v193, s[28:31], s66 offen offset:1024
  v_mfma_f32_16x16x32_bf16 v[132:135], a[100:103], v[88:91], v[132:135]
  s_waitcnt lgkmcnt(1)
  v_add_f32 v160, v160, v164
  v_add_f32 v161, v161, v165
  v_mfma_f32_16x16x32_bf16 v[136:139], a[104:107], v[88:91], v[136:139]
  v_add_f32 v162, v162, v166
  v_add_f32 v163, v163, v167
  v_mfma_f32_16x16x32_bf16 v[140:143], a[108:111], v[88:91], v[140:143]
  s_waitcnt lgkmcnt(0)
  v_add_f32 v144, v144, v168
  s_waitcnt vmcnt(14)
  v_mfma_f32_16x16x32_bf16 v[128:131], a[112:115], v[92:95], v[128:131]
  buffer_load_dwordx4 v[88:91], v193, s[28:31], s66 offen offset:2048
  v_mfma_f32_16x16x32_bf16 v[132:135], a[116:119], v[92:95], v[132:135]
  v_add_f32 v145, v145, v169
  v_add_f32 v146, v146, v170
  v_mfma_f32_16x16x32_bf16 v[136:139], a[120:123], v[92:95], v[136:139]
  v_add_f32 v147, v147, v171
  v_add_f32 v144, v144, v160
  v_mfma_f32_16x16x32_bf16 v[140:143], a[124:127], v[92:95], v[140:143]
  v_add_f32 v145, v145, v161
  s_waitcnt vmcnt(14)
  v_mfma_f32_16x16x32_bf16 v[128:131], a[128:131], v[96:99], v[128:131]
  buffer_load_dwordx4 v[92:95], v193, s[28:31], s66 offen offset:3072
  v_mfma_f32_16x16x32_bf16 v[132:135], a[132:135], v[96:99], v[132:135]
  v_add_f32 v146, v146, v162
  v_add_f32 v147, v147, v163
  v_mfma_f32_16x16x32_bf16 v[136:139], a[136:139], v[96:99], v[136:139]
  v_mul_f32 v160, v144, v144
  v_mul_f32 v161, v145, v145
  v_mfma_f32_16x16x32_bf16 v[140:143], a[140:143], v[96:99], v[140:143]
  v_mul_f32 v162, v146, v146
  s_waitcnt vmcnt(14)
  v_mfma_f32_16x16x32_bf16 v[128:131], a[144:147], v[100:103], v[128:131]
  buffer_load_dwordx4 v[96:99], v194, s[28:31], s66 offen offset:0
  v_mfma_f32_16x16x32_bf16 v[132:135], a[148:151], v[100:103], v[132:135]
  v_mul_f32 v163, v147, v147
  v_fma_f32 v160, v160, s62, v30
  v_mfma_f32_16x16x32_bf16 v[136:139], a[152:155], v[100:103], v[136:139]
  v_fma_f32 v161, v161, s62, v30
  v_fma_f32 v162, v162, s62, v30
  v_mfma_f32_16x16x32_bf16 v[140:143], a[156:159], v[100:103], v[140:143]
  v_fma_f32 v163, v163, s62, v30
  s_waitcnt vmcnt(14)
  v_mfma_f32_16x16x32_bf16 v[128:131], a[160:163], v[104:107], v[128:131]
  buffer_load_dwordx4 v[100:103], v194, s[28:31], s66 offen offset:1024
  v_mfma_f32_16x16x32_bf16 v[132:135], a[164:167], v[104:107], v[132:135]
  v_mul_f32 v160, v160, v144
  v_mul_f32 v161, v161, v145
  v_mfma_f32_16x16x32_bf16 v[136:139], a[168:171], v[104:107], v[136:139]
  v_mul_f32 v162, v162, v146
  v_mul_f32 v163, v163, v147
  v_mfma_f32_16x16x32_bf16 v[140:143], a[172:175], v[104:107], v[140:143]
  s_waitcnt vmcnt(14)
  v_mfma_f32_16x16x32_bf16 v[128:131], a[176:179], v[108:111], v[128:131]
  buffer_load_dwordx4 v[104:107], v194, s[28:31], s66 offen offset:2048
  v_mfma_f32_16x16x32_bf16 v[132:135], a[180:183], v[108:111], v[132:135]
  v_exp_f32 v160, v160
  v_exp_f32 v161, v161
  v_mfma_f32_16x16x32_bf16 v[136:139], a[184:187], v[108:111], v[136:139]
  v_exp_f32 v162, v162
  v_exp_f32 v163, v163
  v_mfma_f32_16x16x32_bf16 v[140:143], a[188:191], v[108:111], v[140:143]
  s_waitcnt vmcnt(14)
  v_mfma_f32_16x16x32_bf16 v[128:131], a[192:195], v[112:115], v[128:131]
  buffer_load_dwordx4 v[108:111], v194, s[28:31], s66 offen offset:3072
  v_mfma_f32_16x16x32_bf16 v[132:135], a[196:199], v[112:115], v[132:135]
  v_add_f32 v160, 1.0, v160
  v_add_f32 v161, 1.0, v161
  v_mfma_f32_16x16x32_bf16 v[136:139], a[200:203], v[112:115], v[136:139]
  v_add_f32 v162, 1.0, v162
  v_add_f32 v163, 1.0, v163
  v_mfma_f32_16x16x32_bf16 v[140:143], a[204:207], v[112:115], v[140:143]
  s_waitcnt vmcnt(14)
  v_mfma_f32_16x16x32_bf16 v[128:131], a[208:211], v[116:119], v[128:131]
  buffer_load_dwordx4 v[112:115], v195, s[28:31], s66 offen offset:0
  v_mfma_f32_16x16x32_bf16 v[132:135], a[212:215], v[116:119], v[132:135]
  v_rcp_f32 v160, v160
  v_rcp_f32 v161, v161
  v_mfma_f32_16x16x32_bf16 v[136:139], a[216:219], v[116:119], v[136:139]
  v_rcp_f32 v162, v162
  v_rcp_f32 v163, v163
  v_mfma_f32_16x16x32_bf16 v[140:143], a[220:223], v[116:119], v[140:143]
  s_waitcnt vmcnt(14)
  v_mfma_f32_16x16x32_bf16 v[128:131], a[224:227], v[120:123], v[128:131]
  buffer_load_dwordx4 v[116:119], v195, s[28:31], s66 offen offset:1024
  v_mfma_f32_16x16x32_bf16 v[132:135], a[228:231], v[120:123], v[132:135]
  v_mul_f32 v160, v160, v144
  v_mul_f32 v161, v161, v145
  v_mfma_f32_16x16x32_bf16 v[136:139], a[232:235], v[120:123], v[136:139]
  v_mul_f32 v162, v162, v146
  v_mul_f32 v163, v163, v147
  v_mfma_f32_16x16x32_bf16 v[140:143], a[236:239], v[120:123], v[140:143]
  s_waitcnt vmcnt(14)
  v_mfma_f32_16x16x32_bf16 v[128:131], a[240:243], v[124:127], v[128:131]
  buffer_load_dwordx4 v[120:123], v195, s[28:31], s66 offen offset:2048
  v_mfma_f32_16x16x32_bf16 v[132:135], a[244:247], v[124:127], v[132:135]
  v_cvt_pk_bf16_f32 v174, v160, v161
  v_cvt_pk_bf16_f32 v175, v162, v163
  v_mfma_f32_16x16x32_bf16 v[136:139], a[248:251], v[124:127], v[136:139]
  v_permlane16_swap_b32 v172, v174
  v_permlane16_swap_b32 v173, v175
  v_mfma_f32_16x16x32_bf16 v[140:143], a[252:255], v[124:127], v[140:143]
  s_waitcnt vmcnt(14)
  v_mfma_f32_16x16x32_bf16 v[144:147], a[0:3], v[64:67], v[24:27]
  buffer_load_dwordx4 v[124:127], v195, s[28:31], s66 offen offset:3072
  v_mfma_f32_16x16x32_bf16 v[148:151], a[4:7], v[64:67], 0
  ds_write_b128 v2, v[132:135] offset:0
  v_mfma_f32_16x16x32_bf16 v[152:155], a[8:11], v[64:67], 0
  v_mfma_f32_16x16x32_bf16 v[156:159], a[12:15], v[64:67], 0
  s_waitcnt vmcnt(14)
  v_mfma_f32_16x16x32_bf16 v[144:147], a[16:19], v[68:71], v[144:147]
  buffer_load_dwordx4 v[64:67], v192, s[28:31], s67 offen offset:0
  v_mfma_f32_16x16x32_bf16 v[148:151], a[20:23], v[68:71], v[148:151]
  ds_write_b128 v2, v[136:139] offset:4096
  v_mfma_f32_16x16x32_bf16 v[152:155], a[24:27], v[68:71], v[152:155]
  v_mfma_f32_16x16x32_bf16 v[156:159], a[28:31], v[68:71], v[156:159]
  s_waitcnt vmcnt(14)
  v_mfma_f32_16x16x32_bf16 v[144:147], a[32:35], v[72:75], v[144:147]
  buffer_load_dwordx4 v[68:71], v192, s[28:31], s67 offen offset:1024
  v_mfma_f32_16x16x32_bf16 v[148:151], a[36:39], v[72:75], v[148:151]
  ds_write_b128 v2, v[140:143] offset:8192
  v_mfma_f32_16x16x32_bf16 v[152:155], a[40:43], v[72:75], v[152:155]
  v_mfma_f32_16x16x32_bf16 v[156:159], a[44:47], v[72:75], v[156:159]
  s_waitcnt vmcnt(14)
  v_mfma_f32_16x16x32_bf16 v[144:147], a[48:51], v[76:79], v[144:147]
  buffer_load_dwordx4 v[72:75], v192, s[28:31], s67 offen offset:2048
  v_mfma_f32_16x16x32_bf16 v[148:151], a[52:55], v[76:79], v[148:151]
  v_mfma_f32_16x16x32_bf16 v[152:155], a[56:59], v[76:79], v[152:155]
  v_mfma_f32_16x16x32_bf16 v[156:159], a[60:63], v[76:79], v[156:159]
  s_waitcnt lgkmcnt(0)
  s_barrier
  s_waitcnt vmcnt(14)
  v_mfma_f32_16x16x32_bf16 v[144:147], a[64:67], v[80:83], v[144:147]
  buffer_load_dwordx4 v[76:79], v192, s[28:31], s67 offen offset:3072
  v_mfma_f32_16x16x32_bf16 v[148:151], a[68:71], v[80:83], v[148:151]
  ds_read_b128 v[160:163], v3 offset:0
  v_mfma_f32_16x16x32_bf16 v[152:155], a[72:75], v[80:83], v[152:155]
  ds_read_b128 v[164:167], v4 offset:4096
  v_mfma_f32_16x16x32_bf16 v[156:159], a[76:79], v[80:83], v[156:159]
  ds_read_b128 v[168:171], v5 offset:8192
  s_waitcnt vmcnt(14)
  v_mfma_f32_16x16x32_bf16 v[144:147], a[80:83], v[84:87], v[144:147]
  buffer_load_dwordx4 v[80:83], v193, s[28:31], s67 offen offset:0
  v_mfma_f32_16x16x32_bf16 v[148:151], a[84:87], v[84:87], v[148:151]
  v_mfma_f32_16x16x32_bf16 v[152:155], a[88:91], v[84:87], v[152:155]
  v_mfma_f32_16x16x32_bf16 v[156:159], a[92:95], v[84:87], v[156:159]
  s_waitcnt vmcnt(14)
  v_mfma_f32_16x16x32_bf16 v[144:147], a[96:99], v[88:91], v[144:147]
  buffer_load_dwordx4 v[84:87], v193, s[28:31], s67 offen offset:1024
  v_mfma_f32_16x16x32_bf16 v[148:151], a[100:103], v[88:91], v[148:151]
  s_waitcnt lgkmcnt(1)
  v_add_f32 v160, v160, v164
  v_add_f32 v161, v161, v165
  v_mfma_f32_16x16x32_bf16 v[152:155], a[104:107], v[88:91], v[152:155]
  v_add_f32 v162, v162, v166
  v_add_f32 v163, v163, v167
  v_mfma_f32_16x16x32_bf16 v[156:159], a[108:111], v[88:91], v[156:159]
  s_waitcnt lgkmcnt(0)
  v_add_f32 v128, v128, v168
  s_waitcnt vmcnt(14)
  v_mfma_f32_16x16x32_bf16 v[144:147], a[112:115], v[92:95], v[144:147]
  buffer_load_dwordx4 v[88:91], v193, s[28:31], s67 offen offset:2048
  v_mfma_f32_16x16x32_bf16 v[148:151], a[116:119], v[92:95], v[148:151]
  v_add_f32 v129, v129, v169
  v_add_f32 v130, v130, v170
  v_mfma_f32_16x16x32_bf16 v[152:155], a[120:123], v[92:95], v[152:155]
  v_add_f32 v131, v131, v171
  v_add_f32 v128, v128, v160
  v_mfma_f32_16x16x32_bf16 v[156:159], a[124:127], v[92:95], v[156:159]
  v_add_f32 v129, v129, v161
  s_waitcnt vmcnt(14)
  v_mfma_f32_16x16x32_bf16 v[144:147], a[128:131], v[96:99], v[144:147]
  buffer_load_dwordx4 v[92:95], v193, s[28:31], s67 offen offset:3072
  v_mfma_f32_16x16x32_bf16 v[148:151], a[132:135], v[96:99], v[148:151]
  v_add_f32 v130, v130, v162
  v_add_f32 v131, v131, v163
  v_mfma_f32_16x16x32_bf16 v[152:155], a[136:139], v[96:99], v[152:155]
  v_mul_f32 v160, v128, v128
  v_mul_f32 v161, v129, v129
  v_mfma_f32_16x16x32_bf16 v[156:159], a[140:143], v[96:99], v[156:159]
  s_waitcnt vmcnt(14)
  v_mfma_f32_16x16x32_bf16 v[144:147], a[144:147], v[100:103], v[144:147]
  buffer_load_dwordx4 v[96:99], v194, s[28:31], s67 offen offset:0
  v_mfma_f32_16x16x32_bf16 v[148:151], a[148:151], v[100:103], v[148:151]
  v_mul_f32 v162, v130, v130
  v_mul_f32 v163, v131, v131
  v_mfma_f32_16x16x32_bf16 v[152:155], a[152:155], v[100:103], v[152:155]
  v_fma_f32 v160, v160, s62, v30
  v_fma_f32 v161, v161, s62, v30
  v_mfma_f32_16x16x32_bf16 v[156:159], a[156:159], v[100:103], v[156:159]
  s_waitcnt vmcnt(14)
  v_mfma_f32_16x16x32_bf16 v[144:147], a[160:163], v[104:107], v[144:147]
  buffer_load_dwordx4 v[100:103], v194, s[28:31], s67 offen offset:1024
  v_mfma_f32_16x16x32_bf16 v[148:151], a[164:167], v[104:107], v[148:151]
  v_fma_f32 v162, v162, s62, v30
  v_fma_f32 v163, v163, s62, v30
  v_mfma_f32_16x16x32_bf16 v[152:155], a[168:171], v[104:107], v[152:155]
  v_mul_f32 v160, v160, v128
  v_mul_f32 v161, v161, v129
  v_mfma_f32_16x16x32_bf16 v[156:159], a[172:175], v[104:107], v[156:159]
  s_waitcnt vmcnt(14)
  v_mfma_f32_16x16x32_bf16 v[144:147], a[176:179], v[108:111], v[144:147]
  buffer_load_dwordx4 v[104:107], v194, s[28:31], s67 offen offset:2048
  v_mfma_f32_16x16x32_bf16 v[148:151], a[180:183], v[108:111], v[148:151]
  v_mul_f32 v162, v162, v130
  v_mul_f32 v163, v163, v131
  v_mfma_f32_16x16x32_bf16 v[152:155], a[184:187], v[108:111], v[152:155]
  v_exp_f32 v160, v160
  v_exp_f32 v161, v161
  v_mfma_f32_16x16x32_bf16 v[156:159], a[188:191], v[108:111], v[156:159]
  s_waitcnt vmcnt(14)
  v_mfma_f32_16x16x32_bf16 v[144:147], a[192:195], v[112:115], v[144:147]
  buffer_load_dwordx4 v[108:111], v194, s[28:31], s67 offen offset:3072
  v_mfma_f32_16x16x32_bf16 v[148:151], a[196:199], v[112:115], v[148:151]
  v_exp_f32 v162, v162
  v_exp_f32 v163, v163
  v_mfma_f32_16x16x32_bf16 v[152:155], a[200:203], v[112:115], v[152:155]
  v_add_f32 v160, 1.0, v160
  v_add_f32 v161, 1.0, v161
  v_mfma_f32_16x16x32_bf16 v[156:159], a[204:207], v[112:115], v[156:159]
  s_waitcnt vmcnt(14)
  v_mfma_f32_16x16x32_bf16 v[144:147], a[208:211], v[116:119], v[144:147]
  buffer_load_dwordx4 v[112:115], v195, s[28:31], s67 offen offset:0
  v_mfma_f32_16x16x32_bf16 v[148:151], a[212:215], v[116:119], v[148:151]
  v_add_f32 v162, 1.0, v162
  v_add_f32 v163, 1.0, v163
  v_mfma_f32_16x16x32_bf16 v[152:155], a[216:219], v[116:119], v[152:155]
  v_rcp_f32 v160, v160
  v_rcp_f32 v161, v161
  v_mfma_f32_16x16x32_bf16 v[156:159], a[220:223], v[116:119], v[156:159]
  s_waitcnt vmcnt(14)
  v_mfma_f32_16x16x32_bf16 v[144:147], a[224:227], v[120:123], v[144:147]
  buffer_load_dwordx4 v[116:119], v195, s[28:31], s67 offen offset:1024
  v_mfma_f32_16x16x32_bf16 v[148:151], a[228:231], v[120:123], v[148:151]
  v_rcp_f32 v162, v162
  v_rcp_f32 v163, v163
  v_mfma_f32_16x16x32_bf16 v[152:155], a[232:235], v[120:123], v[152:155]
  v_mul_f32 v160, v160, v128
  v_mul_f32 v161, v161, v129
  v_mfma_f32_16x16x32_bf16 v[156:159], a[236:239], v[120:123], v[156:159]
  s_waitcnt vmcnt(14)
  v_mfma_f32_16x16x32_bf16 v[144:147], a[240:243], v[124:127], v[144:147]
  buffer_load_dwordx4 v[120:123], v195, s[28:31], s67 offen offset:2048
  v_mfma_f32_16x16x32_bf16 v[148:151], a[244:247], v[124:127], v[148:151]
  v_mul_f32 v162, v162, v130
  v_mul_f32 v163, v163, v131
  v_mfma_f32_16x16x32_bf16 v[152:155], a[248:251], v[124:127], v[152:155]
  v_cvt_pk_bf16_f32 v176, v160, v161
  v_cvt_pk_bf16_f32 v177, v162, v163
  v_mfma_f32_16x16x32_bf16 v[156:159], a[252:255], v[124:127], v[156:159]
  s_waitcnt vmcnt(14)
  v_mfma_f32_16x16x32_bf16 v[128:131], a[0:3], v[64:67], v[24:27]
  buffer_load_dwordx4 v[124:127], v195, s[28:31], s67 offen offset:3072
  v_mfma_f32_16x16x32_bf16 v[132:135], a[4:7], v[64:67], 0
  ds_write_b128 v2, v[148:151] offset:12288
  v_mfma_f32_16x16x32_bf16 v[136:139], a[8:11], v[64:67], 0
  v_mfma_f32_16x16x32_bf16 v[140:143], a[12:15], v[64:67], 0
  s_waitcnt vmcnt(14)
  v_mfma_f32_16x16x32_bf16 v[128:131], a[16:19], v[68:71], v[128:131]
  buffer_store_dwordx4 v[172:175], v11, s[28:31], s20 offen sc1
  v_mfma_f32_16x16x32_bf16 v[132:135], a[20:23], v[68:71], v[132:135]
  ds_write_b128 v2, v[152:155] offset:16384
  v_mfma_f32_16x16x32_bf16 v[136:139], a[24:27], v[68:71], v[136:139]
  v_mfma_f32_16x16x32_bf16 v[140:143], a[28:31], v[68:71], v[140:143]
  s_waitcnt vmcnt(14)
  v_mfma_f32_16x16x32_bf16 v[128:131], a[32:35], v[72:75], v[128:131]
  v_mfma_f32_16x16x32_bf16 v[132:135], a[36:39], v[72:75], v[132:135]
  ds_write_b128 v2, v[156:159] offset:20480
  v_mfma_f32_16x16x32_bf16 v[136:139], a[40:43], v[72:75], v[136:139]
  v_mfma_f32_16x16x32_bf16 v[140:143], a[44:47], v[72:75], v[140:143]
  s_waitcnt vmcnt(13)
  v_mfma_f32_16x16x32_bf16 v[128:131], a[48:51], v[76:79], v[128:131]
  v_mfma_f32_16x16x32_bf16 v[132:135], a[52:55], v[76:79], v[132:135]
  v_mfma_f32_16x16x32_bf16 v[136:139], a[56:59], v[76:79], v[136:139]
  v_mfma_f32_16x16x32_bf16 v[140:143], a[60:63], v[76:79], v[140:143]
  s_waitcnt lgkmcnt(0)
  s_barrier
  s_waitcnt vmcnt(12)
  v_mfma_f32_16x16x32_bf16 v[128:131], a[64:67], v[80:83], v[128:131]
  v_mfma_f32_16x16x32_bf16 v[132:135], a[68:71], v[80:83], v[132:135]
  ds_read_b128 v[160:163], v3 offset:12288
  v_mfma_f32_16x16x32_bf16 v[136:139], a[72:75], v[80:83], v[136:139]
  ds_read_b128 v[164:167], v4 offset:16384
  v_mfma_f32_16x16x32_bf16 v[140:143], a[76:79], v[80:83], v[140:143]
  ds_read_b128 v[168:171], v5 offset:20480
  s_waitcnt vmcnt(11)
  v_mfma_f32_16x16x32_bf16 v[128:131], a[80:83], v[84:87], v[128:131]
  v_mfma_f32_16x16x32_bf16 v[132:135], a[84:87], v[84:87], v[132:135]
  v_mfma_f32_16x16x32_bf16 v[136:139], a[88:91], v[84:87], v[136:139]
  v_mfma_f32_16x16x32_bf16 v[140:143], a[92:95], v[84:87], v[140:143]
  s_waitcnt vmcnt(10)
  v_mfma_f32_16x16x32_bf16 v[128:131], a[96:99], v[88:91], v[128:131]
  v_mfma_f32_16x16x32_bf16 v[132:135], a[100:103], v[88:91], v[132:135]
  s_waitcnt lgkmcnt(1)
  v_add_f32 v160, v160, v164
  v_add_f32 v161, v161, v165
  v_mfma_f32_16x16x32_bf16 v[136:139], a[104:107], v[88:91], v[136:139]
  v_add_f32 v162, v162, v166
  v_add_f32 v163, v163, v167
  v_mfma_f32_16x16x32_bf16 v[140:143], a[108:111], v[88:91], v[140:143]
  s_waitcnt lgkmcnt(0)
  v_add_f32 v144, v144, v168
  s_waitcnt vmcnt(9)
  v_mfma_f32_16x16x32_bf16 v[128:131], a[112:115], v[92:95], v[128:131]
  v_mfma_f32_16x16x32_bf16 v[132:135], a[116:119], v[92:95], v[132:135]
  v_add_f32 v145, v145, v169
  v_add_f32 v146, v146, v170
  v_mfma_f32_16x16x32_bf16 v[136:139], a[120:123], v[92:95], v[136:139]
  v_add_f32 v147, v147, v171
  v_add_f32 v144, v144, v160
  v_mfma_f32_16x16x32_bf16 v[140:143], a[124:127], v[92:95], v[140:143]
  v_add_f32 v145, v145, v161
  s_waitcnt vmcnt(8)
  v_mfma_f32_16x16x32_bf16 v[128:131], a[128:131], v[96:99], v[128:131]
  v_mfma_f32_16x16x32_bf16 v[132:135], a[132:135], v[96:99], v[132:135]
  v_add_f32 v146, v146, v162
  v_add_f32 v147, v147, v163
  v_mfma_f32_16x16x32_bf16 v[136:139], a[136:139], v[96:99], v[136:139]
  v_mul_f32 v160, v144, v144
  v_mul_f32 v161, v145, v145
  v_mfma_f32_16x16x32_bf16 v[140:143], a[140:143], v[96:99], v[140:143]
  v_mul_f32 v162, v146, v146
  s_waitcnt vmcnt(7)
  v_mfma_f32_16x16x32_bf16 v[128:131], a[144:147], v[100:103], v[128:131]
  v_mfma_f32_16x16x32_bf16 v[132:135], a[148:151], v[100:103], v[132:135]
  v_mul_f32 v163, v147, v147
  v_fma_f32 v160, v160, s62, v30
  v_mfma_f32_16x16x32_bf16 v[136:139], a[152:155], v[100:103], v[136:139]
  v_fma_f32 v161, v161, s62, v30
  v_fma_f32 v162, v162, s62, v30
  v_mfma_f32_16x16x32_bf16 v[140:143], a[156:159], v[100:103], v[140:143]
  v_fma_f32 v163, v163, s62, v30
  s_waitcnt vmcnt(6)
  v_mfma_f32_16x16x32_bf16 v[128:131], a[160:163], v[104:107], v[128:131]
  v_mfma_f32_16x16x32_bf16 v[132:135], a[164:167], v[104:107], v[132:135]
  v_mul_f32 v160, v160, v144
  v_mul_f32 v161, v161, v145
  v_mfma_f32_16x16x32_bf16 v[136:139], a[168:171], v[104:107], v[136:139]
  v_mul_f32 v162, v162, v146
  v_mul_f32 v163, v163, v147
  v_mfma_f32_16x16x32_bf16 v[140:143], a[172:175], v[104:107], v[140:143]
  v_exp_f32 v160, v160
  s_waitcnt vmcnt(5)
  v_mfma_f32_16x16x32_bf16 v[128:131], a[176:179], v[108:111], v[128:131]
  v_mfma_f32_16x16x32_bf16 v[132:135], a[180:183], v[108:111], v[132:135]
  v_exp_f32 v161, v161
  v_exp_f32 v162, v162
  v_mfma_f32_16x16x32_bf16 v[136:139], a[184:187], v[108:111], v[136:139]
  v_exp_f32 v163, v163
  v_add_f32 v160, 1.0, v160
  v_mfma_f32_16x16x32_bf16 v[140:143], a[188:191], v[108:111], v[140:143]
  s_waitcnt vmcnt(4)
  v_mfma_f32_16x16x32_bf16 v[128:131], a[192:195], v[112:115], v[128:131]
  v_mfma_f32_16x16x32_bf16 v[132:135], a[196:199], v[112:115], v[132:135]
  v_add_f32 v161, 1.0, v161
  v_add_f32 v162, 1.0, v162
  v_mfma_f32_16x16x32_bf16 v[136:139], a[200:203], v[112:115], v[136:139]
  v_add_f32 v163, 1.0, v163
  v_rcp_f32 v160, v160
  v_mfma_f32_16x16x32_bf16 v[140:143], a[204:207], v[112:115], v[140:143]
  s_waitcnt vmcnt(3)
  v_mfma_f32_16x16x32_bf16 v[128:131], a[208:211], v[116:119], v[128:131]
  v_mfma_f32_16x16x32_bf16 v[132:135], a[212:215], v[116:119], v[132:135]
  v_rcp_f32 v161, v161
  v_rcp_f32 v162, v162
  v_mfma_f32_16x16x32_bf16 v[136:139], a[216:219], v[116:119], v[136:139]
  v_rcp_f32 v163, v163
  v_mul_f32 v160, v160, v144
  v_mfma_f32_16x16x32_bf16 v[140:143], a[220:223], v[116:119], v[140:143]
  s_waitcnt vmcnt(2)
  v_mfma_f32_16x16x32_bf16 v[128:131], a[224:227], v[120:123], v[128:131]
  v_mfma_f32_16x16x32_bf16 v[132:135], a[228:231], v[120:123], v[132:135]
  v_mul_f32 v161, v161, v145
  v_mul_f32 v162, v162, v146
  v_mfma_f32_16x16x32_bf16 v[136:139], a[232:235], v[120:123], v[136:139]
  v_mul_f32 v163, v163, v147
  v_cvt_pk_bf16_f32 v178, v160, v161
  v_mfma_f32_16x16x32_bf16 v[140:143], a[236:239], v[120:123], v[140:143]
  s_waitcnt vmcnt(1)
  v_mfma_f32_16x16x32_bf16 v[128:131], a[240:243], v[124:127], v[128:131]
  v_mfma_f32_16x16x32_bf16 v[132:135], a[244:247], v[124:127], v[132:135]
  v_cvt_pk_bf16_f32 v179, v162, v163
  v_permlane16_swap_b32 v176, v178
  v_mfma_f32_16x16x32_bf16 v[136:139], a[248:251], v[124:127], v[136:139]
  v_permlane16_swap_b32 v177, v179
  buffer_store_dwordx4 v[176:179], v11, s[28:31], s22 offen sc1
  v_mfma_f32_16x16x32_bf16 v[140:143], a[252:255], v[124:127], v[140:143]
  s_nop 1
  ds_write_b128 v2, v[132:135] offset:0
  s_nop 1
  ds_write_b128 v2, v[136:139] offset:4096
  s_nop 1
  ds_write_b128 v2, v[140:143] offset:8192
  s_lshl3_add_u32 s74, s76, s9
  s_lshl_b32 s74, s74, 7
  s_add_u32 s74, s74, 655360
  v_mov_b32 v21, s59
  s_waitcnt vmcnt(1)
  s_waitcnt lgkmcnt(0)
  s_barrier
  ds_read_b128 v[160:163], v3 offset:0
  ds_read_b128 v[164:167], v4 offset:4096
  ds_read_b128 v[168:171], v5 offset:8192
  s_cmp_lg_u32 s58, 1
  s_cbranch_scc1 Lnoef
  s_mov_b64 exec, 1
  buffer_store_dword v21, off, s[28:31], s74 sc1
  s_mov_b64 exec, -1
Lnoef:
  s_waitcnt lgkmcnt(1)
  v_add_f32 v160, v160, v164
  v_add_f32 v161, v161, v165
  v_add_f32 v162, v162, v166
  v_add_f32 v163, v163, v167
  s_waitcnt lgkmcnt(0)
  v_add_f32 v128, v128, v168
  v_add_f32 v129, v129, v169
  v_add_f32 v130, v130, v170
  v_add_f32 v131, v131, v171
  v_add_f32 v128, v128, v160
  v_add_f32 v129, v129, v161
  v_add_f32 v130, v130, v162
  v_add_f32 v131, v131, v163
  v_mul_f32 v160, v128, v128
  v_mul_f32 v161, v129, v129
  v_mul_f32 v162, v130, v130
  v_mul_f32 v163, v131, v131
  v_fma_f32 v160, v160, s62, v30
  v_fma_f32 v161, v161, s62, v30
  v_fma_f32 v162, v162, s62, v30
  v_fma_f32 v163, v163, s62, v30
  v_mul_f32 v160, v160, v128
  v_mul_f32 v161, v161, v129
  v_mul_f32 v162, v162, v130
  v_mul_f32 v163, v163, v131
  v_exp_f32 v160, v160
  v_exp_f32 v161, v161
  v_exp_f32 v162, v162
  v_exp_f32 v163, v163
  v_add_f32 v160, 1.0, v160
  v_add_f32 v161, 1.0, v161
  v_add_f32 v162, 1.0, v162
  v_add_f32 v163, 1.0, v163
  v_rcp_f32 v160, v160
  v_rcp_f32 v161, v161
  v_rcp_f32 v162, v162
  v_rcp_f32 v163, v163
  v_mul_f32 v160, v160, v128
  v_mul_f32 v161, v161, v129
  v_mul_f32 v162, v162, v130
  v_mul_f32 v163, v163, v131
  v_cvt_pk_bf16_f32 v180, v160, v161
  v_cvt_pk_bf16_f32 v181, v162, v163
  buffer_store_dwordx2 v[180:181], v10, s[28:31], s24 offen sc1
  s_branch Lp4end
Lp4skip:
  s_add_u32 m0, s4, s3
  s_mul_i32 s5, s4, 32
  buffer_load_dwordx4 v248, s[48:51], s5 offen lds
  buffer_load_dwordx4 v249, s[48:51], s5 offen offset:1024 lds
  s_addk_i32 s4, 2048
  s_bitset0_b32 s4, 15
  s_add_u32 m0, s4, s3
  s_mul_i32 s5, s4, 32
  buffer_load_dwordx4 v248, s[48:51], s5 offen lds
  buffer_load_dwordx4 v249, s[48:51], s5 offen offset:1024 lds
  s_addk_i32 s4, 2048
  s_bitset0_b32 s4, 15
  s_add_u32 m0, s4, s3
  s_mul_i32 s5, s4, 32
  buffer_load_dwordx4 v248, s[48:51], s5 offen lds
  buffer_load_dwordx4 v249, s[48:51], s5 offen offset:1024 lds
  s_addk_i32 s4, 2048
  s_bitset0_b32 s4, 15
  s_add_u32 m0, s4, s3
  s_mul_i32 s5, s4, 32
  buffer_load_dwordx4 v248, s[48:51], s5 offen lds
  buffer_load_dwordx4 v249, s[48:51], s5 offen offset:1024 lds
  s_addk_i32 s4, 2048
  s_bitset0_b32 s4, 15
  s_add_u32 m0, s4, s3
  s_mul_i32 s5, s4, 32
  buffer_load_dwordx4 v248, s[48:51], s5 offen lds
  buffer_load_dwordx4 v249, s[48:51], s5 offen offset:1024 lds
  s_sub_u32 s70, s76, 27
  s_lshl3_add_u32 s70, s70, s9
  s_cmp_ge_u32 s70, 32
  s_cbranch_scc1 Lnow2
  s_lshl_b32 s71, s77, 5
  s_add_u32 s70, s70, s71
  s_add_u32 s70, s70, 256
  s_lshl_b32 s70, s70, 12
  v_lshrrev_b32 v16, 5, v1
  v_and_b32 v17, 31, v1
  v_lshlrev_b32 v17, 7, v17
  v_lshl_add_u32 v16, v16, 17, v17
  buffer_load_dword v64, v16, s[48:51], s70 offen
  s_add_u32 s70, s70, 262144
  buffer_load_dword v65, v16, s[48:51], s70 offen
  s_add_u32 s70, s70, 262144
  buffer_load_dword v66, v16, s[48:51], s70 offen
  s_add_u32 s70, s70, 262144
Lnow2:
  s_waitcnt vmcnt(0) lgkmcnt(0)
Lp4end:
  s_mul_i32 s17, s58, 32768
  s_add_u32 s17, s17, 0
  v_add_u32 v252, s17, v250
  v_xor_b32 v253, 32, v252
  v_xor_b32 v254, 64, v252
  v_xor_b32 v255, 96, v252
  ds_read_b64_tr_b16 a[0:1], v252 offset:0
  ds_read_b64_tr_b16 a[2:3], v252 offset:512
  ds_read_b64_tr_b16 a[4:5], v253 offset:0
  ds_read_b64_tr_b16 a[6:7], v253 offset:512
  ds_read_b64_tr_b16 a[8:9], v254 offset:0
  ds_read_b64_tr_b16 a[10:11], v254 offset:512
  ds_read_b64_tr_b16 a[12:13], v255 offset:0
  ds_read_b64_tr_b16 a[14:15], v255 offset:512
  ds_read_b64_tr_b16 a[16:17], v252 offset:4096
  ds_read_b64_tr_b16 a[18:19], v252 offset:4608
  ds_read_b64_tr_b16 a[20:21], v253 offset:4096
  ds_read_b64_tr_b16 a[22:23], v253 offset:4608
  ds_read_b64_tr_b16 a[24:25], v254 offset:4096
  ds_read_b64_tr_b16 a[26:27], v254 offset:4608
  ds_read_b64_tr_b16 a[28:29], v255 offset:4096
  ds_read_b64_tr_b16 a[30:31], v255 offset:4608
  ds_read_b64_tr_b16 a[32:33], v252 offset:8192
  ds_read_b64_tr_b16 a[34:35], v252 offset:8704
  ds_read_b64_tr_b16 a[36:37], v253 offset:8192
  ds_read_b64_tr_b16 a[38:39], v253 offset:8704
  ds_read_b64_tr_b16 a[40:41], v254 offset:8192
  ds_read_b64_tr_b16 a[42:43], v254 offset:8704
  ds_read_b64_tr_b16 a[44:45], v255 offset:8192
  ds_read_b64_tr_b16 a[46:47], v255 offset:8704
  ds_read_b64_tr_b16 a[48:49], v252 offset:12288
  ds_read_b64_tr_b16 a[50:51], v252 offset:12800
  ds_read_b64_tr_b16 a[52:53], v253 offset:12288
  ds_read_b64_tr_b16 a[54:55], v253 offset:12800
  ds_read_b64_tr_b16 a[56:57], v254 offset:12288
  ds_read_b64_tr_b16 a[58:59], v254 offset:12800
  ds_read_b64_tr_b16 a[60:61], v255 offset:12288
  ds_read_b64_tr_b16 a[62:63], v255 offset:12800
  ds_read_b64_tr_b16 a[64:65], v252 offset:16384
  ds_read_b64_tr_b16 a[66:67], v252 offset:16896
  ds_read_b64_tr_b16 a[68:69], v253 offset:16384
  ds_read_b64_tr_b16 a[70:71], v253 offset:16896
  ds_read_b64_tr_b16 a[72:73], v254 offset:16384
  ds_read_b64_tr_b16 a[74:75], v254 offset:16896
  ds_read_b64_tr_b16 a[76:77], v255 offset:16384
  ds_read_b64_tr_b16 a[78:79], v255 offset:16896
  ds_read_b64_tr_b16 a[80:81], v252 offset:20480
  ds_read_b64_tr_b16 a[82:83], v252 offset:20992
  ds_read_b64_tr_b16 a[84:85], v253 offset:20480
  ds_read_b64_tr_b16 a[86:87], v253 offset:20992
  ds_read_b64_tr_b16 a[88:89], v254 offset:20480
  ds_read_b64_tr_b16 a[90:91], v254 offset:20992
  ds_read_b64_tr_b16 a[92:93], v255 offset:20480
  ds_read_b64_tr_b16 a[94:95], v255 offset:20992
  ds_read_b64_tr_b16 a[96:97], v252 offset:24576
  ds_read_b64_tr_b16 a[98:99], v252 offset:25088
  ds_read_b64_tr_b16 a[100:101], v253 offset:24576
  ds_read_b64_tr_b16 a[102:103], v253 offset:25088
  ds_read_b64_tr_b16 a[104:105], v254 offset:24576
  ds_read_b64_tr_b16 a[106:107], v254 offset:25088
  ds_read_b64_tr_b16 a[108:109], v255 offset:24576
  ds_read_b64_tr_b16 a[110:111], v255 offset:25088
  ds_read_b64_tr_b16 a[112:113], v252 offset:28672
  ds_read_b64_tr_b16 a[114:115], v252 offset:29184
  ds_read_b64_tr_b16 a[116:117], v253 offset:28672
  ds_read_b64_tr_b16 a[118:119], v253 offset:29184
  ds_read_b64_tr_b16 a[120:121], v254 offset:28672
  ds_read_b64_tr_b16 a[122:123], v254 offset:29184
  ds_read_b64_tr_b16 a[124:125], v255 offset:28672
  ds_read_b64_tr_b16 a[126:127], v255 offset:29184
  s_lshl3_add_u32 s71, s76, s9
  s_lshl_b32 s70, s71, 7
  s_add_u32 s70, s70, 102400
  v_mov_b32 v16, s59
  s_waitcnt vmcnt(0)
  s_waitcnt lgkmcnt(0)
  s_cmp_lg_u32 s58, 0
  s_barrier
  s_cbranch_scc1 Lfl16
  s_mov_b64 exec, 1
  buffer_store_dword v16, off, s[28:31], s70 sc1
  s_mov_b64 exec, -1
Lfl16:
  s_mov_b32 s72, s9
  s_lshr_b32 s70, s77, 1
  v_and_b32 v16, 7, v1
  v_add_u32 v16, s70, v16
  v_min_u32 v16, 26, v16
  v_lshl_add_u32 v16, v16, 3, s72
  v_lshlrev_b32 v6, 7, v16
  s_mov_b32 s73, 102400
  s_lshl2_add_u32 s70, s10, s58
  s_lshl_b32 s70, s70, 4
  v_and_b32 v16, 15, v1
  v_add_u32 v16, s70, v16
  v_lshlrev_b32 v17, 1, v16
  global_load_ushort v24, v17, s[18:19]
  v_mul_u32_u24 v16, 1280, v16
  v_lshrrev_b32 v17, 4, v1
  v_lshl_add_u32 v16, v17, 3, v16
  s_mul_i32 s70, s72, 160
  v_add_u32 v10, s70, v16
  v_and_b32 v11, 1, v17
  v_mad_u32_u24 v11, v11, 24, v10
  s_mul_i32 s70, s72, 276480
  s_lshl_b32 s71, s77, 10
  s_add_u32 s70, s70, s71
  v_lshl_add_u32 v7, v1, 4, s70
  s_lshr_b32 s70, s58, 1
  s_lshl_b32 s70, s70, 31
  v_or_b32 v192, s70, v7
  s_mov_b64 exec, 0xff
  s_mov_b32 s74, 655360
  s_mov_b64 exec, -1
  s_mul_i32 s3, s58, 32768
  s_mul_i32 s4, s12, 3072
  s_add_u32 s3, s3, 0
  s_and_b32 s4, s4, 0xfffff800
  v_add_u32 v248, 1048576, v246
  v_add_u32 v249, 1048576, v247
  s_add_u32 m0, s4, s3
  s_mul_i32 s5, s4, 32
  buffer_load_dwordx4 v248, s[48:51], s5 offen lds
  buffer_load_dwordx4 v249, s[48:51], s5 offen offset:1024 lds
  s_addk_i32 s4, 2048
  s_cmpk_eq_u32 s4, 24576
  s_cmovk_i32 s4, 0
  s_add_u32 m0, s4, s3
  s_mul_i32 s5, s4, 32
  buffer_load_dwordx4 v248, s[48:51], s5 offen lds
  buffer_load_dwordx4 v249, s[48:51], s5 offen offset:1024 lds
  s_addk_i32 s4, 2048
  s_cmpk_eq_u32 s4, 24576
  s_cmovk_i32 s4, 0
  s_add_u32 m0, s4, s3
  s_mul_i32 s5, s4, 32
  buffer_load_dwordx4 v248, s[48:51], s5 offen lds
  buffer_load_dwordx4 v249, s[48:51], s5 offen offset:1024 lds
  s_addk_i32 s4, 2048
  s_cmpk_eq_u32 s4, 24576
  s_cmovk_i32 s4, 0
  s_add_u32 m0, s4, s3
  s_mul_i32 s5, s4, 32
  buffer_load_dwordx4 v248, s[48:51], s5 offen lds
  buffer_load_dwordx4 v249, s[48:51], s5 offen offset:1024 lds
  s_addk_i32 s4, 2048
  s_cmpk_eq_u32 s4, 24576
  s_cmovk_i32 s4, 0
  s_add_u32 m0, s4, s3
  s_mul_i32 s5, s4, 32
  buffer_load_dwordx4 v248, s[48:51], s5 offen lds
  buffer_load_dwordx4 v249, s[48:51], s5 offen offset:1024 lds
  s_addk_i32 s4, 2048
  s_cmpk_eq_u32 s4, 24576
  s_cmovk_i32 s4, 0
  s_add_u32 m0, s4, s3
  s_mul_i32 s5, s4, 32
  buffer_load_dwordx4 v248, s[48:51], s5 offen lds
  buffer_load_dwordx4 v249, s[48:51], s5 offen offset:1024 lds
  s_addk_i32 s4, 2048
  s_cmpk_eq_u32 s4, 24576
  s_cmovk_i32 s4, 0
  s_add_u32 m0, s4, s3
  s_mul_i32 s5, s4, 32
  buffer_load_dwordx4 v248, s[48:51], s5 offen lds
  buffer_load_dwordx4 v249, s[48:51], s5 offen offset:1024 lds
  s_addk_i32 s4, 2048
  s_cmpk_eq_u32 s4, 24576
  s_cmovk_i32 s4, 0
  s_add_u32 m0, s4, s3
  s_mul_i32 s5, s4, 32
  buffer_load_dwordx4 v248, s[48:51], s5 offen lds
  buffer_load_dwordx4 v249, s[48:51], s5 offen offset:1024 lds
  s_addk_i32 s4, 2048
  s_cmpk_eq_u32 s4, 24576
  s_cmovk_i32 s4, 0
  s_add_u32 m0, s4, s3
  s_mul_i32 s5, s4, 32
  buffer_load_dwordx4 v248, s[48:51], s5 offen lds
  buffer_load_dwordx4 v249, s[48:51], s5 offen offset:1024 lds
  s_addk_i32 s4, 2048
  s_cmpk_eq_u32 s4, 24576
  s_cmovk_i32 s4, 0
  buffer_load_dword v20, v6, s[28:31], s74 offen sc1
  s_add_u32 m0, s4, s3
  s_mul_i32 s5, s4, 32
  buffer_load_dwordx4 v248, s[48:51], s5 offen lds
  buffer_load_dwordx4 v249, s[48:51], s5 offen offset:1024 lds
  s_addk_i32 s4, 2048
  s_cmpk_eq_u32 s4, 24576
  s_cmovk_i32 s4, 0
  s_add_u32 m0, s4, s3
  s_mul_i32 s5, s4, 32
  buffer_load_dwordx4 v248, s[48:51], s5 offen lds
  buffer_load_dwordx4 v249, s[48:51], s5 offen offset:1024 lds
  s_addk_i32 s4, 2048
  s_cmpk_eq_u32 s4, 24576
  s_cmovk_i32 s4, 0
  s_add_u32 m0, s4, s3
  s_mul_i32 s5, s4, 32
  buffer_load_dwordx4 v248, s[48:51], s5 offen lds
  buffer_load_dwordx4 v249, s[48:51], s5 offen offset:1024 lds
  v_add_u32 v193, 0, v7
  v_add_u32 v194, 4096, v7
  v_add_u32 v195, 8192, v7
  v_add_u32 v196, 12288, v7
  s_mov_b32 s63, 15204352
  s_mov_b32 s64, 15259648
  s_mov_b32 s65, 15314944
  s_mov_b32 s66, 15370240
  s_mov_b32 s67, 15425536
  s_waitcnt vmcnt(25)
  v_lshlrev_b32 v24, 16, v24
  v_lshlrev_b32 v40, 16, v234
  v_and_b32 v41, 0xffff0000, v234
  v_lshlrev_b32 v42, 16, v235
  v_and_b32 v43, 0xffff0000, v235
  v_lshlrev_b32 v44, 16, v236
  v_and_b32 v45, 0xffff0000, v236
  v_lshlrev_b32 v46, 16, v237
  v_and_b32 v47, 0xffff0000, v237
  v_lshlrev_b32 v48, 16, v238
  v_and_b32 v49, 0xffff0000, v238
  v_lshlrev_b32 v50, 16, v239
  v_and_b32 v51, 0xffff0000, v239
  v_lshlrev_b32 v52, 16, v240
  v_and_b32 v53, 0xffff0000, v240
  v_lshlrev_b32 v54, 16, v241
  v_and_b32 v55, 0xffff0000, v241
  v_lshlrev_b32 v56, 16, v242
  v_and_b32 v57, 0xffff0000, v242
  v_lshlrev_b32 v58, 16, v243
  v_and_b32 v59, 0xffff0000, v243
  v_add_f32 v40, v24, v40
  v_add_f32 v41, v24, v41
  v_add_f32 v42, v24, v42
  v_add_f32 v43, v24, v43
  v_add_f32 v44, v24, v44
  v_add_f32 v45, v24, v45
  v_add_f32 v46, v24, v46
  v_add_f32 v47, v24, v47
  v_add_f32 v48, v24, v48
  v_add_f32 v49, v24, v49
  v_add_f32 v50, v24, v50
  v_add_f32 v51, v24, v51
  v_add_f32 v52, v24, v52
  v_add_f32 v53, v24, v53
  v_add_f32 v54, v24, v54
  v_add_f32 v55, v24, v55
  v_add_f32 v56, v24, v56
  v_add_f32 v57, v24, v57
  v_add_f32 v58, v24, v58
  v_add_f32 v59, v24, v59
  s_mov_b64 exec, 0xff
  s_waitcnt vmcnt(6)
  v_cmp_ne_u32 vcc, s59, v20
  s_cbranch_vccz Ld18
Lp17:
  buffer_load_dword v20, v6, s[28:31], s74 offen sc1
  s_waitcnt vmcnt(0) lgkmcnt(0)
  v_cmp_ne_u32 vcc, s59, v20
  s_cbranch_vccz Ld18
  s_sub_u32 s61, s61, 1
  s_cbranch_scc0 Lp17
  s_branch Lexit
Ld18:
  s_mov_b64 exec, -1
  buffer_load_dwordx4 v[64:67], v192, s[28:31], s63 offen offset:0
  buffer_load_dwordx4 v[68:71], v193, s[28:31], s63 offen offset:1024
  buffer_load_dwordx4 v[72:75], v193, s[28:31], s63 offen offset:2048
  buffer_load_dwordx4 v[76:79], v193, s[28:31], s63 offen offset:3072
  buffer_load_dwordx4 v[80:83], v194, s[28:31], s63 offen offset:0
  buffer_load_dwordx4 v[84:87], v194, s[28:31], s63 offen offset:1024
  buffer_load_dwordx4 v[88:91], v194, s[28:31], s63 offen offset:2048
  buffer_load_dwordx4 v[92:95], v194, s[28:31], s63 offen offset:3072
  buffer_load_dwordx4 v[96:99], v195, s[28:31], s63 offen offset:0
  buffer_load_dwordx4 v[100:103], v195, s[28:31], s63 offen offset:1024
  s_waitcnt vmcnt(10)
  s_mul_i32 s17, s58, 32768
  s_add_u32 s17, s17, 0
  v_add_u32 v252, s17, v250
  v_xor_b32 v253, 32, v252
  v_xor_b32 v254, 64, v252
  v_xor_b32 v255, 96, v252
  ds_read_b64_tr_b16 a[128:129], v252 offset:0
  ds_read_b64_tr_b16 a[130:131], v252 offset:512
  ds_read_b64_tr_b16 a[132:133], v253 offset:0
  ds_read_b64_tr_b16 a[134:135], v253 offset:512
  ds_read_b64_tr_b16 a[136:137], v254 offset:0
  ds_read_b64_tr_b16 a[138:139], v254 offset:512
  ds_read_b64_tr_b16 a[140:141], v255 offset:0
  ds_read_b64_tr_b16 a[142:143], v255 offset:512
  ds_read_b64_tr_b16 a[144:145], v252 offset:4096
  ds_read_b64_tr_b16 a[146:147], v252 offset:4608
  ds_read_b64_tr_b16 a[148:149], v253 offset:4096
  ds_read_b64_tr_b16 a[150:151], v253 offset:4608
  ds_read_b64_tr_b16 a[152:153], v254 offset:4096
  ds_read_b64_tr_b16 a[154:155], v254 offset:4608
  ds_read_b64_tr_b16 a[156:157], v255 offset:4096
  ds_read_b64_tr_b16 a[158:159], v255 offset:4608
  ds_read_b64_tr_b16 a[160:161], v252 offset:8192
  ds_read_b64_tr_b16 a[162:163], v252 offset:8704
  ds_read_b64_tr_b16 a[164:165], v253 offset:8192
  ds_read_b64_tr_b16 a[166:167], v253 offset:8704
  ds_read_b64_tr_b16 a[168:169], v254 offset:8192
  ds_read_b64_tr_b16 a[170:171], v254 offset:8704
  ds_read_b64_tr_b16 a[172:173], v255 offset:8192
  ds_read_b64_tr_b16 a[174:175], v255 offset:8704
  ds_read_b64_tr_b16 a[176:177], v252 offset:12288
  ds_read_b64_tr_b16 a[178:179], v252 offset:12800
  ds_read_b64_tr_b16 a[180:181], v253 offset:12288
  ds_read_b64_tr_b16 a[182:183], v253 offset:12800
  ds_read_b64_tr_b16 a[184:185], v254 offset:12288
  ds_read_b64_tr_b16 a[186:187], v254 offset:12800
  ds_read_b64_tr_b16 a[188:189], v255 offset:12288
  ds_read_b64_tr_b16 a[190:191], v255 offset:12800
  ds_read_b64_tr_b16 a[192:193], v252 offset:16384
  ds_read_b64_tr_b16 a[194:195], v252 offset:16896
  ds_read_b64_tr_b16 a[196:197], v253 offset:16384
  ds_read_b64_tr_b16 a[198:199], v253 offset:16896
  ds_read_b64_tr_b16 a[200:201], v254 offset:16384
  ds_read_b64_tr_b16 a[202:203], v254 offset:16896
  ds_read_b64_tr_b16 a[204:205], v255 offset:16384
  ds_read_b64_tr_b16 a[206:207], v255 offset:16896
  ds_read_b64_tr_b16 a[208:209], v252 offset:20480
  ds_read_b64_tr_b16 a[210:211], v252 offset:20992
  ds_read_b64_tr_b16 a[212:213], v253 offset:20480
  ds_read_b64_tr_b16 a[214:215], v253 offset:20992
  ds_read_b64_tr_b16 a[216:217], v254 offset:20480
  ds_read_b64_tr_b16 a[218:219], v254 offset:20992
  ds_read_b64_tr_b16 a[220:221], v255 offset:20480
  ds_read_b64_tr_b16 a[222:223], v255 offset:20992
  s_waitcnt vmcnt(9)
  v_mfma_f32_16x16x32_bf16 v[128:131], v[64:67], a[0:3], v[40:43]
  buffer_load_dwordx4 v[104:107], v195, s[28:31], s63 offen offset:2048
  v_mfma_f32_16x16x32_bf16 v[132:135], v[64:67], a[4:7], 0
  v_mfma_f32_16x16x32_bf16 v[136:139], v[64:67], a[8:11], 0
  buffer_load_dwordx4 v[108:111], v195, s[28:31], s63 offen offset:3072
  v_mfma_f32_16x16x32_bf16 v[140:143], v[64:67], a[12:15], 0
  s_waitcnt vmcnt(10)
  v_mfma_f32_16x16x32_bf16 v[128:131], v[68:71], a[16:19], v[128:131]
  buffer_load_dwordx4 v[112:115], v196, s[28:31], s63 offen offset:0
  v_mfma_f32_16x16x32_bf16 v[132:135], v[68:71], a[20:23], v[132:135]
  v_mfma_f32_16x16x32_bf16 v[136:139], v[68:71], a[24:27], v[136:139]
  buffer_load_dwordx4 v[116:119], v196, s[28:31], s63 offen offset:1024
  v_mfma_f32_16x16x32_bf16 v[140:143], v[68:71], a[28:31], v[140:143]
  s_waitcnt vmcnt(11)
  v_mfma_f32_16x16x32_bf16 v[128:131], v[72:75], a[32:35], v[128:131]
  buffer_load_dwordx4 v[64:67], v192, s[28:31], s64 offen offset:0
  v_mfma_f32_16x16x32_bf16 v[132:135], v[72:75], a[36:39], v[132:135]
  buffer_load_dword v20, v6, s[28:31], s73 offen sc1
  v_mfma_f32_16x16x32_bf16 v[136:139], v[72:75], a[40:43], v[136:139]
  buffer_load_dwordx4 v[68:71], v193, s[28:31], s64 offen offset:1024
  v_mfma_f32_16x16x32_bf16 v[140:143], v[72:75], a[44:47], v[140:143]
  s_waitcnt vmcnt(13)
  v_mfma_f32_16x16x32_bf16 v[128:131], v[76:79], a[48:51], v[128:131]
  buffer_load_dwordx4 v[72:75], v193, s[28:31], s64 offen offset:2048
  v_mfma_f32_16x16x32_bf16 v[132:135], v[76:79], a[52:55], v[132:135]
  v_mfma_f32_16x16x32_bf16 v[136:139], v[76:79], a[56:59], v[136:139]
  v_mfma_f32_16x16x32_bf16 v[140:143], v[76:79], a[60:63], v[140:143]
  s_waitcnt vmcnt(13)
  v_mfma_f32_16x16x32_bf16 v[128:131], v[80:83], a[64:67], v[128:131]
  buffer_load_dwordx4 v[76:79], v193, s[28:31], s64 offen offset:3072
  v_mfma_f32_16x16x32_bf16 v[132:135], v[80:83], a[68:71], v[132:135]
  v_mfma_f32_16x16x32_bf16 v[136:139], v[80:83], a[72:75], v[136:139]
  v_mfma_f32_16x16x32_bf16 v[140:143], v[80:83], a[76:79], v[140:143]
  s_waitcnt vmcnt(13)
  v_mfma_f32_16x16x32_bf16 v[128:131], v[84:87], a[80:83], v[128:131]
  buffer_load_dwordx4 v[80:83], v194, s[28:31], s64 offen offset:0
  v_mfma_f32_16x16x32_bf16 v[132:135], v[84:87], a[84:87], v[132:135]
  v_mfma_f32_16x16x32_bf16 v[136:139], v[84:87], a[88:91], v[136:139]
  v_mfma_f32_16x16x32_bf16 v[140:143], v[84:87], a[92:95], v[140:143]
  s_waitcnt vmcnt(13)
  v_mfma_f32_16x16x32_bf16 v[128:131], v[88:91], a[96:99], v[128:131]
  buffer_load_dwordx4 v[84:87], v194, s[28:31], s64 offen offset:1024
  v_mfma_f32_16x16x32_bf16 v[132:135], v[88:91], a[100:103], v[132:135]
  v_mfma_f32_16x16x32_bf16 v[136:139], v[88:91], a[104:107], v[136:139]
  v_mfma_f32_16x16x32_bf16 v[140:143], v[88:91], a[108:111], v[140:143]
  s_waitcnt vmcnt(13)
  v_mfma_f32_16x16x32_bf16 v[128:131], v[92:95], a[112:115], v[128:131]
  buffer_load_dwordx4 v[88:91], v194, s[28:31], s64 offen offset:2048
  v_mfma_f32_16x16x32_bf16 v[132:135], v[92:95], a[116:119], v[132:135]
  v_mfma_f32_16x16x32_bf16 v[136:139], v[92:95], a[120:123], v[136:139]
  v_mfma_f32_16x16x32_bf16 v[140:143], v[92:95], a[124:127], v[140:143]
  s_waitcnt vmcnt(13) lgkmcnt(15)
  v_mfma_f32_16x16x32_bf16 v[128:131], v[96:99], a[128:131], v[128:131]
  buffer_load_dwordx4 v[92:95], v194, s[28:31], s64 offen offset:3072
  v_mfma_f32_16x16x32_bf16 v[132:135], v[96:99], a[132:135], v[132:135]
  v_mfma_f32_16x16x32_bf16 v[136:139], v[96:99], a[136:139], v[136:139]
  v_mfma_f32_16x16x32_bf16 v[140:143], v[96:99], a[140:143], v[140:143]
  s_waitcnt vmcnt(13)
  v_mfma_f32_16x16x32_bf16 v[128:131], v[100:103], a[144:147], v[128:131]
  buffer_load_dwordx4 v[96:99], v195, s[28:31], s64 offen offset:0
  v_mfma_f32_16x16x32_bf16 v[132:135], v[100:103], a[148:151], v[132:135]
  v_mfma_f32_16x16x32_bf16 v[136:139], v[100:103], a[152:155], v[136:139]
  v_mfma_f32_16x16x32_bf16 v[140:143], v[100:103], a[156:159], v[140:143]
  s_waitcnt vmcnt(13)
  v_mfma_f32_16x16x32_bf16 v[128:131], v[104:107], a[160:163], v[128:131]
  buffer_load_dwordx4 v[100:103], v195, s[28:31], s64 offen offset:1024
  v_mfma_f32_16x16x32_bf16 v[132:135], v[104:107], a[164:167], v[132:135]
  v_mfma_f32_16x16x32_bf16 v[136:139], v[104:107], a[168:171], v[136:139]
  v_mfma_f32_16x16x32_bf16 v[140:143], v[104:107], a[172:175], v[140:143]
  s_waitcnt vmcnt(13)
  v_mfma_f32_16x16x32_bf16 v[128:131], v[108:111], a[176:179], v[128:131]
  buffer_load_dwordx4 v[104:107], v195, s[28:31], s64 offen offset:2048
  v_mfma_f32_16x16x32_bf16 v[132:135], v[108:111], a[180:183], v[132:135]
  v_mfma_f32_16x16x32_bf16 v[136:139], v[108:111], a[184:187], v[136:139]
  v_mfma_f32_16x16x32_bf16 v[140:143], v[108:111], a[188:191], v[140:143]
  s_waitcnt vmcnt(13) lgkmcnt(14)
  v_mfma_f32_16x16x32_bf16 v[128:131], v[112:115], a[192:195], v[128:131]
  buffer_load_dwordx4 v[108:111], v195, s[28:31], s64 offen offset:3072
  s_waitcnt lgkmcnt(12)
  v_mfma_f32_16x16x32_bf16 v[132:135], v[112:115], a[196:199], v[132:135]
  s_waitcnt lgkmcnt(10)
  v_mfma_f32_16x16x32_bf16 v[136:139], v[112:115], a[200:203], v[136:139]
  s_waitcnt lgkmcnt(8)
  v_mfma_f32_16x16x32_bf16 v[140:143], v[112:115], a[204:207], v[140:143]
  s_waitcnt vmcnt(13) lgkmcnt(6)
  v_mfma_f32_16x16x32_bf16 v[128:131], v[116:119], a[208:211], v[128:131]
  buffer_load_dwordx4 v[112:115], v196, s[28:31], s64 offen offset:0
  s_waitcnt lgkmcnt(4)
  v_mfma_f32_16x16x32_bf16 v[132:135], v[116:119], a[212:215], v[132:135]
  s_waitcnt lgkmcnt(2)
  v_mfma_f32_16x16x32_bf16 v[136:139], v[116:119], a[216:219], v[136:139]
  s_waitcnt lgkmcnt(0)
  v_mfma_f32_16x16x32_bf16 v[140:143], v[116:119], a[220:223], v[140:143]
  s_waitcnt vmcnt(13)
  v_mfma_f32_16x16x32_bf16 v[144:147], v[64:67], a[0:3], v[44:47]
  buffer_load_dwordx4 v[116:119], v196, s[28:31], s64 offen offset:1024
  v_mfma_f32_16x16x32_bf16 v[148:151], v[64:67], a[4:7], 0
  ds_write_b128 v2, v[132:135] offset:0
  v_mfma_f32_16x16x32_bf16 v[152:155], v[64:67], a[8:11], 0
  v_mfma_f32_16x16x32_bf16 v[156:159], v[64:67], a[12:15], 0
  s_waitcnt vmcnt(13)
  v_cmp_ne_u32 vcc, s59, v20
  s_cbranch_vccz Ld20
Lp19:
  buffer_load_dword v20, v6, s[28:31], s73 offen sc1
  s_waitcnt vmcnt(0) lgkmcnt(0)
  v_cmp_ne_u32 vcc, s59, v20
  s_cbranch_vccz Ld20
  s_sub_u32 s61, s61, 1
  s_cbranch_scc0 Lp19
  s_branch Lexit
Ld20:
  s_waitcnt vmcnt(12)
  v_mfma_f32_16x16x32_bf16 v[144:147], v[68:71], a[16:19], v[144:147]
  buffer_load_dwordx4 v[64:67], v192, s[28:31], s65 offen offset:0
  v_mfma_f32_16x16x32_bf16 v[148:151], v[68:71], a[20:23], v[148:151]
  ds_write_b128 v2, v[136:139] offset:4096
  v_mfma_f32_16x16x32_bf16 v[152:155], v[68:71], a[24:27], v[152:155]
  v_mfma_f32_16x16x32_bf16 v[156:159], v[68:71], a[28:31], v[156:159]
  s_waitcnt vmcnt(12)
  v_mfma_f32_16x16x32_bf16 v[144:147], v[72:75], a[32:35], v[144:147]
  buffer_load_dwordx4 v[68:71], v193, s[28:31], s65 offen offset:1024
  v_mfma_f32_16x16x32_bf16 v[148:151], v[72:75], a[36:39], v[148:151]
  ds_write_b128 v2, v[140:143] offset:8192
  v_mfma_f32_16x16x32_bf16 v[152:155], v[72:75], a[40:43], v[152:155]
  v_mfma_f32_16x16x32_bf16 v[156:159], v[72:75], a[44:47], v[156:159]
  s_waitcnt vmcnt(12)
  v_mfma_f32_16x16x32_bf16 v[144:147], v[76:79], a[48:51], v[144:147]
  buffer_load_dwordx4 v[72:75], v193, s[28:31], s65 offen offset:2048
  v_mfma_f32_16x16x32_bf16 v[148:151], v[76:79], a[52:55], v[148:151]
  v_mfma_f32_16x16x32_bf16 v[152:155], v[76:79], a[56:59], v[152:155]
  v_mfma_f32_16x16x32_bf16 v[156:159], v[76:79], a[60:63], v[156:159]
  s_waitcnt lgkmcnt(0)
  s_barrier
  s_waitcnt vmcnt(12)
  v_mfma_f32_16x16x32_bf16 v[144:147], v[80:83], a[64:67], v[144:147]
  buffer_load_dwordx4 v[76:79], v193, s[28:31], s65 offen offset:3072
  v_mfma_f32_16x16x32_bf16 v[148:151], v[80:83], a[68:71], v[148:151]
  ds_read_b128 v[160:163], v3 offset:0
  v_mfma_f32_16x16x32_bf16 v[152:155], v[80:83], a[72:75], v[152:155]
  ds_read_b128 v[164:167], v4 offset:4096
  v_mfma_f32_16x16x32_bf16 v[156:159], v[80:83], a[76:79], v[156:159]
  ds_read_b128 v[168:171], v5 offset:8192
  s_waitcnt vmcnt(12)
  v_mfma_f32_16x16x32_bf16 v[144:147], v[84:87], a[80:83], v[144:147]
  buffer_load_dwordx4 v[80:83], v194, s[28:31], s65 offen offset:0
  v_mfma_f32_16x16x32_bf16 v[148:151], v[84:87], a[84:87], v[148:151]
  v_mfma_f32_16x16x32_bf16 v[152:155], v[84:87], a[88:91], v[152:155]
  v_mfma_f32_16x16x32_bf16 v[156:159], v[84:87], a[92:95], v[156:159]
  s_waitcnt vmcnt(12)
  v_mfma_f32_16x16x32_bf16 v[144:147], v[88:91], a[96:99], v[144:147]
  buffer_load_dwordx4 v[84:87], v194, s[28:31], s65 offen offset:1024
  v_mfma_f32_16x16x32_bf16 v[148:151], v[88:91], a[100:103], v[148:151]
  s_waitcnt lgkmcnt(1)
  v_add_f32 v160, v160, v164
  v_mfma_f32_16x16x32_bf16 v[152:155], v[88:91], a[104:107], v[152:155]
  v_add_f32 v161, v161, v165
  v_mfma_f32_16x16x32_bf16 v[156:159], v[88:91], a[108:111], v[156:159]
  s_waitcnt vmcnt(12)
  v_mfma_f32_16x16x32_bf16 v[144:147], v[92:95], a[112:115], v[144:147]
  buffer_load_dwordx4 v[88:91], v194, s[28:31], s65 offen offset:2048
  v_mfma_f32_16x16x32_bf16 v[148:151], v[92:95], a[116:119], v[148:151]
  v_add_f32 v162, v162, v166
  v_mfma_f32_16x16x32_bf16 v[152:155], v[92:95], a[120:123], v[152:155]
  v_add_f32 v163, v163, v167
  v_mfma_f32_16x16x32_bf16 v[156:159], v[92:95], a[124:127], v[156:159]
  s_waitcnt vmcnt(12)
  v_mfma_f32_16x16x32_bf16 v[144:147], v[96:99], a[128:131], v[144:147]
  buffer_load_dwordx4 v[92:95], v194, s[28:31], s65 offen offset:3072
  v_mfma_f32_16x16x32_bf16 v[148:151], v[96:99], a[132:135], v[148:151]
  s_waitcnt lgkmcnt(0)
  v_add_f32 v128, v128, v168
  v_mfma_f32_16x16x32_bf16 v[152:155], v[96:99], a[136:139], v[152:155]
  v_add_f32 v129, v129, v169
  v_mfma_f32_16x16x32_bf16 v[156:159], v[96:99], a[140:143], v[156:159]
  s_waitcnt vmcnt(12)
  v_mfma_f32_16x16x32_bf16 v[144:147], v[100:103], a[144:147], v[144:147]
  buffer_load_dwordx4 v[96:99], v195, s[28:31], s65 offen offset:0
  v_mfma_f32_16x16x32_bf16 v[148:151], v[100:103], a[148:151], v[148:151]
  v_add_f32 v130, v130, v170
  v_mfma_f32_16x16x32_bf16 v[152:155], v[100:103], a[152:155], v[152:155]
  v_add_f32 v131, v131, v171
  v_mfma_f32_16x16x32_bf16 v[156:159], v[100:103], a[156:159], v[156:159]
  s_waitcnt vmcnt(12)
  v_mfma_f32_16x16x32_bf16 v[144:147], v[104:107], a[160:163], v[144:147]
  buffer_load_dwordx4 v[100:103], v195, s[28:31], s65 offen offset:1024
  v_mfma_f32_16x16x32_bf16 v[148:151], v[104:107], a[164:167], v[148:151]
  v_add_f32 v128, v128, v160
  v_mfma_f32_16x16x32_bf16 v[152:155], v[104:107], a[168:171], v[152:155]
  v_add_f32 v129, v129, v161
  v_mfma_f32_16x16x32_bf16 v[156:159], v[104:107], a[172:175], v[156:159]
  s_waitcnt vmcnt(12)
  v_mfma_f32_16x16x32_bf16 v[144:147], v[108:111], a[176:179], v[144:147]
  buffer_load_dwordx4 v[104:107], v195, s[28:31], s65 offen offset:2048
  v_mfma_f32_16x16x32_bf16 v[148:151], v[108:111], a[180:183], v[148:151]
  v_add_f32 v130, v130, v162
  v_mfma_f32_16x16x32_bf16 v[152:155], v[108:111], a[184:187], v[152:155]
  v_add_f32 v131, v131, v163
  v_mfma_f32_16x16x32_bf16 v[156:159], v[108:111], a[188:191], v[156:159]
  s_waitcnt vmcnt(12)
  v_mfma_f32_16x16x32_bf16 v[144:147], v[112:115], a[192:195], v[144:147]
  buffer_load_dwordx4 v[108:111], v195, s[28:31], s65 offen offset:3072
  v_mfma_f32_16x16x32_bf16 v[148:151], v[112:115], a[196:199], v[148:151]
  v_cvt_pk_bf16_f32 v172, v128, v129
  v_mfma_f32_16x16x32_bf16 v[152:155], v[112:115], a[200:203], v[152:155]
  v_mfma_f32_16x16x32_bf16 v[156:159], v[112:115], a[204:207], v[156:159]
  s_waitcnt vmcnt(12)
  v_mfma_f32_16x16x32_bf16 v[144:147], v[116:119], a[208:211], v[144:147]
  buffer_load_dwordx4 v[112:115], v196, s[28:31], s65 offen offset:0
  v_mfma_f32_16x16x32_bf16 v[148:151], v[116:119], a[212:215], v[148:151]
  v_cvt_pk_bf16_f32 v173, v130, v131
  v_mfma_f32_16x16x32_bf16 v[152:155], v[116:119], a[216:219], v[152:155]
  v_mfma_f32_16x16x32_bf16 v[156:159], v[116:119], a[220:223], v[156:159]
  s_waitcnt vmcnt(12)
  v_mfma_f32_16x16x32_bf16 v[128:131], v[64:67], a[0:3], v[48:51]
  buffer_load_dwordx4 v[116:119], v196, s[28:31], s65 offen offset:1024
  v_mfma_f32_16x16x32_bf16 v[132:135], v[64:67], a[4:7], 0
  s_nop 0
  ds_write_b128 v2, v[148:151] offset:12288
  v_mfma_f32_16x16x32_bf16 v[136:139], v[64:67], a[8:11], 0
  v_mfma_f32_16x16x32_bf16 v[140:143], v[64:67], a[12:15], 0
  s_waitcnt vmcnt(12)
  v_mfma_f32_16x16x32_bf16 v[128:131], v[68:71], a[16:19], v[128:131]
  buffer_load_dwordx4 v[64:67], v192, s[28:31], s66 offen offset:0
  v_mfma_f32_16x16x32_bf16 v[132:135], v[68:71], a[20:23], v[132:135]
  ds_write_b128 v2, v[152:155] offset:16384
  v_mfma_f32_16x16x32_bf16 v[136:139], v[68:71], a[24:27], v[136:139]
  v_mfma_f32_16x16x32_bf16 v[140:143], v[68:71], a[28:31], v[140:143]
  s_waitcnt vmcnt(12)
  v_mfma_f32_16x16x32_bf16 v[128:131], v[72:75], a[32:35], v[128:131]
  buffer_load_dwordx4 v[68:71], v193, s[28:31], s66 offen offset:1024
  v_mfma_f32_16x16x32_bf16 v[132:135], v[72:75], a[36:39], v[132:135]
  ds_write_b128 v2, v[156:159] offset:20480
  v_mfma_f32_16x16x32_bf16 v[136:139], v[72:75], a[40:43], v[136:139]
  v_mfma_f32_16x16x32_bf16 v[140:143], v[72:75], a[44:47], v[140:143]
  s_waitcnt vmcnt(12)
  v_mfma_f32_16x16x32_bf16 v[128:131], v[76:79], a[48:51], v[128:131]
  buffer_load_dwordx4 v[72:75], v193, s[28:31], s66 offen offset:2048
  v_mfma_f32_16x16x32_bf16 v[132:135], v[76:79], a[52:55], v[132:135]
  v_mfma_f32_16x16x32_bf16 v[136:139], v[76:79], a[56:59], v[136:139]
  v_mfma_f32_16x16x32_bf16 v[140:143], v[76:79], a[60:63], v[140:143]
  s_waitcnt lgkmcnt(0)
  s_barrier
  s_waitcnt vmcnt(12)
  v_mfma_f32_16x16x32_bf16 v[128:131], v[80:83], a[64:67], v[128:131]
  buffer_load_dwordx4 v[76:79], v193, s[28:31], s66 offen offset:3072
  v_mfma_f32_16x16x32_bf16 v[132:135], v[80:83], a[68:71], v[132:135]
  ds_read_b128 v[160:163], v3 offset:12288
  v_mfma_f32_16x16x32_bf16 v[136:139], v[80:83], a[72:75], v[136:139]
  ds_read_b128 v[164:167], v4 offset:16384
  v_mfma_f32_16x16x32_bf16 v[140:143], v[80:83], a[76:79], v[140:143]
  ds_read_b128 v[168:171], v5 offset:20480
  s_waitcnt vmcnt(12)
  v_mfma_f32_16x16x32_bf16 v[128:131], v[84:87], a[80:83], v[128:131]
  buffer_load_dwordx4 v[80:83], v194, s[28:31], s66 offen offset:0
  v_mfma_f32_16x16x32_bf16 v[132:135], v[84:87], a[84:87], v[132:135]
  v_mfma_f32_16x16x32_bf16 v[136:139], v[84:87], a[88:91], v[136:139]
  v_mfma_f32_16x16x32_bf16 v[140:143], v[84:87], a[92:95], v[140:143]
  s_waitcnt vmcnt(12)
  v_mfma_f32_16x16x32_bf16 v[128:131], v[88:91], a[96:99], v[128:131]
  buffer_load_dwordx4 v[84:87], v194, s[28:31], s66 offen offset:1024
  v_mfma_f32_16x16x32_bf16 v[132:135], v[88:91], a[100:103], v[132:135]
  s_waitcnt lgkmcnt(1)
  v_add_f32 v160, v160, v164
  v_mfma_f32_16x16x32_bf16 v[136:139], v[88:91], a[104:107], v[136:139]
  v_add_f32 v161, v161, v165
  v_mfma_f32_16x16x32_bf16 v[140:143], v[88:91], a[108:111], v[140:143]
  s_waitcnt vmcnt(12)
  v_mfma_f32_16x16x32_bf16 v[128:131], v[92:95], a[112:115], v[128:131]
  buffer_load_dwordx4 v[88:91], v194, s[28:31], s66 offen offset:2048
  v_mfma_f32_16x16x32_bf16 v[132:135], v[92:95], a[116:119], v[132:135]
  v_add_f32 v162, v162, v166
  v_mfma_f32_16x16x32_bf16 v[136:139], v[92:95], a[120:123], v[136:139]
  v_add_f32 v163, v163, v167
  v_mfma_f32_16x16x32_bf16 v[140:143], v[92:95], a[124:127], v[140:143]
  s_waitcnt vmcnt(12)
  v_mfma_f32_16x16x32_bf16 v[128:131], v[96:99], a[128:131], v[128:131]
  buffer_load_dwordx4 v[92:95], v194, s[28:31], s66 offen offset:3072
  v_mfma_f32_16x16x32_bf16 v[132:135], v[96:99], a[132:135], v[132:135]
  s_waitcnt lgkmcnt(0)
  v_add_f32 v144, v144, v168
  v_mfma_f32_16x16x32_bf16 v[136:139], v[96:99], a[136:139], v[136:139]
  v_add_f32 v145, v145, v169
  v_mfma_f32_16x16x32_bf16 v[140:143], v[96:99], a[140:143], v[140:143]
  s_waitcnt vmcnt(12)
  v_mfma_f32_16x16x32_bf16 v[128:131], v[100:103], a[144:147], v[128:131]
  buffer_load_dwordx4 v[96:99], v195, s[28:31], s66 offen offset:0
  v_mfma_f32_16x16x32_bf16 v[132:135], v[100:103], a[148:151], v[132:135]
  v_add_f32 v146, v146, v170
  v_mfma_f32_16x16x32_bf16 v[136:139], v[100:103], a[152:155], v[136:139]
  v_add_f32 v147, v147, v171
  v_mfma_f32_16x16x32_bf16 v[140:143], v[100:103], a[156:159], v[140:143]
  s_waitcnt vmcnt(12)
  v_mfma_f32_16x16x32_bf16 v[128:131], v[104:107], a[160:163], v[128:131]
  buffer_load_dwordx4 v[100:103], v195, s[28:31], s66 offen offset:1024
  v_mfma_f32_16x16x32_bf16 v[132:135], v[104:107], a[164:167], v[132:135]
  v_add_f32 v144, v144, v160
  v_mfma_f32_16x16x32_bf16 v[136:139], v[104:107], a[168:171], v[136:139]
  v_add_f32 v145, v145, v161
  v_mfma_f32_16x16x32_bf16 v[140:143], v[104:107], a[172:175], v[140:143]
  s_waitcnt vmcnt(12)
  v_mfma_f32_16x16x32_bf16 v[128:131], v[108:111], a[176:179], v[128:131]
  buffer_load_dwordx4 v[104:107], v195, s[28:31], s66 offen offset:2048
  v_mfma_f32_16x16x32_bf16 v[132:135], v[108:111], a[180:183], v[132:135]
  v_add_f32 v146, v146, v162
  v_mfma_f32_16x16x32_bf16 v[136:139], v[108:111], a[184:187], v[136:139]
  v_add_f32 v147, v147, v163
  v_mfma_f32_16x16x32_bf16 v[140:143], v[108:111], a[188:191], v[140:143]
  s_waitcnt vmcnt(12)
  v_mfma_f32_16x16x32_bf16 v[128:131], v[112:115], a[192:195], v[128:131]
  buffer_load_dwordx4 v[108:111], v195, s[28:31], s66 offen offset:3072
  v_mfma_f32_16x16x32_bf16 v[132:135], v[112:115], a[196:199], v[132:135]
  v_cvt_pk_bf16_f32 v174, v144, v145
  v_mfma_f32_16x16x32_bf16 v[136:139], v[112:115], a[200:203], v[136:139]
  v_cvt_pk_bf16_f32 v175, v146, v147
  v_mfma_f32_16x16x32_bf16 v[140:143], v[112:115], a[204:207], v[140:143]
  s_waitcnt vmcnt(12)
  v_mfma_f32_16x16x32_bf16 v[128:131], v[116:119], a[208:211], v[128:131]
  buffer_load_dwordx4 v[112:115], v196, s[28:31], s66 offen offset:0
  v_mfma_f32_16x16x32_bf16 v[132:135], v[116:119], a[212:215], v[132:135]
  v_permlane16_swap_b32 v172, v174
  v_mfma_f32_16x16x32_bf16 v[136:139], v[116:119], a[216:219], v[136:139]
  v_permlane16_swap_b32 v173, v175
  v_mfma_f32_16x16x32_bf16 v[140:143], v[116:119], a[220:223], v[140:143]
  s_waitcnt vmcnt(12)
  v_mfma_f32_16x16x32_bf16 v[144:147], v[64:67], a[0:3], v[52:55]
  buffer_load_dwordx4 v[116:119], v196, s[28:31], s66 offen offset:1024
  v_mfma_f32_16x16x32_bf16 v[148:151], v[64:67], a[4:7], 0
  ds_write_b128 v2, v[132:135] offset:0
  v_mfma_f32_16x16x32_bf16 v[152:155], v[64:67], a[8:11], 0
  v_mfma_f32_16x16x32_bf16 v[156:159], v[64:67], a[12:15], 0
  s_waitcnt vmcnt(12)
  v_mfma_f32_16x16x32_bf16 v[144:147], v[68:71], a[16:19], v[144:147]
  buffer_load_dwordx4 v[64:67], v192, s[28:31], s67 offen offset:0
  v_mfma_f32_16x16x32_bf16 v[148:151], v[68:71], a[20:23], v[148:151]
  ds_write_b128 v2, v[136:139] offset:4096
  v_mfma_f32_16x16x32_bf16 v[152:155], v[68:71], a[24:27], v[152:155]
  v_mfma_f32_16x16x32_bf16 v[156:159], v[68:71], a[28:31], v[156:159]
  s_waitcnt vmcnt(12)
  v_mfma_f32_16x16x32_bf16 v[144:147], v[72:75], a[32:35], v[144:147]
  buffer_load_dwordx4 v[68:71], v193, s[28:31], s67 offen offset:1024
  v_mfma_f32_16x16x32_bf16 v[148:151], v[72:75], a[36:39], v[148:151]
  ds_write_b128 v2, v[140:143] offset:8192
  v_mfma_f32_16x16x32_bf16 v[152:155], v[72:75], a[40:43], v[152:155]
  v_mfma_f32_16x16x32_bf16 v[156:159], v[72:75], a[44:47], v[156:159]
  s_waitcnt vmcnt(12)
  v_mfma_f32_16x16x32_bf16 v[144:147], v[76:79], a[48:51], v[144:147]
  buffer_load_dwordx4 v[72:75], v193, s[28:31], s67 offen offset:2048
  v_mfma_f32_16x16x32_bf16 v[148:151], v[76:79], a[52:55], v[148:151]
  v_mfma_f32_16x16x32_bf16 v[152:155], v[76:79], a[56:59], v[152:155]
  v_mfma_f32_16x16x32_bf16 v[156:159], v[76:79], a[60:63], v[156:159]
  s_waitcnt lgkmcnt(0)
  s_barrier
  s_waitcnt vmcnt(12)
  v_mfma_f32_16x16x32_bf16 v[144:147], v[80:83], a[64:67], v[144:147]
  buffer_load_dwordx4 v[76:79], v193, s[28:31], s67 offen offset:3072
  v_mfma_f32_16x16x32_bf16 v[148:151], v[80:83], a[68:71], v[148:151]
  ds_read_b128 v[160:163], v3 offset:0
  v_mfma_f32_16x16x32_bf16 v[152:155], v[80:83], a[72:75], v[152:155]
  ds_read_b128 v[164:167], v4 offset:4096
  v_mfma_f32_16x16x32_bf16 v[156:159], v[80:83], a[76:79], v[156:159]
  ds_read_b128 v[168:171], v5 offset:8192
  s_waitcnt vmcnt(12)
  v_mfma_f32_16x16x32_bf16 v[144:147], v[84:87], a[80:83], v[144:147]
  buffer_load_dwordx4 v[80:83], v194, s[28:31], s67 offen offset:0
  v_mfma_f32_16x16x32_bf16 v[148:151], v[84:87], a[84:87], v[148:151]
  v_mfma_f32_16x16x32_bf16 v[152:155], v[84:87], a[88:91], v[152:155]
  v_mfma_f32_16x16x32_bf16 v[156:159], v[84:87], a[92:95], v[156:159]
  s_waitcnt vmcnt(12)
  v_mfma_f32_16x16x32_bf16 v[144:147], v[88:91], a[96:99], v[144:147]
  buffer_load_dwordx4 v[84:87], v194, s[28:31], s67 offen offset:1024
  v_mfma_f32_16x16x32_bf16 v[148:151], v[88:91], a[100:103], v[148:151]
  s_waitcnt lgkmcnt(1)
  v_add_f32 v160, v160, v164
  v_mfma_f32_16x16x32_bf16 v[152:155], v[88:91], a[104:107], v[152:155]
  v_add_f32 v161, v161, v165
  v_mfma_f32_16x16x32_bf16 v[156:159], v[88:91], a[108:111], v[156:159]
  s_waitcnt vmcnt(12)
  v_mfma_f32_16x16x32_bf16 v[144:147], v[92:95], a[112:115], v[144:147]
  buffer_load_dwordx4 v[88:91], v194, s[28:31], s67 offen offset:2048
  v_mfma_f32_16x16x32_bf16 v[148:151], v[92:95], a[116:119], v[148:151]
  v_add_f32 v162, v162, v166
  v_mfma_f32_16x16x32_bf16 v[152:155], v[92:95], a[120:123], v[152:155]
  v_add_f32 v163, v163, v167
  v_mfma_f32_16x16x32_bf16 v[156:159], v[92:95], a[124:127], v[156:159]
  s_waitcnt vmcnt(12)
  v_mfma_f32_16x16x32_bf16 v[144:147], v[96:99], a[128:131], v[144:147]
  buffer_load_dwordx4 v[92:95], v194, s[28:31], s67 offen offset:3072
  v_mfma_f32_16x16x32_bf16 v[148:151], v[96:99], a[132:135], v[148:151]
  s_waitcnt lgkmcnt(0)
  v_add_f32 v128, v128, v168
  v_mfma_f32_16x16x32_bf16 v[152:155], v[96:99], a[136:139], v[152:155]
  v_add_f32 v129, v129, v169
  v_mfma_f32_16x16x32_bf16 v[156:159], v[96:99], a[140:143], v[156:159]
  s_waitcnt vmcnt(12)
  v_mfma_f32_16x16x32_bf16 v[144:147], v[100:103], a[144:147], v[144:147]
  buffer_load_dwordx4 v[96:99], v195, s[28:31], s67 offen offset:0
  v_mfma_f32_16x16x32_bf16 v[148:151], v[100:103], a[148:151], v[148:151]
  v_add_f32 v130, v130, v170
  v_mfma_f32_16x16x32_bf16 v[152:155], v[100:103], a[152:155], v[152:155]
  v_add_f32 v131, v131, v171
  v_mfma_f32_16x16x32_bf16 v[156:159], v[100:103], a[156:159], v[156:159]
  s_waitcnt vmcnt(12)
  v_mfma_f32_16x16x32_bf16 v[144:147], v[104:107], a[160:163], v[144:147]
  buffer_load_dwordx4 v[100:103], v195, s[28:31], s67 offen offset:1024
  v_mfma_f32_16x16x32_bf16 v[148:151], v[104:107], a[164:167], v[148:151]
  v_add_f32 v128, v128, v160
  v_mfma_f32_16x16x32_bf16 v[152:155], v[104:107], a[168:171], v[152:155]
  v_add_f32 v129, v129, v161
  v_mfma_f32_16x16x32_bf16 v[156:159], v[104:107], a[172:175], v[156:159]
  s_waitcnt vmcnt(12)
  v_mfma_f32_16x16x32_bf16 v[144:147], v[108:111], a[176:179], v[144:147]
  buffer_load_dwordx4 v[104:107], v195, s[28:31], s67 offen offset:2048
  v_mfma_f32_16x16x32_bf16 v[148:151], v[108:111], a[180:183], v[148:151]
  v_add_f32 v130, v130, v162
  v_mfma_f32_16x16x32_bf16 v[152:155], v[108:111], a[184:187], v[152:155]
  v_add_f32 v131, v131, v163
  v_mfma_f32_16x16x32_bf16 v[156:159], v[108:111], a[188:191], v[156:159]
  s_waitcnt vmcnt(12)
  v_mfma_f32_16x16x32_bf16 v[144:147], v[112:115], a[192:195], v[144:147]
  buffer_load_dwordx4 v[108:111], v195, s[28:31], s67 offen offset:3072
  v_mfma_f32_16x16x32_bf16 v[148:151], v[112:115], a[196:199], v[148:151]
  v_cvt_pk_bf16_f32 v176, v128, v129
  v_mfma_f32_16x16x32_bf16 v[152:155], v[112:115], a[200:203], v[152:155]
  v_mfma_f32_16x16x32_bf16 v[156:159], v[112:115], a[204:207], v[156:159]
  s_waitcnt vmcnt(12)
  v_mfma_f32_16x16x32_bf16 v[144:147], v[116:119], a[208:211], v[144:147]
  buffer_load_dwordx4 v[112:115], v196, s[28:31], s67 offen offset:0
  v_mfma_f32_16x16x32_bf16 v[148:151], v[116:119], a[212:215], v[148:151]
  v_cvt_pk_bf16_f32 v177, v130, v131
  v_mfma_f32_16x16x32_bf16 v[152:155], v[116:119], a[216:219], v[152:155]
  v_mfma_f32_16x16x32_bf16 v[156:159], v[116:119], a[220:223], v[156:159]
  s_waitcnt vmcnt(12)
  v_mfma_f32_16x16x32_bf16 v[128:131], v[64:67], a[0:3], v[56:59]
  buffer_load_dwordx4 v[116:119], v196, s[28:31], s67 offen offset:1024
  v_mfma_f32_16x16x32_bf16 v[132:135], v[64:67], a[4:7], 0
  s_nop 0
  ds_write_b128 v2, v[148:151] offset:12288
  v_mfma_f32_16x16x32_bf16 v[136:139], v[64:67], a[8:11], 0
  v_mfma_f32_16x16x32_bf16 v[140:143], v[64:67], a[12:15], 0
  s_waitcnt vmcnt(12)
  v_mfma_f32_16x16x32_bf16 v[128:131], v[68:71], a[16:19], v[128:131]
  buffer_store_dwordx4 v[172:175], v11, s[52:55], 0 offen offset:0 sc1
  v_mfma_f32_16x16x32_bf16 v[132:135], v[68:71], a[20:23], v[132:135]
  ds_write_b128 v2, v[152:155] offset:16384
  v_mfma_f32_16x16x32_bf16 v[136:139], v[68:71], a[24:27], v[136:139]
  v_mfma_f32_16x16x32_bf16 v[140:143], v[68:71], a[28:31], v[140:143]
  s_waitcnt vmcnt(12)
  v_mfma_f32_16x16x32_bf16 v[128:131], v[72:75], a[32:35], v[128:131]
  v_mfma_f32_16x16x32_bf16 v[132:135], v[72:75], a[36:39], v[132:135]
  ds_write_b128 v2, v[156:159] offset:20480
  v_mfma_f32_16x16x32_bf16 v[136:139], v[72:75], a[40:43], v[136:139]
  v_mfma_f32_16x16x32_bf16 v[140:143], v[72:75], a[44:47], v[140:143]
  s_waitcnt vmcnt(11)
  v_mfma_f32_16x16x32_bf16 v[128:131], v[76:79], a[48:51], v[128:131]
  v_mfma_f32_16x16x32_bf16 v[132:135], v[76:79], a[52:55], v[132:135]
  v_mfma_f32_16x16x32_bf16 v[136:139], v[76:79], a[56:59], v[136:139]
  v_mfma_f32_16x16x32_bf16 v[140:143], v[76:79], a[60:63], v[140:143]
  s_waitcnt lgkmcnt(0)
  s_barrier
  s_waitcnt vmcnt(10)
  v_mfma_f32_16x16x32_bf16 v[128:131], v[80:83], a[64:67], v[128:131]
  v_mfma_f32_16x16x32_bf16 v[132:135], v[80:83], a[68:71], v[132:135]
  ds_read_b128 v[160:163], v3 offset:12288
  v_mfma_f32_16x16x32_bf16 v[136:139], v[80:83], a[72:75], v[136:139]
  ds_read_b128 v[164:167], v4 offset:16384
  v_mfma_f32_16x16x32_bf16 v[140:143], v[80:83], a[76:79], v[140:143]
  ds_read_b128 v[168:171], v5 offset:20480
  s_waitcnt vmcnt(9)
  v_mfma_f32_16x16x32_bf16 v[128:131], v[84:87], a[80:83], v[128:131]
  v_mfma_f32_16x16x32_bf16 v[132:135], v[84:87], a[84:87], v[132:135]
  v_mfma_f32_16x16x32_bf16 v[136:139], v[84:87], a[88:91], v[136:139]
  v_mfma_f32_16x16x32_bf16 v[140:143], v[84:87], a[92:95], v[140:143]
  s_waitcnt vmcnt(8)
  v_mfma_f32_16x16x32_bf16 v[128:131], v[88:91], a[96:99], v[128:131]
  v_mfma_f32_16x16x32_bf16 v[132:135], v[88:91], a[100:103], v[132:135]
  s_waitcnt lgkmcnt(1)
  v_add_f32 v160, v160, v164
  v_add_f32 v161, v161, v165
  v_mfma_f32_16x16x32_bf16 v[136:139], v[88:91], a[104:107], v[136:139]
  v_add_f32 v162, v162, v166
  v_mfma_f32_16x16x32_bf16 v[140:143], v[88:91], a[108:111], v[140:143]
  s_waitcnt vmcnt(7)
  v_mfma_f32_16x16x32_bf16 v[128:131], v[92:95], a[112:115], v[128:131]
  v_mfma_f32_16x16x32_bf16 v[132:135], v[92:95], a[116:119], v[132:135]
  v_add_f32 v163, v163, v167
  v_mfma_f32_16x16x32_bf16 v[136:139], v[92:95], a[120:123], v[136:139]
  s_waitcnt lgkmcnt(0)
  v_add_f32 v144, v144, v168
  v_mfma_f32_16x16x32_bf16 v[140:143], v[92:95], a[124:127], v[140:143]
  s_waitcnt vmcnt(6)
  v_mfma_f32_16x16x32_bf16 v[128:131], v[96:99], a[128:131], v[128:131]
  v_mfma_f32_16x16x32_bf16 v[132:135], v[96:99], a[132:135], v[132:135]
  v_add_f32 v145, v145, v169
  v_mfma_f32_16x16x32_bf16 v[136:139], v[96:99], a[136:139], v[136:139]
  v_add_f32 v146, v146, v170
  v_mfma_f32_16x16x32_bf16 v[140:143], v[96:99], a[140:143], v[140:143]
  s_waitcnt vmcnt(5)
  v_mfma_f32_16x16x32_bf16 v[128:131], v[100:103], a[144:147], v[128:131]
  v_mfma_f32_16x16x32_bf16 v[132:135], v[100:103], a[148:151], v[132:135]
  v_add_f32 v147, v147, v171
  v_mfma_f32_16x16x32_bf16 v[136:139], v[100:103], a[152:155], v[136:139]
  v_add_f32 v144, v144, v160
  v_mfma_f32_16x16x32_bf16 v[140:143], v[100:103], a[156:159], v[140:143]
  s_waitcnt vmcnt(4)
  v_mfma_f32_16x16x32_bf16 v[128:131], v[104:107], a[160:163], v[128:131]
  v_mfma_f32_16x16x32_bf16 v[132:135], v[104:107], a[164:167], v[132:135]
  v_add_f32 v145, v145, v161
  v_mfma_f32_16x16x32_bf16 v[136:139], v[104:107], a[168:171], v[136:139]
  v_add_f32 v146, v146, v162
  v_mfma_f32_16x16x32_bf16 v[140:143], v[104:107], a[172:175], v[140:143]
  s_waitcnt vmcnt(3)
  v_mfma_f32_16x16x32_bf16 v[128:131], v[108:111], a[176:179], v[128:131]
  v_mfma_f32_16x16x32_bf16 v[132:135], v[108:111], a[180:183], v[132:135]
  v_add_f32 v147, v147, v163
  v_mfma_f32_16x16x32_bf16 v[136:139], v[108:111], a[184:187], v[136:139]
  v_cvt_pk_bf16_f32 v178, v144, v145
  v_mfma_f32_16x16x32_bf16 v[140:143], v[108:111], a[188:191], v[140:143]
  s_waitcnt vmcnt(2)
  v_mfma_f32_16x16x32_bf16 v[128:131], v[112:115], a[192:195], v[128:131]
  v_mfma_f32_16x16x32_bf16 v[132:135], v[112:115], a[196:199], v[132:135]
  v_cvt_pk_bf16_f32 v179, v146, v147
  v_mfma_f32_16x16x32_bf16 v[136:139], v[112:115], a[200:203], v[136:139]
  v_permlane16_swap_b32 v176, v178
  v_mfma_f32_16x16x32_bf16 v[140:143], v[112:115], a[204:207], v[140:143]
  s_waitcnt vmcnt(1)
  v_mfma_f32_16x16x32_bf16 v[128:131], v[116:119], a[208:211], v[128:131]
  v_mfma_f32_16x16x32_bf16 v[132:135], v[116:119], a[212:215], v[132:135]
  v_permlane16_swap_b32 v177, v179
  v_mfma_f32_16x16x32_bf16 v[136:139], v[116:119], a[216:219], v[136:139]
  buffer_store_dwordx4 v[176:179], v11, s[52:55], 0 offen offset:64 sc1
  v_mfma_f32_16x16x32_bf16 v[140:143], v[116:119], a[220:223], v[140:143]
  s_nop 3
  ds_write_b128 v2, v[132:135] offset:0
  s_nop 0
  ds_write_b128 v2, v[136:139] offset:4096
  s_nop 0
  ds_write_b128 v2, v[140:143] offset:8192
  s_waitcnt lgkmcnt(0)
  s_barrier
  ds_read_b128 v[160:163], v3 offset:0
  ds_read_b128 v[164:167], v4 offset:4096
  ds_read_b128 v[168:171], v5 offset:8192
  s_waitcnt lgkmcnt(1)
  v_add_f32 v160, v160, v164
  v_add_f32 v161, v161, v165
  v_add_f32 v162, v162, v166
  v_add_f32 v163, v163, v167
  s_waitcnt lgkmcnt(0)
  v_add_f32 v128, v128, v168
  v_add_f32 v129, v129, v169
  v_add_f32 v130, v130, v170
  v_add_f32 v131, v131, v171
  v_add_f32 v128, v128, v160
  v_add_f32 v129, v129, v161
  v_add_f32 v130, v130, v162
  v_add_f32 v131, v131, v163
  v_cvt_pk_bf16_f32 v180, v128, v129
  v_cvt_pk_bf16_f32 v181, v130, v131
  buffer_store_dwordx2 v[180:181], v10, s[52:55], 0 offen offset:128
Lfin:
  s_cmp_lg_u32 s2, 0
  s_cbranch_scc1 Lexit
  v_mov_b32 v16, s59
  s_mov_b64 exec, 1
  buffer_store_dword v16, off, s[28:31], 0 sc1
Lexit:
Lend:
  s_endpgm
Lslow:
  s_cmp_lg_u32 s64, 0
  s_cbranch_scc1 Lattok
  s_mov_b32 s64, 1
  v_mov_b32 v18, 0xf149f2ca
  v_mov_b32 v19, 0xf149f2ca
  s_cmp_gt_u32 s66, 0
  s_cselect_b32 s65, 1.0, 0x3f80f149
  v_mov_b32 v184, s65
  s_mov_b32 exec_hi, 0
  ds_read_b64 v[184:185], v3 offset:4608
  s_mov_b64 exec, -1
  ds_read_b128 v[176:179], v2 offset:9216
  s_waitcnt lgkmcnt(0)
  v_mfma_f32_32x32x16_bf16 v[64:79], v[176:179], v[208:211], v[144:159]
  v_mfma_f32_32x32x8bf16_1k v[64:79], v[184:185], v[214:215], v[64:79]
  s_nop 7
  s_nop 3
  v_max3_f32 v19, v64, v65, v19
  v_max3_f32 v19, v66, v67, v19
  v_max3_f32 v19, v68, v69, v19
  v_max3_f32 v19, v70, v71, v19
  v_max3_f32 v19, v72, v73, v19
  v_max3_f32 v19, v74, v75, v19
  v_max3_f32 v19, v76, v77, v19
  v_max3_f32 v19, v78, v79, v19
  s_cmp_gt_u32 s66, 1
  s_cselect_b32 s65, 1.0, 0x3f80f149
  v_mov_b32 v186, s65
  s_mov_b32 exec_hi, 0
  ds_read_b64 v[186:187], v3 offset:4096
  s_mov_b64 exec, -1
  ds_read_b128 v[180:183], v2 offset:8192
  s_waitcnt lgkmcnt(0)
  v_mfma_f32_32x32x16_bf16 v[80:95], v[180:183], v[204:207], v[144:159]
  v_mfma_f32_32x32x8bf16_1k v[80:95], v[186:187], v[212:213], v[80:95]
  s_nop 7
  s_nop 3
  v_max3_f32 v18, v80, v81, v18
  v_max3_f32 v18, v82, v83, v18
  v_max3_f32 v18, v84, v85, v18
  v_max3_f32 v18, v86, v87, v18
  v_max3_f32 v18, v88, v89, v18
  v_max3_f32 v18, v90, v91, v18
  v_max3_f32 v18, v92, v93, v18
  v_max3_f32 v18, v94, v95, v18
  v_mfma_f32_32x32x16_bf16 v[64:79], v[180:183], v[208:211], 0
  v_mfma_f32_32x32x8bf16_1k v[64:79], v[186:187], v[214:215], v[64:79]
  s_nop 7
  s_nop 3
  v_max3_f32 v19, v64, v65, v19
  v_max3_f32 v19, v66, v67, v19
  v_max3_f32 v19, v68, v69, v19
  v_max3_f32 v19, v70, v71, v19
  v_max3_f32 v19, v72, v73, v19
  v_max3_f32 v19, v74, v75, v19
  v_max3_f32 v19, v76, v77, v19
  v_max3_f32 v19, v78, v79, v19
  s_cmp_gt_u32 s66, 2
  s_cselect_b32 s65, 1.0, 0x3f80f149
  v_mov_b32 v184, s65
  s_mov_b32 exec_hi, 0
  ds_read_b64 v[184:185], v3 offset:3584
  s_mov_b64 exec, -1
  ds_read_b128 v[176:179], v2 offset:7168
  s_waitcnt lgkmcnt(0)
  v_mfma_f32_32x32x16_bf16 v[80:95], v[176:179], v[204:207], 0
  v_mfma_f32_32x32x8bf16_1k v[80:95], v[184:185], v[212:213], v[80:95]
  s_nop 7
  s_nop 3
  v_max3_f32 v18, v80, v81, v18
  v_max3_f32 v18, v82, v83, v18
  v_max3_f32 v18, v84, v85, v18
  v_max3_f32 v18, v86, v87, v18
  v_max3_f32 v18, v88, v89, v18
  v_max3_f32 v18, v90, v91, v18
  v_max3_f32 v18, v92, v93, v18
  v_max3_f32 v18, v94, v95, v18
  v_mfma_f32_32x32x16_bf16 v[64:79], v[176:179], v[208:211], 0
  v_mfma_f32_32x32x8bf16_1k v[64:79], v[184:185], v[214:215], v[64:79]
  s_nop 7
  s_nop 3
  v_max3_f32 v19, v64, v65, v19
  v_max3_f32 v19, v66, v67, v19
  v_max3_f32 v19, v68, v69, v19
  v_max3_f32 v19, v70, v71, v19
  v_max3_f32 v19, v72, v73, v19
  v_max3_f32 v19, v74, v75, v19
  v_max3_f32 v19, v76, v77, v19
  v_max3_f32 v19, v78, v79, v19
  s_cmp_gt_u32 s66, 3
  s_cselect_b32 s65, 1.0, 0x3f80f149
  v_mov_b32 v186, s65
  s_mov_b32 exec_hi, 0
  ds_read_b64 v[186:187], v3 offset:3072
  s_mov_b64 exec, -1
  ds_read_b128 v[180:183], v2 offset:6144
  s_waitcnt lgkmcnt(0)
  v_mfma_f32_32x32x16_bf16 v[80:95], v[180:183], v[204:207], 0
  v_mfma_f32_32x32x8bf16_1k v[80:95], v[186:187], v[212:213], v[80:95]
  s_nop 7
  s_nop 3
  v_max3_f32 v18, v80, v81, v18
  v_max3_f32 v18, v82, v83, v18
  v_max3_f32 v18, v84, v85, v18
  v_max3_f32 v18, v86, v87, v18
  v_max3_f32 v18, v88, v89, v18
  v_max3_f32 v18, v90, v91, v18
  v_max3_f32 v18, v92, v93, v18
  v_max3_f32 v18, v94, v95, v18
  v_mfma_f32_32x32x16_bf16 v[64:79], v[180:183], v[208:211], 0
  v_mfma_f32_32x32x8bf16_1k v[64:79], v[186:187], v[214:215], v[64:79]
  s_nop 7
  s_nop 3
  v_max3_f32 v19, v64, v65, v19
  v_max3_f32 v19, v66, v67, v19
  v_max3_f32 v19, v68, v69, v19
  v_max3_f32 v19, v70, v71, v19
  v_max3_f32 v19, v72, v73, v19
  v_max3_f32 v19, v74, v75, v19
  v_max3_f32 v19, v76, v77, v19
  v_max3_f32 v19, v78, v79, v19
  s_cmp_gt_u32 s66, 4
  s_cselect_b32 s65, 1.0, 0x3f80f149
  v_mov_b32 v184, s65
  s_mov_b32 exec_hi, 0
  ds_read_b64 v[184:185], v3 offset:2560
  s_mov_b64 exec, -1
  ds_read_b128 v[176:179], v2 offset:5120
  s_waitcnt lgkmcnt(0)
  v_mfma_f32_32x32x16_bf16 v[80:95], v[176:179], v[204:207], 0
  v_mfma_f32_32x32x8bf16_1k v[80:95], v[184:185], v[212:213], v[80:95]
  s_nop 7
  s_nop 3
  v_max3_f32 v18, v80, v81, v18
  v_max3_f32 v18, v82, v83, v18
  v_max3_f32 v18, v84, v85, v18
  v_max3_f32 v18, v86, v87, v18
  v_max3_f32 v18, v88, v89, v18
  v_max3_f32 v18, v90, v91, v18
  v_max3_f32 v18, v92, v93, v18
  v_max3_f32 v18, v94, v95, v18
  v_mfma_f32_32x32x16_bf16 v[64:79], v[176:179], v[208:211], 0
  v_mfma_f32_32x32x8bf16_1k v[64:79], v[184:185], v[214:215], v[64:79]
  s_nop 7
  s_nop 3
  v_max3_f32 v19, v64, v65, v19
  v_max3_f32 v19, v66, v67, v19
  v_max3_f32 v19, v68, v69, v19
  v_max3_f32 v19, v70, v71, v19
  v_max3_f32 v19, v72, v73, v19
  v_max3_f32 v19, v74, v75, v19
  v_max3_f32 v19, v76, v77, v19
  v_max3_f32 v19, v78, v79, v19
  s_cmp_gt_u32 s66, 5
  s_cselect_b32 s65, 1.0, 0x3f80f149
  v_mov_b32 v186, s65
  s_mov_b32 exec_hi, 0
  ds_read_b64 v[186:187], v3 offset:2048
  s_mov_b64 exec, -1
  ds_read_b128 v[180:183], v2 offset:4096
  s_waitcnt lgkmcnt(0)
  v_mfma_f32_32x32x16_bf16 v[80:95], v[180:183], v[204:207], 0
  v_mfma_f32_32x32x8bf16_1k v[80:95], v[186:187], v[212:213], v[80:95]
  s_nop 7
  s_nop 3
  v_max3_f32 v18, v80, v81, v18
  v_max3_f32 v18, v82, v83, v18
  v_max3_f32 v18, v84, v85, v18
  v_max3_f32 v18, v86, v87, v18
  v_max3_f32 v18, v88, v89, v18
  v_max3_f32 v18, v90, v91, v18
  v_max3_f32 v18, v92, v93, v18
  v_max3_f32 v18, v94, v95, v18
  v_mfma_f32_32x32x16_bf16 v[64:79], v[180:183], v[208:211], 0
  v_mfma_f32_32x32x8bf16_1k v[64:79], v[186:187], v[214:215], v[64:79]
  s_nop 7
  s_nop 3
  v_max3_f32 v19, v64, v65, v19
  v_max3_f32 v19, v66, v67, v19
  v_max3_f32 v19, v68, v69, v19
  v_max3_f32 v19, v70, v71, v19
  v_max3_f32 v19, v72, v73, v19
  v_max3_f32 v19, v74, v75, v19
  v_max3_f32 v19, v76, v77, v19
  v_max3_f32 v19, v78, v79, v19
  s_cmp_gt_u32 s66, 6
  s_cselect_b32 s65, 1.0, 0x3f80f149
  v_mov_b32 v184, s65
  s_mov_b32 exec_hi, 0
  ds_read_b64 v[184:185], v3 offset:1536
  s_mov_b64 exec, -1
  ds_read_b128 v[176:179], v2 offset:3072
  s_waitcnt lgkmcnt(0)
  v_mfma_f32_32x32x16_bf16 v[80:95], v[176:179], v[204:207], 0
  v_mfma_f32_32x32x8bf16_1k v[80:95], v[184:185], v[212:213], v[80:95]
  s_nop 7
  s_nop 3
  v_max3_f32 v18, v80, v81, v18
  v_max3_f32 v18, v82, v83, v18
  v_max3_f32 v18, v84, v85, v18
  v_max3_f32 v18, v86, v87, v18
  v_max3_f32 v18, v88, v89, v18
  v_max3_f32 v18, v90, v91, v18
  v_max3_f32 v18, v92, v93, v18
  v_max3_f32 v18, v94, v95, v18
  v_mfma_f32_32x32x16_bf16 v[64:79], v[176:179], v[208:211], 0
  v_mfma_f32_32x32x8bf16_1k v[64:79], v[184:185], v[214:215], v[64:79]
  s_nop 7
  s_nop 3
  v_max3_f32 v19, v64, v65, v19
  v_max3_f32 v19, v66, v67, v19
  v_max3_f32 v19, v68, v69, v19
  v_max3_f32 v19, v70, v71, v19
  v_max3_f32 v19, v72, v73, v19
  v_max3_f32 v19, v74, v75, v19
  v_max3_f32 v19, v76, v77, v19
  v_max3_f32 v19, v78, v79, v19
  s_cmp_gt_u32 s66, 7
  s_cselect_b32 s65, 1.0, 0x3f80f149
  v_mov_b32 v186, s65
  s_mov_b32 exec_hi, 0
  ds_read_b64 v[186:187], v3 offset:1024
  s_mov_b64 exec, -1
  ds_read_b128 v[180:183], v2 offset:2048
  s_waitcnt lgkmcnt(0)
  v_mfma_f32_32x32x16_bf16 v[80:95], v[180:183], v[204:207], 0
  v_mfma_f32_32x32x8bf16_1k v[80:95], v[186:187], v[212:213], v[80:95]
  s_nop 7
  s_nop 3
  v_max3_f32 v18, v80, v81, v18
  v_max3_f32 v18, v82, v83, v18
  v_max3_f32 v18, v84, v85, v18
  v_max3_f32 v18, v86, v87, v18
  v_max3_f32 v18, v88, v89, v18
  v_max3_f32 v18, v90, v91, v18
  v_max3_f32 v18, v92, v93, v18
  v_max3_f32 v18, v94, v95, v18
  v_mfma_f32_32x32x16_bf16 v[64:79], v[180:183], v[208:211], 0
  v_mfma_f32_32x32x8bf16_1k v[64:79], v[186:187], v[214:215], v[64:79]
  s_nop 7
  s_nop 3
  v_max3_f32 v19, v64, v65, v19
  v_max3_f32 v19, v66, v67, v19
  v_max3_f32 v19, v68, v69, v19
  v_max3_f32 v19, v70, v71, v19
  v_max3_f32 v19, v72, v73, v19
  v_max3_f32 v19, v74, v75, v19
  v_max3_f32 v19, v76, v77, v19
  v_max3_f32 v19, v78, v79, v19
  s_cmp_gt_u32 s66, 8
  s_cselect_b32 s65, 1.0, 0x3f80f149
  v_mov_b32 v184, s65
  s_mov_b32 exec_hi, 0
  ds_read_b64 v[184:185], v3 offset:512
  s_mov_b64 exec, -1
  ds_read_b128 v[176:179], v2 offset:1024
  s_waitcnt lgkmcnt(0)
  v_mfma_f32_32x32x16_bf16 v[80:95], v[176:179], v[204:207], 0
  v_mfma_f32_32x32x8bf16_1k v[80:95], v[184:185], v[212:213], v[80:95]
  s_nop 7
  s_nop 3
  v_max3_f32 v18, v80, v81, v18
  v_max3_f32 v18, v82, v83, v18
  v_max3_f32 v18, v84, v85, v18
  v_max3_f32 v18, v86, v87, v18
  v_max3_f32 v18, v88, v89, v18
  v_max3_f32 v18, v90, v91, v18
  v_max3_f32 v18, v92, v93, v18
  v_max3_f32 v18, v94, v95, v18
  v_mfma_f32_32x32x16_bf16 v[64:79], v[176:179], v[208:211], v[160:175]
  v_mfma_f32_32x32x8bf16_1k v[64:79], v[184:185], v[214:215], v[64:79]
  s_nop 7
  s_nop 3
  v_max3_f32 v19, v64, v65, v19
  v_max3_f32 v19, v66, v67, v19
  v_max3_f32 v19, v68, v69, v19
  v_max3_f32 v19, v70, v71, v19
  v_max3_f32 v19, v72, v73, v19
  v_max3_f32 v19, v74, v75, v19
  v_max3_f32 v19, v76, v77, v19
  v_max3_f32 v19, v78, v79, v19
  s_cmp_gt_u32 s66, 9
  s_cselect_b32 s65, 1.0, 0x3f80f149
  v_mov_b32 v186, s65
  s_mov_b32 exec_hi, 0
  ds_read_b64 v[186:187], v3 offset:0
  s_mov_b64 exec, -1
  ds_read_b128 v[180:183], v2 offset:0
  s_waitcnt lgkmcnt(0)
  v_mfma_f32_32x32x16_bf16 v[80:95], v[180:183], v[204:207], v[160:175]
  v_mfma_f32_32x32x8bf16_1k v[80:95], v[186:187], v[212:213], v[80:95]
  s_nop 7
  s_nop 3
  v_max3_f32 v18, v80, v81, v18
  v_max3_f32 v18, v82, v83, v18
  v_max3_f32 v18, v84, v85, v18
  v_max3_f32 v18, v86, v87, v18
  v_max3_f32 v18, v88, v89, v18
  v_max3_f32 v18, v90, v91, v18
  v_max3_f32 v18, v92, v93, v18
  v_max3_f32 v18, v94, v95, v18
  v_mov_b32 v16, v18
  s_nop 1
  v_permlane32_swap_b32 v16, v18
  v_max_f32 v16, v16, v18
  v_sub_f32 v16, 0, v16
  v_and_b32 v17, 0xffff0000, v16
  v_sub_f32 v16, v16, v17
  v_or_b32 v17, 0x3f80, v17
  v_and_b32 v20, 0xffff0000, v16
  v_sub_f32 v16, v16, v20
  v_and_b32 v16, 0xffff0000, v16
  v_lshrrev_b32 v20, 16, v20
  s_mov_b32 exec_lo, 0
  v_mov_b32 v212, v17
  v_or_b32 v213, v16, v20
  s_mov_b32 exec_lo, -1
  v_mov_b32 v16, v19
  s_nop 1
  v_permlane32_swap_b32 v16, v19
  v_max_f32 v16, v16, v19
  v_sub_f32 v16, 0, v16
  v_and_b32 v17, 0xffff0000, v16
  v_sub_f32 v16, v16, v17
  v_or_b32 v17, 0x3f80, v17
  v_and_b32 v20, 0xffff0000, v16
  v_sub_f32 v16, v16, v20
  v_and_b32 v16, 0xffff0000, v16
  v_lshrrev_b32 v20, 16, v20
  s_mov_b32 exec_lo, 0
  v_mov_b32 v214, v17
  v_or_b32 v215, v16, v20
  s_mov_b32 exec_lo, -1
  s_waitcnt vmcnt(0) lgkmcnt(0)
  s_mul_i32 s3, s58, 25600
  s_mul_i32 s4, s12, 1536
  s_add_u32 s3, s3, 13312
  s_and_b32 s4, s4, 0xfffff800
  v_add_u32 v248, 331776, v244
  v_add_u32 v249, 331776, v245
  s_add_u32 m0, s4, s3
  s_mul_i32 s5, s4, 27
  buffer_load_dwordx4 v248, s[44:47], s5 offen lds
  buffer_load_dwordx4 v249, s[44:47], s5 offen offset:1024 lds
  s_addk_i32 s4, 2048
  s_cmpk_eq_u32 s4, 12288
  s_cmovk_i32 s4, 0
  s_add_u32 m0, s4, s3
  s_mul_i32 s5, s4, 27
  buffer_load_dwordx4 v248, s[44:47], s5 offen lds
  buffer_load_dwordx4 v249, s[44:47], s5 offen offset:1024 lds
  s_addk_i32 s4, 2048
  s_cmpk_eq_u32 s4, 12288
  s_cmovk_i32 s4, 0
  s_add_u32 m0, s4, s3
  s_mul_i32 s5, s4, 27
  buffer_load_dwordx4 v248, s[44:47], s5 offen lds
  buffer_load_dwordx4 v249, s[44:47], s5 offen offset:1024 lds
  s_addk_i32 s4, 2048
  s_cmpk_eq_u32 s4, 12288
  s_cmovk_i32 s4, 0
  s_add_u32 m0, s4, s3
  s_mul_i32 s5, s4, 27
  buffer_load_dwordx4 v248, s[44:47], s5 offen lds
  buffer_load_dwordx4 v249, s[44:47], s5 offen offset:1024 lds
  s_addk_i32 s4, 2048
  s_cmpk_eq_u32 s4, 12288
  s_cmovk_i32 s4, 0
  s_add_u32 m0, s4, s3
  s_mul_i32 s5, s4, 27
  buffer_load_dwordx4 v248, s[44:47], s5 offen lds
  buffer_load_dwordx4 v249, s[44:47], s5 offen offset:1024 lds
  s_addk_i32 s4, 2048
  s_cmpk_eq_u32 s4, 12288
  s_cmovk_i32 s4, 0
  s_add_u32 m0, s4, s3
  s_mul_i32 s5, s4, 27
  buffer_load_dwordx4 v248, s[44:47], s5 offen lds
  buffer_load_dwordx4 v249, s[44:47], s5 offen offset:1024 lds
  s_waitcnt vmcnt(0) lgkmcnt(0)
  s_nop 7
  s_branch Latt
Lcodeend:
.section .rodata,"a"
.p2align 6
.amdhsa_kernel sequential_preLN__sliding_block__mixer_token_mlp__prompt_kernel
  .amdhsa_next_free_vgpr 512
  .amdhsa_next_free_sgpr 102
  .amdhsa_accum_offset 256
  .amdhsa_group_segment_fixed_size 0
  .amdhsa_kernarg_size 88
  .amdhsa_user_sgpr_count 2
  .amdhsa_user_sgpr_kernarg_segment_ptr 1
  .amdhsa_system_sgpr_workgroup_id_x 1
.end_amdhsa_kernel
```
